```python
import torch

def _softmax(x, axis=-1):
    return torch.softmax(x, dim=axis)
def _gelu(x):
    return torch.nn.functional.gelu(x, approximate="tanh")
def _silu(x):
    return torch.nn.functional.silu(x)
def _sigmoid(x):
    return torch.sigmoid(x)
def _layernorm(x, axis=-1, eps=1e-5):
    m = x.mean(dim=axis, keepdim=True)
    v = x.var(dim=axis, keepdim=True, unbiased=False)
    return (x - m) / torch.sqrt(v + eps)
def _scatter_add(tgt, idx, src, axis=0):
    return tgt.clone().index_add_(axis, idx, src)
def _segment_sum(src, seg, n):
    out = torch.zeros((n,) + src.shape[1:], dtype=src.dtype)
    return out.index_add_(0, seg, src)
def _pad(x, pw):
    flat = tuple(v for pair in reversed(pw) for v in pair)
    return torch.nn.functional.pad(x, flat)

kernel_name = 'concat_heads__gqa_block_cached__gqa_block_cached__near_ridge'

def setup_inputs():

    _w = (lambda a: (lambda t: t.to(torch.bfloat16) if t.is_floating_point() else t)(torch.as_tensor(a)))
    def _A_setup():
        B, Sq, D = 32, 96, 576
        Hq, Hkv, Sk, Dh = 32, 16, 512, 128
        assert Hq % Hkv == 0, (Hq, Hkv)
        return {
            "x": _w((lambda *s: torch.randn(*s, dtype=torch.bfloat16) * 0.8)(B, Sq, D)),
            "k_cache": _w((lambda *s: torch.randn(*s, dtype=torch.bfloat16) * 0.8)(B, Hkv, Sk, Dh)),
            "v_cache": _w((lambda *s: torch.randn(*s, dtype=torch.bfloat16) * 0.05)(B, Hkv, Sk, Dh)),
            "wq": _w((lambda *s: torch.randn(*s, dtype=torch.bfloat16) * 0.8)(D, Hq * Dh) * (D ** -0.5)),
            "wo": _w((lambda *s: torch.randn(*s, dtype=torch.bfloat16) * 0.05)(Hq * Dh, D) * ((Hq * Dh) ** -0.5)),
        }
    _A_in = _A_setup()

    def _B_setup():
        B, Sq, D = 32, 96, 576
        Hq, Hkv, Sk, Dh = 32, 16, 512, 128
        assert Hq % Hkv == 0, (Hq, Hkv)
        return {
            "x": _w((lambda *s: torch.randn(*s, dtype=torch.bfloat16) * 0.8)(B, Sq, D)),
            "k_cache": _w((lambda *s: torch.randn(*s, dtype=torch.bfloat16) * 0.8)(B, Hkv, Sk, Dh)),
            "v_cache": _w((lambda *s: torch.randn(*s, dtype=torch.bfloat16) * 0.05)(B, Hkv, Sk, Dh)),
            "wq": _w((lambda *s: torch.randn(*s, dtype=torch.bfloat16) * 0.8)(D, Hq * Dh) * (D ** -0.5)),
            "wo": _w((lambda *s: torch.randn(*s, dtype=torch.bfloat16) * 0.05)(Hq * Dh, D) * ((Hq * Dh) ** -0.5)),
        }
    _B_in = _B_setup()

    return {
        "A_x": _A_in["x"],
        "A_k_cache": _A_in["k_cache"],
        "A_v_cache": _A_in["v_cache"],
        "A_wq": _A_in["wq"],
        "A_wo": _A_in["wo"],
        "B_x": _B_in["x"],
        "B_k_cache": _B_in["k_cache"],
        "B_v_cache": _B_in["v_cache"],
        "B_wq": _B_in["wq"],
        "B_wo": _B_in["wo"],
    }

def reference(A_x, A_k_cache, A_v_cache, A_wq, A_wo, B_x, B_k_cache, B_v_cache, B_wq, B_wo):
    def _A_ref(x, k_cache, v_cache, wq, wo):
        B, Sq, D = x.shape
        Hq, Dh = 32, 128
        Hkv = k_cache.shape[1]
        rep = Hq // Hkv
        q = (lambda x, *d: x.permute(*d))((x @ wq).reshape(B, Sq, Hq, Dh), 0, 2, 1, 3)
        k = (lambda x, n, axis: torch.repeat_interleave(x, n, dim=axis))(k_cache, rep, axis=1)
        v = (lambda x, n, axis: torch.repeat_interleave(x, n, dim=axis))(v_cache, rep, axis=1)
        scores = torch.einsum("bhqd,bhkd->bhqk", q, k) * (Dh ** -0.5)
        p = _softmax(scores, axis=-1)
        o = torch.einsum("bhqk,bhkd->bhqd", p, v)
        return (lambda x, *d: x.permute(*d))(o, 0, 2, 1, 3).reshape(B, Sq, Hq * Dh) @ wo

    def _B_ref(x, k_cache, v_cache, wq, wo):
        B, Sq, D = x.shape
        Hq, Dh = 32, 128
        Hkv = k_cache.shape[1]
        rep = Hq // Hkv
        q = (lambda x, *d: x.permute(*d))((x @ wq).reshape(B, Sq, Hq, Dh), 0, 2, 1, 3)
        k = (lambda x, n, axis: torch.repeat_interleave(x, n, dim=axis))(k_cache, rep, axis=1)
        v = (lambda x, n, axis: torch.repeat_interleave(x, n, dim=axis))(v_cache, rep, axis=1)
        scores = torch.einsum("bhqd,bhkd->bhqk", q, k) * (Dh ** -0.5)
        p = _softmax(scores, axis=-1)
        o = torch.einsum("bhqk,bhkd->bhqd", p, v)
        return (lambda x, *d: x.permute(*d))(o, 0, 2, 1, 3).reshape(B, Sq, Hq * Dh) @ wo

    a = _A_ref(A_x, A_k_cache, A_v_cache, A_wq, A_wo)
    b = _B_ref(B_x, B_k_cache, B_v_cache, B_wq, B_wo)
    return torch.concatenate([a, b], axis=-1)
```

```asm
; @launch grid=(256,1,1) block=(256,1,1) lds=163840
.amdgcn_target "amdgcn-amd-amdhsa--gfx950"
.text
.globl concat_heads__gqa_block_cached__gqa_block_cached__near_ridge_kernel
.p2align 8
.type concat_heads__gqa_block_cached__gqa_block_cached__near_ridge_kernel,@function
concat_heads__gqa_block_cached__gqa_block_cached__near_ridge_kernel:
    s_cmp_ge_u32 s2, 256
    s_cbranch_scc1 L_end
    s_bfe_u32 s39, s2, 0x10002
    s_and_b32 s38, s2, 2
    s_bfe_u32 s3, s2, 0x10003
    s_or_b32 s38, s38, s3
    s_and_b32 s3, s2, 1
    s_lshl_b32 s3, s3, 4
    s_lshr_b32 s37, s2, 4
    s_or_b32 s37, s37, s3
    s_mul_i32 s3, s39, 40
    s_add_u32 s60, s0, s3
    s_addc_u32 s61, s1, 0
    s_load_dwordx2 s[74:75], s[60:61], 0
    s_load_dwordx2 s[68:69], s[60:61], 24
    s_load_dwordx2 s[64:65], s[60:61], 8
    s_load_dwordx2 s[66:67], s[60:61], 16
    s_load_dwordx2 s[70:71], s[60:61], 32
    s_load_dwordx2 s[72:73], s[0:1], 80
    s_load_dwordx2 s[62:63], s[0:1], 88
    s_load_dwordx2 s[76:77], s[0:1], 96
    s_getpc_b64 s[84:85]
L_pc1:
    s_sub_u32 s84, s84, L_pc1-concat_heads__gqa_block_cached__gqa_block_cached__near_ridge_kernel
    s_subb_u32 s85, s85, 0
    s_lshr_b32 s82, s2, 3
    s_lshl_b32 s82, s82, 11
    v_and_b32 v252, 0xc3, v0
    v_lshrrev_b32 v253, 4, v252
    v_and_b32 v252, 3, v252
    v_add_u32 v252, v252, v253
    v_lshlrev_b32 v252, 7, v252
    v_add_u32 v252, s82, v252
    v_min_u32 v252, L_end-concat_heads__gqa_block_cached__gqa_block_cached__near_ridge_kernel, v252
    v_mov_b32 v253, s85
    v_add_co_u32 v252, vcc, s84, v252
    s_nop 1
    v_addc_co_u32 v253, vcc, 0, v253, vcc
    global_load_dword a255, v[252:253], off
    v_lshrrev_b32 v1, 6, v0
    v_and_b32 v0, 63, v0
    v_readfirstlane_b32 s36, v1
    v_lshrrev_b32 v1, 4, v0
    v_and_b32 v2, 15, v0
    v_lshlrev_b32 v3, 1, v1
    v_xor_b32 v3, v3, v2
    v_lshlrev_b32 v3, 4, v3
    v_lshl_add_u32 v17, v1, 13, v3
    v_add_u32 v18, 31680, v17
    v_add_u32 v19, 63360, v17
    v_add_u32 v20, 95040, v17
    s_mul_i32 s41, s36, 8704
    s_add_u32 s42, s41, 4352
    s_mul_i32 s94, s36, 3072
    s_add_u32 s94, s94, 139264
    s_lshl_b32 s93, s94, 1
    s_add_u32 s93, s93, 12288
    s_lshl_b32 s45, s36, 8
    s_mov_b32 s47, 0
    s_mul_i32 s3, s36, 24
    v_lshrrev_b32 v1, 3, v0
    v_add_u32 v1, s3, v1
    v_add_u32 v1, 0, v1
    v_lshrrev_b32 v2, 1, v1
    v_xor_b32 v2, v2, v0
    v_and_b32 v2, 7, v2
    v_mul_u32_u24 v1, 1152, v1
    v_lshl_add_u32 v21, v2, 4, v1
    v_lshrrev_b32 v1, 3, v0
    v_add_u32 v1, s3, v1
    v_add_u32 v1, 8, v1
    v_lshrrev_b32 v2, 1, v1
    v_xor_b32 v2, v2, v0
    v_and_b32 v2, 7, v2
    v_mul_u32_u24 v1, 1152, v1
    v_lshl_add_u32 v22, v2, 4, v1
    v_subrev_u32 v22, 1024, v22
    v_lshrrev_b32 v1, 3, v0
    v_add_u32 v1, s3, v1
    v_add_u32 v1, 16, v1
    v_lshrrev_b32 v2, 1, v1
    v_xor_b32 v2, v2, v0
    v_and_b32 v2, 7, v2
    v_mul_u32_u24 v1, 1152, v1
    v_lshl_add_u32 v23, v2, 4, v1
    v_subrev_u32 v23, 2048, v23
    s_waitcnt lgkmcnt(0)
    s_mul_i32 s3, s37, 110592
    s_add_u32 s4, s74, s3
    s_addc_u32 s5, s75, 0
    s_and_b32 s5, s5, 0xffff
    s_mov_b32 s6, 110592
    s_mov_b32 s7, 0x20000
    s_lshl_b32 s3, s38, 11
    s_add_u32 s16, s68, s3
    s_addc_u32 s17, s69, 0
    s_and_b32 s17, s17, 0xffff
    s_sub_u32 s18, 4718592, s3
    s_mov_b32 s19, 0x20000
    s_and_b32 s0, s37, 15
    s_and_b32 s1, s38, 1
    s_mul_i32 s1, s1, 4
    s_add_u32 s0, s0, s1
    s_sub_u32 s1, s0, 9
    s_cmp_ge_u32 s0, 9
    s_cselect_b32 s0, s1, s0
    s_sub_u32 s1, s0, 9
    s_cmp_ge_u32 s0, 9
    s_cselect_b32 s0, s1, s0
    s_lshl_b32 s47, s0, 7
    s_lshl_b32 s1, s0, 19
    s_add_u32 s45, s45, s1
    s_mov_b32 m0, s94
    s_nop 0
    buffer_load_dwordx4 v21, s[4:7], s47 offen offset:0 lds
    buffer_load_dwordx4 v22, s[4:7], s47 offen offset:1024 lds
    buffer_load_dwordx4 v23, s[4:7], s47 offen offset:2048 lds
    s_add_u32 s47, s47, 128
    s_sub_u32 s94, s93, s94
    s_cmp_eq_u32 s47, 1152
    s_cselect_b32 s47, 0, s47
    s_add_u32 m0, s41, 0
    s_nop 0
    buffer_load_dwordx4 v17, s[16:19], s45 offen offset:0 lds
    buffer_load_dwordx4 v18, s[16:19], s45 offen offset:1088 lds
    buffer_load_dwordx4 v19, s[16:19], s45 offen offset:2176 lds
    buffer_load_dwordx4 v20, s[16:19], s45 offen offset:3264 lds
    s_add_u32 s46, s45, 131072
    s_add_u32 m0, s42, 0
    s_nop 0
    buffer_load_dwordx4 v17, s[16:19], s46 offen offset:0 lds
    buffer_load_dwordx4 v18, s[16:19], s46 offen offset:1088 lds
    buffer_load_dwordx4 v19, s[16:19], s46 offen offset:2176 lds
    buffer_load_dwordx4 v20, s[16:19], s46 offen offset:3264 lds
    s_add_u32 s45, s45, 262144
    s_cmp_ge_u32 s45, 4718592
    s_cselect_b32 s46, 4718592, 0
    s_sub_u32 s45, s45, s46
    s_add_u32 m0, s41, 34816
    s_nop 0
    buffer_load_dwordx4 v17, s[16:19], s45 offen offset:0 lds
    buffer_load_dwordx4 v18, s[16:19], s45 offen offset:1088 lds
    buffer_load_dwordx4 v19, s[16:19], s45 offen offset:2176 lds
    buffer_load_dwordx4 v20, s[16:19], s45 offen offset:3264 lds
    s_add_u32 s46, s45, 131072
    s_add_u32 m0, s42, 34816
    s_nop 0
    buffer_load_dwordx4 v17, s[16:19], s46 offen offset:0 lds
    buffer_load_dwordx4 v18, s[16:19], s46 offen offset:1088 lds
    buffer_load_dwordx4 v19, s[16:19], s46 offen offset:2176 lds
    buffer_load_dwordx4 v20, s[16:19], s46 offen offset:3264 lds
    s_add_u32 s45, s45, 262144
    s_cmp_ge_u32 s45, 4718592
    s_cselect_b32 s46, 4718592, 0
    s_sub_u32 s45, s45, s46
    s_mov_b32 m0, s94
    s_nop 0
    buffer_load_dwordx4 v21, s[4:7], s47 offen offset:0 lds
    buffer_load_dwordx4 v22, s[4:7], s47 offen offset:1024 lds
    buffer_load_dwordx4 v23, s[4:7], s47 offen offset:2048 lds
    s_add_u32 s47, s47, 128
    s_sub_u32 s94, s93, s94
    s_cmp_eq_u32 s47, 1152
    s_cselect_b32 s47, 0, s47
    s_add_u32 m0, s41, 69632
    s_nop 0
    buffer_load_dwordx4 v17, s[16:19], s45 offen offset:0 lds
    buffer_load_dwordx4 v18, s[16:19], s45 offen offset:1088 lds
    buffer_load_dwordx4 v19, s[16:19], s45 offen offset:2176 lds
    buffer_load_dwordx4 v20, s[16:19], s45 offen offset:3264 lds
    s_add_u32 s46, s45, 131072
    s_add_u32 m0, s42, 69632
    s_nop 0
    buffer_load_dwordx4 v17, s[16:19], s46 offen offset:0 lds
    buffer_load_dwordx4 v18, s[16:19], s46 offen offset:1088 lds
    buffer_load_dwordx4 v19, s[16:19], s46 offen offset:2176 lds
    buffer_load_dwordx4 v20, s[16:19], s46 offen offset:3264 lds
    s_add_u32 s45, s45, 262144
    s_cmp_ge_u32 s45, 4718592
    s_cselect_b32 s46, 4718592, 0
    s_sub_u32 s45, s45, s46
    s_mov_b32 s50, 1040356334
    s_mov_b32 s51, 1040356334
    s_mov_b32 s95, 0
    s_mov_b32 s61, 0
    s_mov_b32 s98, 104448
    s_mov_b32 s101, 12288
    s_lshl_b32 s60, s37, 2
    s_add_u32 s60, s60, s38
    s_lshl_b32 s60, s60, 2
    s_lshr_b32 s3, s36, 1
    s_add_u32 s60, s60, s3
    s_lshl_b32 s60, s60, 17
    s_mul_i32 s53, s3, 17408
    s_mul_i32 s3, s2, 203008
    s_add_u32 s28, s76, s3
    s_addc_u32 s29, s77, 0
    s_and_b32 s29, s29, 0xffff
    s_mov_b32 s30, 196608
    s_mov_b32 s31, 0x20000
    s_mul_i32 s3, s38, 1179648
    s_add_u32 s20, s70, s3
    s_addc_u32 s21, s71, 0
    s_and_b32 s21, s21, 0xffff
    s_mov_b32 s22, 1179648
    s_mov_b32 s23, 0x20000
    s_mul_i32 s3, s37, 221184
    s_mul_i32 s54, s39, 1152
    s_add_u32 s3, s3, s54
    s_add_u32 s24, s72, s3
    s_addc_u32 s25, s73, 0
    s_and_b32 s25, s25, 0xffff
    s_sub_u32 s26, 221184, s54
    s_mov_b32 s27, 0x20000
    s_lshl_b32 s3, s37, 1
    s_add_u32 s3, s3, s39
    s_mul_i32 s3, s3, 460800
    s_add_u32 s3, s3, 100663296
    s_add_u32 s32, s76, s3
    s_addc_u32 s33, s77, 0
    s_and_b32 s33, s33, 0xffff
    s_mov_b32 s34, 460800
    s_mov_b32 s35, 0x20000
    v_lshrrev_b32 v1, 4, v0
    v_bfe_u32 v2, v0, 2, 2
    v_and_b32 v3, 3, v0
    v_lshlrev_b32 v3, 3, v3
    v_lshl_add_u32 v3, v2, 8, v3
    v_mul_u32_u24 v28, 2176, v1
    v_add_u32 v28, v28, v3
    v_add_u32 v28, s41, v28
    v_lshlrev_b32 v4, 1, v1
    v_and_b32 v4, 2, v4
    v_lshrrev_b32 v29, 1, v1
    v_or_b32 v4, v4, v29
    v_mul_u32_u24 v4, 1088, v4
    v_add_u32 v4, v4, v3
    s_add_u32 s3, s53, 8704
    v_add_u32 v4, s3, v4
    v_xor_b32 v3, 0, v2
    v_lshl_add_u32 v24, v3, 5, v28
    v_lshl_add_u32 v5, v3, 5, v4
    v_xor_b32 v3, 1, v2
    v_lshl_add_u32 v25, v3, 5, v28
    v_lshl_add_u32 v6, v3, 5, v4
    v_xor_b32 v3, 2, v2
    v_lshl_add_u32 v26, v3, 5, v28
    v_lshl_add_u32 v7, v3, 5, v4
    v_xor_b32 v3, 3, v2
    v_lshl_add_u32 v27, v3, 5, v28
    v_lshl_add_u32 v8, v3, 5, v4
    v_and_b32 v2, 15, v0
    v_lshrrev_b32 v3, 1, v2
    v_xor_b32 v3, v3, v1
    v_lshlrev_b32 v3, 4, v3
    v_lshl_add_u32 v28, v2, 7, v3
    v_add_u32 v28, 139264, v28
    v_xor_b32 v29, 64, v28
    v_lshrrev_b32 v3, 2, v2
    v_mul_u32_u24 v4, 1088, v3
    v_and_b32 v2, 3, v2
    v_lshl_add_u32 v4, v2, 8, v4
    v_xor_b32 v2, v2, v1
    v_lshl_add_u32 v4, v2, 4, v4
    v_add_u32 v4, s53, v4
    s_and_b32 s55, s37, 15
    s_lshl_b32 s55, s55, 2
    s_add_u32 s55, s55, s36
    s_mul_i32 s55, s55, 72
    v_add_u32 v1, s55, v0
    v_lshrrev_b32 v2, 3, v1
    v_and_b32 v1, 7, v1
    v_lshlrev_b32 v1, 7, v1
    v_lshl_add_u32 v1, v2, 13, v1
    v_lshlrev_b32 v2, 7, v0
    s_and_b32 s55, s38, 1
    s_lshl_b32 s55, s55, 2
    s_add_u32 s55, s55, s36
    s_mul_i32 s55, s55, 13824
    s_lshl_b32 s55, s38, 2
    s_add_u32 s55, s55, s36
    s_lshl_b32 s55, s55, 7
    s_add_u32 s55, s55, 458752
    v_mov_b32 v36, 0
    v_mov_b32 v37, 0
    v_mov_b32 v38, 0
    v_mov_b32 v39, 0
    v_mov_b32 v1, 0
    buffer_store_dwordx4 v[36:39], v1, s[32:35], s55 offen sc1
    s_mov_b32 s99, s98
    s_add_u32 s98, s98, 34816
    s_cmp_eq_u32 s98, 139264
    s_cselect_b32 s98, 0, s98
    s_sub_u32 s100, s98, s99
    s_waitcnt vmcnt(20)
    s_barrier
    s_add_u32 m0, s41, s99
    s_nop 0
    buffer_load_dwordx4 v17, s[16:19], s45 offen offset:0 lds
    buffer_load_dwordx4 v18, s[16:19], s45 offen offset:1088 lds
    buffer_load_dwordx4 v19, s[16:19], s45 offen offset:2176 lds
    buffer_load_dwordx4 v20, s[16:19], s45 offen offset:3264 lds
    s_add_u32 s46, s45, 131072
    s_add_u32 m0, s42, s99
    s_nop 0
    buffer_load_dwordx4 v17, s[16:19], s46 offen offset:0 lds
    buffer_load_dwordx4 v18, s[16:19], s46 offen offset:1088 lds
    buffer_load_dwordx4 v19, s[16:19], s46 offen offset:2176 lds
    buffer_load_dwordx4 v20, s[16:19], s46 offen offset:3264 lds
    s_add_u32 s45, s45, 262144
    s_cmp_ge_u32 s45, 4718592
    s_cselect_b32 s46, 4718592, 0
    s_sub_u32 s45, s45, s46
    ds_read_b128 a[224:227], v28 offset:0
    ds_read_b128 a[228:231], v28 offset:2048
    ds_read_b128 a[232:235], v28 offset:4096
    ds_read_b128 a[236:239], v28 offset:6144
    ds_read_b128 a[240:243], v28 offset:8192
    ds_read_b128 a[244:247], v28 offset:10240
    ds_read_b64_tr_b16 a[192:193], v24 offset:0
    ds_read_b64_tr_b16 a[194:195], v24 offset:1088
    ds_read_b64_tr_b16 a[196:197], v25 offset:0
    ds_read_b64_tr_b16 a[198:199], v25 offset:1088
    ds_read_b64_tr_b16 a[200:201], v26 offset:0
    ds_read_b64_tr_b16 a[202:203], v26 offset:1088
    ds_read_b64_tr_b16 a[204:205], v27 offset:0
    ds_read_b64_tr_b16 a[206:207], v27 offset:1088
    ds_read_b64_tr_b16 a[208:209], v24 offset:128
    ds_read_b64_tr_b16 a[210:211], v24 offset:1216
    ds_read_b64_tr_b16 a[212:213], v25 offset:128
    ds_read_b64_tr_b16 a[214:215], v25 offset:1216
    ds_read_b64_tr_b16 a[216:217], v26 offset:128
    ds_read_b64_tr_b16 a[218:219], v26 offset:1216
    ds_read_b64_tr_b16 a[220:221], v27 offset:128
    ds_read_b64_tr_b16 a[222:223], v27 offset:1216
    s_mov_b32 s99, s98
    s_add_u32 s98, s98, 34816
    s_waitcnt lgkmcnt(14)
    v_mfma_f32_16x16x32_bf16 v[36:39], a[192:195], a[224:227], 0
    s_cmp_eq_u32 s98, 139264
    s_cselect_b32 s98, 0, s98
    v_mfma_f32_16x16x32_bf16 v[44:47], a[192:195], a[228:231], 0
    s_sub_u32 s100, s98, s99
    s_waitcnt lgkmcnt(0)
    s_waitcnt vmcnt(20)
    v_mfma_f32_16x16x32_bf16 v[52:55], a[192:195], a[232:235], 0
    s_barrier
    s_add_u32 m0, s41, s99
    v_mfma_f32_16x16x32_bf16 v[60:63], a[192:195], a[236:239], 0
    buffer_load_dwordx4 v17, s[16:19], s45 offen offset:0 lds
    v_mfma_f32_16x16x32_bf16 v[68:71], a[192:195], a[240:243], 0
    v_add_u32 v24, s100, v24
    v_add_u32 v25, s100, v25
    v_mfma_f32_16x16x32_bf16 v[76:79], a[192:195], a[244:247], 0
    buffer_load_dwordx4 v18, s[16:19], s45 offen offset:1088 lds
    v_mfma_f32_16x16x32_bf16 v[40:43], a[196:199], a[224:227], 0
    v_add_u32 v26, s100, v26
    v_add_u32 v27, s100, v27
    v_mfma_f32_16x16x32_bf16 v[48:51], a[196:199], a[228:231], 0
    ds_read_b128 a[32:35], v29 offset:0
    ds_read_b128 a[36:39], v29 offset:2048
    v_mfma_f32_16x16x32_bf16 v[56:59], a[196:199], a[232:235], 0
    ds_read_b128 a[40:43], v29 offset:4096
    ds_read_b128 a[44:47], v29 offset:6144
    v_mfma_f32_16x16x32_bf16 v[64:67], a[196:199], a[236:239], 0
    ds_read_b128 a[48:51], v29 offset:8192
    ds_read_b128 a[52:55], v29 offset:10240
    v_mfma_f32_16x16x32_bf16 v[72:75], a[196:199], a[240:243], 0
    buffer_load_dwordx4 v19, s[16:19], s45 offen offset:2176 lds
    v_mfma_f32_16x16x32_bf16 v[80:83], a[196:199], a[244:247], 0
    ds_read_b64_tr_b16 a[0:1], v24 offset:0
    ds_read_b64_tr_b16 a[2:3], v24 offset:1088
    v_mfma_f32_16x16x32_bf16 v[84:87], a[200:203], a[224:227], 0
    ds_read_b64_tr_b16 a[4:5], v25 offset:0
    ds_read_b64_tr_b16 a[6:7], v25 offset:1088
    v_mfma_f32_16x16x32_bf16 v[92:95], a[200:203], a[228:231], 0
    ds_read_b64_tr_b16 a[8:9], v26 offset:0
    ds_read_b64_tr_b16 a[10:11], v26 offset:1088
    v_mfma_f32_16x16x32_bf16 v[100:103], a[200:203], a[232:235], 0
    ds_read_b64_tr_b16 a[12:13], v27 offset:0
    ds_read_b64_tr_b16 a[14:15], v27 offset:1088
    v_mfma_f32_16x16x32_bf16 v[108:111], a[200:203], a[236:239], 0
    ds_read_b64_tr_b16 a[16:17], v24 offset:128
    ds_read_b64_tr_b16 a[18:19], v24 offset:1216
    v_mfma_f32_16x16x32_bf16 v[116:119], a[200:203], a[240:243], 0
    buffer_load_dwordx4 v20, s[16:19], s45 offen offset:3264 lds
    v_mfma_f32_16x16x32_bf16 v[124:127], a[200:203], a[244:247], 0
    ds_read_b64_tr_b16 a[20:21], v25 offset:128
    ds_read_b64_tr_b16 a[22:23], v25 offset:1216
    v_mfma_f32_16x16x32_bf16 v[88:91], a[204:207], a[224:227], 0
    ds_read_b64_tr_b16 a[24:25], v26 offset:128
    ds_read_b64_tr_b16 a[26:27], v26 offset:1216
    v_mfma_f32_16x16x32_bf16 v[96:99], a[204:207], a[228:231], 0
    ds_read_b64_tr_b16 a[28:29], v27 offset:128
    ds_read_b64_tr_b16 a[30:31], v27 offset:1216
    v_mfma_f32_16x16x32_bf16 v[104:107], a[204:207], a[232:235], 0
    s_add_u32 s46, s45, 131072
    s_add_u32 m0, s42, s99
    v_mfma_f32_16x16x32_bf16 v[112:115], a[204:207], a[236:239], 0
    buffer_load_dwordx4 v17, s[16:19], s46 offen offset:0 lds
    v_mfma_f32_16x16x32_bf16 v[120:123], a[204:207], a[240:243], 0
    s_add_u32 s45, s45, 262144
    s_cmp_ge_u32 s45, 4718592
    v_mfma_f32_16x16x32_bf16 v[128:131], a[204:207], a[244:247], 0
    v_mfma_f32_16x16x32_bf16 v[132:135], a[208:211], a[224:227], 0
    v_mfma_f32_16x16x32_bf16 v[140:143], a[208:211], a[228:231], 0
    v_mfma_f32_16x16x32_bf16 v[148:151], a[208:211], a[232:235], 0
    buffer_load_dwordx4 v18, s[16:19], s46 offen offset:1088 lds
    v_mfma_f32_16x16x32_bf16 v[156:159], a[208:211], a[236:239], 0
    v_mfma_f32_16x16x32_bf16 v[164:167], a[208:211], a[240:243], 0
    v_mfma_f32_16x16x32_bf16 v[172:175], a[208:211], a[244:247], 0
    v_mfma_f32_16x16x32_bf16 v[136:139], a[212:215], a[224:227], 0
    v_mfma_f32_16x16x32_bf16 v[144:147], a[212:215], a[228:231], 0
    v_mfma_f32_16x16x32_bf16 v[152:155], a[212:215], a[232:235], 0
    buffer_load_dwordx4 v19, s[16:19], s46 offen offset:2176 lds
    v_mfma_f32_16x16x32_bf16 v[160:163], a[212:215], a[236:239], 0
    v_mfma_f32_16x16x32_bf16 v[168:171], a[212:215], a[240:243], 0
    v_mfma_f32_16x16x32_bf16 v[176:179], a[212:215], a[244:247], 0
    v_mfma_f32_16x16x32_bf16 v[180:183], a[216:219], a[224:227], 0
    v_mfma_f32_16x16x32_bf16 v[188:191], a[216:219], a[228:231], 0
    buffer_load_dwordx4 v20, s[16:19], s46 offen offset:3264 lds
    v_mfma_f32_16x16x32_bf16 v[196:199], a[216:219], a[232:235], 0
    s_cselect_b32 s46, 4718592, 0
    s_sub_u32 s45, s45, s46
    v_mfma_f32_16x16x32_bf16 v[204:207], a[216:219], a[236:239], 0
    v_mfma_f32_16x16x32_bf16 v[212:215], a[216:219], a[240:243], 0
    v_mfma_f32_16x16x32_bf16 v[220:223], a[216:219], a[244:247], 0
    v_mfma_f32_16x16x32_bf16 v[184:187], a[220:223], a[224:227], 0
    v_mfma_f32_16x16x32_bf16 v[192:195], a[220:223], a[228:231], 0
    v_mfma_f32_16x16x32_bf16 v[200:203], a[220:223], a[232:235], 0
    v_mfma_f32_16x16x32_bf16 v[208:211], a[220:223], a[236:239], 0
    v_mfma_f32_16x16x32_bf16 v[216:219], a[220:223], a[240:243], 0
    v_mfma_f32_16x16x32_bf16 v[224:227], a[220:223], a[244:247], 0
    s_mov_b32 s99, s98
    s_add_u32 s98, s98, 34816
    s_waitcnt lgkmcnt(14)
    v_mfma_f32_16x16x32_bf16 v[36:39], a[0:3], a[32:35], v[36:39]
    s_cmp_eq_u32 s98, 139264
    s_cselect_b32 s98, 0, s98
    v_mfma_f32_16x16x32_bf16 v[44:47], a[0:3], a[36:39], v[44:47]
    s_sub_u32 s100, s98, s99
    s_waitcnt lgkmcnt(0)
    s_waitcnt vmcnt(17)
    v_mfma_f32_16x16x32_bf16 v[52:55], a[0:3], a[40:43], v[52:55]
    s_barrier
    s_mov_b32 m0, s94
    v_mfma_f32_16x16x32_bf16 v[60:63], a[0:3], a[44:47], v[60:63]
    buffer_load_dwordx4 v21, s[4:7], s47 offen offset:0 lds
    v_mfma_f32_16x16x32_bf16 v[68:71], a[0:3], a[48:51], v[68:71]
    buffer_load_dwordx4 v22, s[4:7], s47 offen offset:1024 lds
    v_mfma_f32_16x16x32_bf16 v[76:79], a[0:3], a[52:55], v[76:79]
    v_add_u32 v24, s100, v24
    v_add_u32 v25, s100, v25
    v_mfma_f32_16x16x32_bf16 v[40:43], a[4:7], a[32:35], v[40:43]
    v_add_u32 v26, s100, v26
    v_add_u32 v27, s100, v27
    v_mfma_f32_16x16x32_bf16 v[48:51], a[4:7], a[36:39], v[48:51]
    buffer_load_dwordx4 v23, s[4:7], s47 offen offset:2048 lds
    v_mfma_f32_16x16x32_bf16 v[56:59], a[4:7], a[40:43], v[56:59]
    v_add_u32 v28, s101, v28
    ds_read_b128 a[224:227], v28 offset:0
    v_mfma_f32_16x16x32_bf16 v[64:67], a[4:7], a[44:47], v[64:67]
    ds_read_b128 a[228:231], v28 offset:2048
    ds_read_b128 a[232:235], v28 offset:4096
    v_mfma_f32_16x16x32_bf16 v[72:75], a[4:7], a[48:51], v[72:75]
    s_add_u32 s47, s47, 128
    s_sub_u32 s94, s93, s94
    v_mfma_f32_16x16x32_bf16 v[80:83], a[4:7], a[52:55], v[80:83]
    s_cmp_eq_u32 s47, 1152
    s_cselect_b32 s47, 0, s47
    v_mfma_f32_16x16x32_bf16 v[84:87], a[8:11], a[32:35], v[84:87]
    s_add_u32 m0, s41, s99
    ds_read_b128 a[236:239], v28 offset:6144
    v_mfma_f32_16x16x32_bf16 v[92:95], a[8:11], a[36:39], v[92:95]
    buffer_load_dwordx4 v17, s[16:19], s45 offen offset:0 lds
    v_mfma_f32_16x16x32_bf16 v[100:103], a[8:11], a[40:43], v[100:103]
    ds_read_b128 a[240:243], v28 offset:8192
    ds_read_b128 a[244:247], v28 offset:10240
    v_mfma_f32_16x16x32_bf16 v[108:111], a[8:11], a[44:47], v[108:111]
    buffer_load_dwordx4 v18, s[16:19], s45 offen offset:1088 lds
    v_mfma_f32_16x16x32_bf16 v[116:119], a[8:11], a[48:51], v[116:119]
    ds_read_b64_tr_b16 a[192:193], v24 offset:0
    ds_read_b64_tr_b16 a[194:195], v24 offset:1088
    v_mfma_f32_16x16x32_bf16 v[124:127], a[8:11], a[52:55], v[124:127]
    ds_read_b64_tr_b16 a[196:197], v25 offset:0
    ds_read_b64_tr_b16 a[198:199], v25 offset:1088
    v_mfma_f32_16x16x32_bf16 v[88:91], a[12:15], a[32:35], v[88:91]
    ds_read_b64_tr_b16 a[200:201], v26 offset:0
    ds_read_b64_tr_b16 a[202:203], v26 offset:1088
    v_mfma_f32_16x16x32_bf16 v[96:99], a[12:15], a[36:39], v[96:99]
    buffer_load_dwordx4 v19, s[16:19], s45 offen offset:2176 lds
    v_mfma_f32_16x16x32_bf16 v[104:107], a[12:15], a[40:43], v[104:107]
    ds_read_b64_tr_b16 a[204:205], v27 offset:0
    ds_read_b64_tr_b16 a[206:207], v27 offset:1088
    v_mfma_f32_16x16x32_bf16 v[112:115], a[12:15], a[44:47], v[112:115]
    ds_read_b64_tr_b16 a[208:209], v24 offset:128
    ds_read_b64_tr_b16 a[210:211], v24 offset:1216
    v_mfma_f32_16x16x32_bf16 v[120:123], a[12:15], a[48:51], v[120:123]
    ds_read_b64_tr_b16 a[212:213], v25 offset:128
    ds_read_b64_tr_b16 a[214:215], v25 offset:1216
    v_mfma_f32_16x16x32_bf16 v[128:131], a[12:15], a[52:55], v[128:131]
    buffer_load_dwordx4 v20, s[16:19], s45 offen offset:3264 lds
    v_mfma_f32_16x16x32_bf16 v[132:135], a[16:19], a[32:35], v[132:135]
    ds_read_b64_tr_b16 a[216:217], v26 offset:128
    ds_read_b64_tr_b16 a[218:219], v26 offset:1216
    v_mfma_f32_16x16x32_bf16 v[140:143], a[16:19], a[36:39], v[140:143]
    ds_read_b64_tr_b16 a[220:221], v27 offset:128
    ds_read_b64_tr_b16 a[222:223], v27 offset:1216
    v_mfma_f32_16x16x32_bf16 v[148:151], a[16:19], a[40:43], v[148:151]
    s_add_u32 s46, s45, 131072
    s_add_u32 m0, s42, s99
    v_mfma_f32_16x16x32_bf16 v[156:159], a[16:19], a[44:47], v[156:159]
    buffer_load_dwordx4 v17, s[16:19], s46 offen offset:0 lds
    v_mfma_f32_16x16x32_bf16 v[164:167], a[16:19], a[48:51], v[164:167]
    s_add_u32 s45, s45, 262144
    s_cmp_ge_u32 s45, 4718592
    v_mfma_f32_16x16x32_bf16 v[172:175], a[16:19], a[52:55], v[172:175]
    v_mfma_f32_16x16x32_bf16 v[136:139], a[20:23], a[32:35], v[136:139]
    v_mfma_f32_16x16x32_bf16 v[144:147], a[20:23], a[36:39], v[144:147]
    buffer_load_dwordx4 v18, s[16:19], s46 offen offset:1088 lds
    v_mfma_f32_16x16x32_bf16 v[152:155], a[20:23], a[40:43], v[152:155]
    v_mfma_f32_16x16x32_bf16 v[160:163], a[20:23], a[44:47], v[160:163]
    v_mfma_f32_16x16x32_bf16 v[168:171], a[20:23], a[48:51], v[168:171]
    v_mfma_f32_16x16x32_bf16 v[176:179], a[20:23], a[52:55], v[176:179]
    buffer_load_dwordx4 v19, s[16:19], s46 offen offset:2176 lds
    v_mfma_f32_16x16x32_bf16 v[180:183], a[24:27], a[32:35], v[180:183]
    v_mfma_f32_16x16x32_bf16 v[188:191], a[24:27], a[36:39], v[188:191]
    v_mfma_f32_16x16x32_bf16 v[196:199], a[24:27], a[40:43], v[196:199]
    v_mfma_f32_16x16x32_bf16 v[204:207], a[24:27], a[44:47], v[204:207]
    buffer_load_dwordx4 v20, s[16:19], s46 offen offset:3264 lds
    v_mfma_f32_16x16x32_bf16 v[212:215], a[24:27], a[48:51], v[212:215]
    s_cselect_b32 s46, 4718592, 0
    s_sub_u32 s45, s45, s46
    v_mfma_f32_16x16x32_bf16 v[220:223], a[24:27], a[52:55], v[220:223]
    v_mfma_f32_16x16x32_bf16 v[184:187], a[28:31], a[32:35], v[184:187]
    v_mfma_f32_16x16x32_bf16 v[192:195], a[28:31], a[36:39], v[192:195]
    v_mfma_f32_16x16x32_bf16 v[200:203], a[28:31], a[40:43], v[200:203]
    v_mfma_f32_16x16x32_bf16 v[208:211], a[28:31], a[44:47], v[208:211]
    v_mfma_f32_16x16x32_bf16 v[216:219], a[28:31], a[48:51], v[216:219]
    v_mfma_f32_16x16x32_bf16 v[224:227], a[28:31], a[52:55], v[224:227]
    s_mov_b32 s40, 6
L_qp:
    s_mov_b32 s99, s98
    s_add_u32 s98, s98, 34816
    s_waitcnt lgkmcnt(14)
    v_mfma_f32_16x16x32_bf16 v[36:39], a[192:195], a[224:227], v[36:39]
    s_cmp_eq_u32 s98, 139264
    s_cselect_b32 s98, 0, s98
    v_mfma_f32_16x16x32_bf16 v[44:47], a[192:195], a[228:231], v[44:47]
    s_sub_u32 s100, s98, s99
    s_waitcnt lgkmcnt(0)
    s_waitcnt vmcnt(19)
    v_mfma_f32_16x16x32_bf16 v[52:55], a[192:195], a[232:235], v[52:55]
    s_barrier
    s_add_u32 m0, s41, s99
    v_mfma_f32_16x16x32_bf16 v[60:63], a[192:195], a[236:239], v[60:63]
    buffer_load_dwordx4 v17, s[16:19], s45 offen offset:0 lds
    v_mfma_f32_16x16x32_bf16 v[68:71], a[192:195], a[240:243], v[68:71]
    v_add_u32 v24, s100, v24
    v_add_u32 v25, s100, v25
    v_mfma_f32_16x16x32_bf16 v[76:79], a[192:195], a[244:247], v[76:79]
    buffer_load_dwordx4 v18, s[16:19], s45 offen offset:1088 lds
    v_mfma_f32_16x16x32_bf16 v[40:43], a[196:199], a[224:227], v[40:43]
    v_add_u32 v26, s100, v26
    v_add_u32 v27, s100, v27
    v_mfma_f32_16x16x32_bf16 v[48:51], a[196:199], a[228:231], v[48:51]
    v_add_u32 v29, s101, v29
    ds_read_b128 a[32:35], v29 offset:0
    v_mfma_f32_16x16x32_bf16 v[56:59], a[196:199], a[232:235], v[56:59]
    ds_read_b128 a[36:39], v29 offset:2048
    ds_read_b128 a[40:43], v29 offset:4096
    v_mfma_f32_16x16x32_bf16 v[64:67], a[196:199], a[236:239], v[64:67]
    ds_read_b128 a[44:47], v29 offset:6144
    ds_read_b128 a[48:51], v29 offset:8192
    v_mfma_f32_16x16x32_bf16 v[72:75], a[196:199], a[240:243], v[72:75]
    buffer_load_dwordx4 v19, s[16:19], s45 offen offset:2176 lds
    v_mfma_f32_16x16x32_bf16 v[80:83], a[196:199], a[244:247], v[80:83]
    ds_read_b128 a[52:55], v29 offset:10240
    ds_read_b64_tr_b16 a[0:1], v24 offset:0
    v_mfma_f32_16x16x32_bf16 v[84:87], a[200:203], a[224:227], v[84:87]
    ds_read_b64_tr_b16 a[2:3], v24 offset:1088
    ds_read_b64_tr_b16 a[4:5], v25 offset:0
    v_mfma_f32_16x16x32_bf16 v[92:95], a[200:203], a[228:231], v[92:95]
    ds_read_b64_tr_b16 a[6:7], v25 offset:1088
    ds_read_b64_tr_b16 a[8:9], v26 offset:0
    v_mfma_f32_16x16x32_bf16 v[100:103], a[200:203], a[232:235], v[100:103]
    ds_read_b64_tr_b16 a[10:11], v26 offset:1088
    ds_read_b64_tr_b16 a[12:13], v27 offset:0
    v_mfma_f32_16x16x32_bf16 v[108:111], a[200:203], a[236:239], v[108:111]
    ds_read_b64_tr_b16 a[14:15], v27 offset:1088
    ds_read_b64_tr_b16 a[16:17], v24 offset:128
    v_mfma_f32_16x16x32_bf16 v[116:119], a[200:203], a[240:243], v[116:119]
    buffer_load_dwordx4 v20, s[16:19], s45 offen offset:3264 lds
    v_mfma_f32_16x16x32_bf16 v[124:127], a[200:203], a[244:247], v[124:127]
    ds_read_b64_tr_b16 a[18:19], v24 offset:1216
    ds_read_b64_tr_b16 a[20:21], v25 offset:128
    v_mfma_f32_16x16x32_bf16 v[88:91], a[204:207], a[224:227], v[88:91]
    ds_read_b64_tr_b16 a[22:23], v25 offset:1216
    ds_read_b64_tr_b16 a[24:25], v26 offset:128
    v_mfma_f32_16x16x32_bf16 v[96:99], a[204:207], a[228:231], v[96:99]
    ds_read_b64_tr_b16 a[26:27], v26 offset:1216
    ds_read_b64_tr_b16 a[28:29], v27 offset:128
    v_mfma_f32_16x16x32_bf16 v[104:107], a[204:207], a[232:235], v[104:107]
    s_add_u32 s46, s45, 131072
    s_add_u32 m0, s42, s99
    v_mfma_f32_16x16x32_bf16 v[112:115], a[204:207], a[236:239], v[112:115]
    buffer_load_dwordx4 v17, s[16:19], s46 offen offset:0 lds
    v_mfma_f32_16x16x32_bf16 v[120:123], a[204:207], a[240:243], v[120:123]
    s_add_u32 s45, s45, 262144
    s_cmp_ge_u32 s45, 4718592
    v_mfma_f32_16x16x32_bf16 v[128:131], a[204:207], a[244:247], v[128:131]
    ds_read_b64_tr_b16 a[30:31], v27 offset:1216
    v_mfma_f32_16x16x32_bf16 v[132:135], a[208:211], a[224:227], v[132:135]
    v_mfma_f32_16x16x32_bf16 v[140:143], a[208:211], a[228:231], v[140:143]
    v_mfma_f32_16x16x32_bf16 v[148:151], a[208:211], a[232:235], v[148:151]
    buffer_load_dwordx4 v18, s[16:19], s46 offen offset:1088 lds
    v_mfma_f32_16x16x32_bf16 v[156:159], a[208:211], a[236:239], v[156:159]
    v_mfma_f32_16x16x32_bf16 v[164:167], a[208:211], a[240:243], v[164:167]
    v_mfma_f32_16x16x32_bf16 v[172:175], a[208:211], a[244:247], v[172:175]
    v_mfma_f32_16x16x32_bf16 v[136:139], a[212:215], a[224:227], v[136:139]
    v_mfma_f32_16x16x32_bf16 v[144:147], a[212:215], a[228:231], v[144:147]
    v_mfma_f32_16x16x32_bf16 v[152:155], a[212:215], a[232:235], v[152:155]
    buffer_load_dwordx4 v19, s[16:19], s46 offen offset:2176 lds
    v_mfma_f32_16x16x32_bf16 v[160:163], a[212:215], a[236:239], v[160:163]
    v_mfma_f32_16x16x32_bf16 v[168:171], a[212:215], a[240:243], v[168:171]
    v_mfma_f32_16x16x32_bf16 v[176:179], a[212:215], a[244:247], v[176:179]
    v_mfma_f32_16x16x32_bf16 v[180:183], a[216:219], a[224:227], v[180:183]
    v_mfma_f32_16x16x32_bf16 v[188:191], a[216:219], a[228:231], v[188:191]
    buffer_load_dwordx4 v20, s[16:19], s46 offen offset:3264 lds
    v_mfma_f32_16x16x32_bf16 v[196:199], a[216:219], a[232:235], v[196:199]
    s_cselect_b32 s46, 4718592, 0
    s_sub_u32 s45, s45, s46
    v_mfma_f32_16x16x32_bf16 v[204:207], a[216:219], a[236:239], v[204:207]
    s_sub_u32 s101, 0, s101
    v_mfma_f32_16x16x32_bf16 v[212:215], a[216:219], a[240:243], v[212:215]
    v_mfma_f32_16x16x32_bf16 v[220:223], a[216:219], a[244:247], v[220:223]
    v_mfma_f32_16x16x32_bf16 v[184:187], a[220:223], a[224:227], v[184:187]
    v_mfma_f32_16x16x32_bf16 v[192:195], a[220:223], a[228:231], v[192:195]
    v_mfma_f32_16x16x32_bf16 v[200:203], a[220:223], a[232:235], v[200:203]
    v_mfma_f32_16x16x32_bf16 v[208:211], a[220:223], a[236:239], v[208:211]
    v_mfma_f32_16x16x32_bf16 v[216:219], a[220:223], a[240:243], v[216:219]
    v_mfma_f32_16x16x32_bf16 v[224:227], a[220:223], a[244:247], v[224:227]
    s_mov_b32 s99, s98
    s_add_u32 s98, s98, 34816
    s_waitcnt lgkmcnt(14)
    v_mfma_f32_16x16x32_bf16 v[36:39], a[0:3], a[32:35], v[36:39]
    s_cmp_eq_u32 s98, 139264
    s_cselect_b32 s98, 0, s98
    v_mfma_f32_16x16x32_bf16 v[44:47], a[0:3], a[36:39], v[44:47]
    s_sub_u32 s100, s98, s99
    s_waitcnt lgkmcnt(0)
    s_waitcnt vmcnt(16)
    v_mfma_f32_16x16x32_bf16 v[52:55], a[0:3], a[40:43], v[52:55]
    s_barrier
    s_mov_b32 m0, s94
    v_mfma_f32_16x16x32_bf16 v[60:63], a[0:3], a[44:47], v[60:63]
    buffer_load_dwordx4 v21, s[4:7], s47 offen offset:0 lds
    v_mfma_f32_16x16x32_bf16 v[68:71], a[0:3], a[48:51], v[68:71]
    buffer_load_dwordx4 v22, s[4:7], s47 offen offset:1024 lds
    v_mfma_f32_16x16x32_bf16 v[76:79], a[0:3], a[52:55], v[76:79]
    v_add_u32 v24, s100, v24
    v_add_u32 v25, s100, v25
    v_mfma_f32_16x16x32_bf16 v[40:43], a[4:7], a[32:35], v[40:43]
    v_add_u32 v26, s100, v26
    v_add_u32 v27, s100, v27
    v_mfma_f32_16x16x32_bf16 v[48:51], a[4:7], a[36:39], v[48:51]
    buffer_load_dwordx4 v23, s[4:7], s47 offen offset:2048 lds
    v_mfma_f32_16x16x32_bf16 v[56:59], a[4:7], a[40:43], v[56:59]
    v_add_u32 v28, s101, v28
    ds_read_b128 a[224:227], v28 offset:0
    v_mfma_f32_16x16x32_bf16 v[64:67], a[4:7], a[44:47], v[64:67]
    ds_read_b128 a[228:231], v28 offset:2048
    ds_read_b128 a[232:235], v28 offset:4096
    v_mfma_f32_16x16x32_bf16 v[72:75], a[4:7], a[48:51], v[72:75]
    s_add_u32 s47, s47, 128
    s_sub_u32 s94, s93, s94
    v_mfma_f32_16x16x32_bf16 v[80:83], a[4:7], a[52:55], v[80:83]
    s_cmp_eq_u32 s47, 1152
    s_cselect_b32 s47, 0, s47
    v_mfma_f32_16x16x32_bf16 v[84:87], a[8:11], a[32:35], v[84:87]
    s_add_u32 m0, s41, s99
    ds_read_b128 a[236:239], v28 offset:6144
    v_mfma_f32_16x16x32_bf16 v[92:95], a[8:11], a[36:39], v[92:95]
    buffer_load_dwordx4 v17, s[16:19], s45 offen offset:0 lds
    v_mfma_f32_16x16x32_bf16 v[100:103], a[8:11], a[40:43], v[100:103]
    ds_read_b128 a[240:243], v28 offset:8192
    ds_read_b128 a[244:247], v28 offset:10240
    v_mfma_f32_16x16x32_bf16 v[108:111], a[8:11], a[44:47], v[108:111]
    buffer_load_dwordx4 v18, s[16:19], s45 offen offset:1088 lds
    v_mfma_f32_16x16x32_bf16 v[116:119], a[8:11], a[48:51], v[116:119]
    ds_read_b64_tr_b16 a[192:193], v24 offset:0
    ds_read_b64_tr_b16 a[194:195], v24 offset:1088
    v_mfma_f32_16x16x32_bf16 v[124:127], a[8:11], a[52:55], v[124:127]
    ds_read_b64_tr_b16 a[196:197], v25 offset:0
    ds_read_b64_tr_b16 a[198:199], v25 offset:1088
    v_mfma_f32_16x16x32_bf16 v[88:91], a[12:15], a[32:35], v[88:91]
    ds_read_b64_tr_b16 a[200:201], v26 offset:0
    ds_read_b64_tr_b16 a[202:203], v26 offset:1088
    v_mfma_f32_16x16x32_bf16 v[96:99], a[12:15], a[36:39], v[96:99]
    buffer_load_dwordx4 v19, s[16:19], s45 offen offset:2176 lds
    v_mfma_f32_16x16x32_bf16 v[104:107], a[12:15], a[40:43], v[104:107]
    ds_read_b64_tr_b16 a[204:205], v27 offset:0
    ds_read_b64_tr_b16 a[206:207], v27 offset:1088
    v_mfma_f32_16x16x32_bf16 v[112:115], a[12:15], a[44:47], v[112:115]
    ds_read_b64_tr_b16 a[208:209], v24 offset:128
    ds_read_b64_tr_b16 a[210:211], v24 offset:1216
    v_mfma_f32_16x16x32_bf16 v[120:123], a[12:15], a[48:51], v[120:123]
    ds_read_b64_tr_b16 a[212:213], v25 offset:128
    ds_read_b64_tr_b16 a[214:215], v25 offset:1216
    v_mfma_f32_16x16x32_bf16 v[128:131], a[12:15], a[52:55], v[128:131]
    buffer_load_dwordx4 v20, s[16:19], s45 offen offset:3264 lds
    v_mfma_f32_16x16x32_bf16 v[132:135], a[16:19], a[32:35], v[132:135]
    ds_read_b64_tr_b16 a[216:217], v26 offset:128
    ds_read_b64_tr_b16 a[218:219], v26 offset:1216
    v_mfma_f32_16x16x32_bf16 v[140:143], a[16:19], a[36:39], v[140:143]
    ds_read_b64_tr_b16 a[220:221], v27 offset:128
    ds_read_b64_tr_b16 a[222:223], v27 offset:1216
    v_mfma_f32_16x16x32_bf16 v[148:151], a[16:19], a[40:43], v[148:151]
    s_add_u32 s46, s45, 131072
    s_add_u32 m0, s42, s99
    v_mfma_f32_16x16x32_bf16 v[156:159], a[16:19], a[44:47], v[156:159]
    buffer_load_dwordx4 v17, s[16:19], s46 offen offset:0 lds
    v_mfma_f32_16x16x32_bf16 v[164:167], a[16:19], a[48:51], v[164:167]
    s_add_u32 s45, s45, 262144
    s_cmp_ge_u32 s45, 4718592
    v_mfma_f32_16x16x32_bf16 v[172:175], a[16:19], a[52:55], v[172:175]
    v_mfma_f32_16x16x32_bf16 v[136:139], a[20:23], a[32:35], v[136:139]
    v_mfma_f32_16x16x32_bf16 v[144:147], a[20:23], a[36:39], v[144:147]
    buffer_load_dwordx4 v18, s[16:19], s46 offen offset:1088 lds
    v_mfma_f32_16x16x32_bf16 v[152:155], a[20:23], a[40:43], v[152:155]
    v_mfma_f32_16x16x32_bf16 v[160:163], a[20:23], a[44:47], v[160:163]
    v_mfma_f32_16x16x32_bf16 v[168:171], a[20:23], a[48:51], v[168:171]
    v_mfma_f32_16x16x32_bf16 v[176:179], a[20:23], a[52:55], v[176:179]
    buffer_load_dwordx4 v19, s[16:19], s46 offen offset:2176 lds
    v_mfma_f32_16x16x32_bf16 v[180:183], a[24:27], a[32:35], v[180:183]
    v_mfma_f32_16x16x32_bf16 v[188:191], a[24:27], a[36:39], v[188:191]
    v_mfma_f32_16x16x32_bf16 v[196:199], a[24:27], a[40:43], v[196:199]
    v_mfma_f32_16x16x32_bf16 v[204:207], a[24:27], a[44:47], v[204:207]
    buffer_load_dwordx4 v20, s[16:19], s46 offen offset:3264 lds
    v_mfma_f32_16x16x32_bf16 v[212:215], a[24:27], a[48:51], v[212:215]
    s_cselect_b32 s46, 4718592, 0
    s_sub_u32 s45, s45, s46
    v_mfma_f32_16x16x32_bf16 v[220:223], a[24:27], a[52:55], v[220:223]
    v_mfma_f32_16x16x32_bf16 v[184:187], a[28:31], a[32:35], v[184:187]
    v_mfma_f32_16x16x32_bf16 v[192:195], a[28:31], a[36:39], v[192:195]
    v_mfma_f32_16x16x32_bf16 v[200:203], a[28:31], a[40:43], v[200:203]
    v_mfma_f32_16x16x32_bf16 v[208:211], a[28:31], a[44:47], v[208:211]
    v_mfma_f32_16x16x32_bf16 v[216:219], a[28:31], a[48:51], v[216:219]
    v_mfma_f32_16x16x32_bf16 v[224:227], a[28:31], a[52:55], v[224:227]
    s_sub_u32 s40, s40, 1
    s_cmp_lg_u32 s40, 0
    s_cbranch_scc1 L_qp
    s_mov_b32 s99, s98
    s_add_u32 s98, s98, 34816
    s_waitcnt lgkmcnt(14)
    v_mfma_f32_16x16x32_bf16 v[36:39], a[192:195], a[224:227], v[36:39]
    s_cmp_eq_u32 s98, 139264
    s_cselect_b32 s98, 0, s98
    v_mfma_f32_16x16x32_bf16 v[44:47], a[192:195], a[228:231], v[44:47]
    s_sub_u32 s100, s98, s99
    s_waitcnt lgkmcnt(0)
    s_waitcnt vmcnt(19)
    v_mfma_f32_16x16x32_bf16 v[52:55], a[192:195], a[232:235], v[52:55]
    s_barrier
    s_add_u32 s8, s64, s60
    v_mfma_f32_16x16x32_bf16 v[60:63], a[192:195], a[236:239], v[60:63]
    s_addc_u32 s9, s65, 0
    s_sub_u32 s8, s8, 256
    v_mfma_f32_16x16x32_bf16 v[68:71], a[192:195], a[240:243], v[68:71]
    s_subb_u32 s9, s9, 0
    s_and_b32 s9, s9, 0xffff
    v_mfma_f32_16x16x32_bf16 v[76:79], a[192:195], a[244:247], v[76:79]
    s_mov_b32 s10, 131328
    s_mov_b32 s11, 0x20000
    v_mfma_f32_16x16x32_bf16 v[40:43], a[196:199], a[224:227], v[40:43]
    s_add_u32 s12, s66, s60
    s_addc_u32 s13, s67, 0
    v_mfma_f32_16x16x32_bf16 v[48:51], a[196:199], a[228:231], v[48:51]
    s_sub_u32 s12, s12, 1280
    s_subb_u32 s13, s13, 0
    v_mfma_f32_16x16x32_bf16 v[56:59], a[196:199], a[232:235], v[56:59]
    s_and_b32 s13, s13, 0xffff
    s_mov_b32 s14, 132352
    v_mfma_f32_16x16x32_bf16 v[64:67], a[196:199], a[236:239], v[64:67]
    s_mov_b32 s15, 0x20000
    s_mov_b32 s96, 8192
    v_mfma_f32_16x16x32_bf16 v[72:75], a[196:199], a[240:243], v[72:75]
    s_lshr_b32 s53, s36, 1
    s_mul_i32 s53, s53, 17408
    v_mfma_f32_16x16x32_bf16 v[80:83], a[196:199], a[244:247], v[80:83]
    s_and_b32 s43, s36, 1
    s_mul_i32 s43, s43, 4352
    v_mfma_f32_16x16x32_bf16 v[84:87], a[200:203], a[224:227], v[84:87]
    s_add_u32 s43, s43, s53
    s_add_u32 s44, s43, 8704
    v_mfma_f32_16x16x32_bf16 v[92:95], a[200:203], a[228:231], v[92:95]
    v_lshrrev_b32 v1, 4, v0
    v_and_b32 v2, 15, v0
    v_mfma_f32_16x16x32_bf16 v[100:103], a[200:203], a[232:235], v[100:103]
    v_xor_b32 v3, v1, v2
    v_lshlrev_b32 v3, 4, v3
    v_mfma_f32_16x16x32_bf16 v[108:111], a[200:203], a[236:239], v[108:111]
    v_lshl_add_u32 v12, v1, 8, v3
    v_add_u32 v9, 256, v12
    v_mfma_f32_16x16x32_bf16 v[116:119], a[200:203], a[240:243], v[116:119]
    v_add_u32 v10, 192, v12
    v_add_u32 v11, 128, v12
    v_mfma_f32_16x16x32_bf16 v[124:127], a[200:203], a[244:247], v[124:127]
    v_add_u32 v12, 64, v12
    v_lshlrev_b32 v3, 1, v1
    v_mfma_f32_16x16x32_bf16 v[88:91], a[204:207], a[224:227], v[88:91]
    v_xor_b32 v3, v3, v2
    v_lshlrev_b32 v3, 4, v3
    v_mfma_f32_16x16x32_bf16 v[96:99], a[204:207], a[228:231], v[96:99]
    v_lshl_add_u32 v16, v1, 8, v3
    v_add_u32 v13, 1280, v16
    v_mfma_f32_16x16x32_bf16 v[104:107], a[204:207], a[232:235], v[104:107]
    v_add_u32 v14, 2240, v16
    v_add_u32 v15, 128, v16
    v_mfma_f32_16x16x32_bf16 v[112:115], a[204:207], a[236:239], v[112:115]
    v_add_u32 v16, 1088, v16
    s_and_b32 s48, s36, 1
    v_mfma_f32_16x16x32_bf16 v[120:123], a[204:207], a[240:243], v[120:123]
    s_lshl_b32 s48, s48, 12
    s_mov_b32 s49, s48
    v_mfma_f32_16x16x32_bf16 v[128:131], a[204:207], a[244:247], v[128:131]
    s_add_u32 m0, s43, s99
    v_add_u32 v24, s100, v24
    v_mfma_f32_16x16x32_bf16 v[132:135], a[208:211], a[224:227], v[132:135]
    buffer_load_dwordx4 v9, s[8:11], s48 offen offset:0 nt lds
    v_mfma_f32_16x16x32_bf16 v[140:143], a[208:211], a[228:231], v[140:143]
    buffer_load_dwordx4 v10, s[8:11], s48 offen offset:1088 nt lds
    v_mfma_f32_16x16x32_bf16 v[148:151], a[208:211], a[232:235], v[148:151]
    buffer_load_dwordx4 v11, s[8:11], s48 offen offset:2176 nt lds
    v_mfma_f32_16x16x32_bf16 v[156:159], a[208:211], a[236:239], v[156:159]
    v_add_u32 v25, s100, v25
    v_add_u32 v26, s100, v26
    v_mfma_f32_16x16x32_bf16 v[164:167], a[208:211], a[240:243], v[164:167]
    v_add_u32 v27, s100, v27
    v_add_u32 v29, s101, v29
    v_mfma_f32_16x16x32_bf16 v[172:175], a[208:211], a[244:247], v[172:175]
    ds_read_b128 a[32:35], v29 offset:0
    ds_read_b128 a[36:39], v29 offset:2048
    v_mfma_f32_16x16x32_bf16 v[136:139], a[212:215], a[224:227], v[136:139]
    ds_read_b128 a[40:43], v29 offset:4096
    ds_read_b128 a[44:47], v29 offset:6144
    v_mfma_f32_16x16x32_bf16 v[144:147], a[212:215], a[228:231], v[144:147]
    ds_read_b128 a[48:51], v29 offset:8192
    ds_read_b128 a[52:55], v29 offset:10240
    v_mfma_f32_16x16x32_bf16 v[152:155], a[212:215], a[232:235], v[152:155]
    buffer_load_dwordx4 v12, s[8:11], s48 offen offset:3264 nt lds
    v_mfma_f32_16x16x32_bf16 v[160:163], a[212:215], a[236:239], v[160:163]
    s_add_u32 s48, s48, s96
    s_sub_u32 s101, 0, s101
    v_mfma_f32_16x16x32_bf16 v[168:171], a[212:215], a[240:243], v[168:171]
    ds_read_b64_tr_b16 a[0:1], v24 offset:0
    ds_read_b64_tr_b16 a[2:3], v24 offset:1088
    v_mfma_f32_16x16x32_bf16 v[176:179], a[212:215], a[244:247], v[176:179]
    ds_read_b64_tr_b16 a[4:5], v25 offset:0
    ds_read_b64_tr_b16 a[6:7], v25 offset:1088
    v_mfma_f32_16x16x32_bf16 v[180:183], a[216:219], a[224:227], v[180:183]
    ds_read_b64_tr_b16 a[8:9], v26 offset:0
    ds_read_b64_tr_b16 a[10:11], v26 offset:1088
    v_mfma_f32_16x16x32_bf16 v[188:191], a[216:219], a[228:231], v[188:191]
    ds_read_b64_tr_b16 a[12:13], v27 offset:0
    ds_read_b64_tr_b16 a[14:15], v27 offset:1088
    v_mfma_f32_16x16x32_bf16 v[196:199], a[216:219], a[232:235], v[196:199]
    ds_read_b64_tr_b16 a[16:17], v24 offset:128
    ds_read_b64_tr_b16 a[18:19], v24 offset:1216
    v_mfma_f32_16x16x32_bf16 v[204:207], a[216:219], a[236:239], v[204:207]
    ds_read_b64_tr_b16 a[20:21], v25 offset:128
    ds_read_b64_tr_b16 a[22:23], v25 offset:1216
    v_mfma_f32_16x16x32_bf16 v[212:215], a[216:219], a[240:243], v[212:215]
    ds_read_b64_tr_b16 a[24:25], v26 offset:128
    ds_read_b64_tr_b16 a[26:27], v26 offset:1216
    v_mfma_f32_16x16x32_bf16 v[220:223], a[216:219], a[244:247], v[220:223]
    ds_read_b64_tr_b16 a[28:29], v27 offset:128
    ds_read_b64_tr_b16 a[30:31], v27 offset:1216
    v_mfma_f32_16x16x32_bf16 v[184:187], a[220:223], a[224:227], v[184:187]
    v_mfma_f32_16x16x32_bf16 v[192:195], a[220:223], a[228:231], v[192:195]
    v_mfma_f32_16x16x32_bf16 v[200:203], a[220:223], a[232:235], v[200:203]
    v_mfma_f32_16x16x32_bf16 v[208:211], a[220:223], a[236:239], v[208:211]
    v_mfma_f32_16x16x32_bf16 v[216:219], a[220:223], a[240:243], v[216:219]
    v_mfma_f32_16x16x32_bf16 v[224:227], a[220:223], a[244:247], v[224:227]
    s_mov_b32 s99, s98
    s_add_u32 s98, s98, 34816
    s_waitcnt lgkmcnt(14)
    v_mfma_f32_16x16x32_bf16 v[36:39], a[0:3], a[32:35], v[36:39]
    s_cmp_eq_u32 s98, 139264
    s_cselect_b32 s98, 0, s98
    v_mfma_f32_16x16x32_bf16 v[44:47], a[0:3], a[36:39], v[44:47]
    s_sub_u32 s100, s98, s99
    s_waitcnt lgkmcnt(0)
    s_waitcnt vmcnt(12)
    v_mfma_f32_16x16x32_bf16 v[52:55], a[0:3], a[40:43], v[52:55]
    s_barrier
    s_add_u32 m0, s43, s99
    v_mfma_f32_16x16x32_bf16 v[60:63], a[0:3], a[44:47], v[60:63]
    buffer_load_dwordx4 v9, s[8:11], s48 offen offset:0 nt lds
    v_mfma_f32_16x16x32_bf16 v[68:71], a[0:3], a[48:51], v[68:71]
    v_add_u32 v24, s100, v24
    v_add_u32 v25, s100, v25
    v_mfma_f32_16x16x32_bf16 v[76:79], a[0:3], a[52:55], v[76:79]
    buffer_load_dwordx4 v10, s[8:11], s48 offen offset:1088 nt lds
    v_mfma_f32_16x16x32_bf16 v[40:43], a[4:7], a[32:35], v[40:43]
    v_add_u32 v26, s100, v26
    v_add_u32 v27, s100, v27
    v_mfma_f32_16x16x32_bf16 v[48:51], a[4:7], a[36:39], v[48:51]
    v_add_u32 v28, s101, v28
    ds_read_b128 a[224:227], v28 offset:0
    v_mfma_f32_16x16x32_bf16 v[56:59], a[4:7], a[40:43], v[56:59]
    ds_read_b128 a[228:231], v28 offset:2048
    ds_read_b128 a[232:235], v28 offset:4096
    v_mfma_f32_16x16x32_bf16 v[64:67], a[4:7], a[44:47], v[64:67]
    ds_read_b128 a[236:239], v28 offset:6144
    ds_read_b128 a[240:243], v28 offset:8192
    v_mfma_f32_16x16x32_bf16 v[72:75], a[4:7], a[48:51], v[72:75]
    buffer_load_dwordx4 v11, s[8:11], s48 offen offset:2176 nt lds
    v_mfma_f32_16x16x32_bf16 v[80:83], a[4:7], a[52:55], v[80:83]
    ds_read_b128 a[244:247], v28 offset:10240
    ds_read_b64_tr_b16 a[192:193], v24 offset:0
    v_mfma_f32_16x16x32_bf16 v[84:87], a[8:11], a[32:35], v[84:87]
    ds_read_b64_tr_b16 a[194:195], v24 offset:1088
    ds_read_b64_tr_b16 a[196:197], v25 offset:0
    v_mfma_f32_16x16x32_bf16 v[92:95], a[8:11], a[36:39], v[92:95]
    ds_read_b64_tr_b16 a[198:199], v25 offset:1088
    ds_read_b64_tr_b16 a[200:201], v26 offset:0
    v_mfma_f32_16x16x32_bf16 v[100:103], a[8:11], a[40:43], v[100:103]
    ds_read_b64_tr_b16 a[202:203], v26 offset:1088
    ds_read_b64_tr_b16 a[204:205], v27 offset:0
    v_mfma_f32_16x16x32_bf16 v[108:111], a[8:11], a[44:47], v[108:111]
    ds_read_b64_tr_b16 a[206:207], v27 offset:1088
    ds_read_b64_tr_b16 a[208:209], v24 offset:128
    v_mfma_f32_16x16x32_bf16 v[116:119], a[8:11], a[48:51], v[116:119]
    buffer_load_dwordx4 v12, s[8:11], s48 offen offset:3264 nt lds
    v_mfma_f32_16x16x32_bf16 v[124:127], a[8:11], a[52:55], v[124:127]
    ds_read_b64_tr_b16 a[210:211], v24 offset:1216
    ds_read_b64_tr_b16 a[212:213], v25 offset:128
    v_mfma_f32_16x16x32_bf16 v[88:91], a[12:15], a[32:35], v[88:91]
    ds_read_b64_tr_b16 a[214:215], v25 offset:1216
    ds_read_b64_tr_b16 a[216:217], v26 offset:128
    v_mfma_f32_16x16x32_bf16 v[96:99], a[12:15], a[36:39], v[96:99]
    ds_read_b64_tr_b16 a[218:219], v26 offset:1216
    ds_read_b64_tr_b16 a[220:221], v27 offset:128
    v_mfma_f32_16x16x32_bf16 v[104:107], a[12:15], a[40:43], v[104:107]
    s_add_u32 s48, s48, s96
    s_add_u32 m0, s44, s99
    v_mfma_f32_16x16x32_bf16 v[112:115], a[12:15], a[44:47], v[112:115]
    buffer_load_dwordx4 v13, s[12:15], s49 offen offset:0 nt lds
    v_mfma_f32_16x16x32_bf16 v[120:123], a[12:15], a[48:51], v[120:123]
    ds_read_b64_tr_b16 a[222:223], v27 offset:1216
    v_mfma_f32_16x16x32_bf16 v[128:131], a[12:15], a[52:55], v[128:131]
    v_mfma_f32_16x16x32_bf16 v[132:135], a[16:19], a[32:35], v[132:135]
    v_mfma_f32_16x16x32_bf16 v[140:143], a[16:19], a[36:39], v[140:143]
    v_mfma_f32_16x16x32_bf16 v[148:151], a[16:19], a[40:43], v[148:151]
    buffer_load_dwordx4 v14, s[12:15], s49 offen offset:1088 nt lds
    v_mfma_f32_16x16x32_bf16 v[156:159], a[16:19], a[44:47], v[156:159]
    v_mfma_f32_16x16x32_bf16 v[164:167], a[16:19], a[48:51], v[164:167]
    v_mfma_f32_16x16x32_bf16 v[172:175], a[16:19], a[52:55], v[172:175]
    v_mfma_f32_16x16x32_bf16 v[136:139], a[20:23], a[32:35], v[136:139]
    v_mfma_f32_16x16x32_bf16 v[144:147], a[20:23], a[36:39], v[144:147]
    v_mfma_f32_16x16x32_bf16 v[152:155], a[20:23], a[40:43], v[152:155]
    buffer_load_dwordx4 v15, s[12:15], s49 offen offset:2176 nt lds
    v_mfma_f32_16x16x32_bf16 v[160:163], a[20:23], a[44:47], v[160:163]
    v_mfma_f32_16x16x32_bf16 v[168:171], a[20:23], a[48:51], v[168:171]
    v_mfma_f32_16x16x32_bf16 v[176:179], a[20:23], a[52:55], v[176:179]
    v_mfma_f32_16x16x32_bf16 v[180:183], a[24:27], a[32:35], v[180:183]
    v_mfma_f32_16x16x32_bf16 v[188:191], a[24:27], a[36:39], v[188:191]
    buffer_load_dwordx4 v16, s[12:15], s49 offen offset:3264 nt lds
    v_mfma_f32_16x16x32_bf16 v[196:199], a[24:27], a[40:43], v[196:199]
    s_add_u32 s49, s49, s96
    v_mfma_f32_16x16x32_bf16 v[204:207], a[24:27], a[44:47], v[204:207]
    v_mfma_f32_16x16x32_bf16 v[212:215], a[24:27], a[48:51], v[212:215]
    v_mfma_f32_16x16x32_bf16 v[220:223], a[24:27], a[52:55], v[220:223]
    v_mfma_f32_16x16x32_bf16 v[184:187], a[28:31], a[32:35], v[184:187]
    v_mfma_f32_16x16x32_bf16 v[192:195], a[28:31], a[36:39], v[192:195]
    v_mfma_f32_16x16x32_bf16 v[200:203], a[28:31], a[40:43], v[200:203]
    v_mfma_f32_16x16x32_bf16 v[208:211], a[28:31], a[44:47], v[208:211]
    v_mfma_f32_16x16x32_bf16 v[216:219], a[28:31], a[48:51], v[216:219]
    v_mfma_f32_16x16x32_bf16 v[224:227], a[28:31], a[52:55], v[224:227]
    s_mov_b32 s99, s98
    s_add_u32 s98, s98, 34816
    s_waitcnt lgkmcnt(14)
    v_mfma_f32_16x16x32_bf16 v[36:39], a[192:195], a[224:227], v[36:39]
    s_cmp_eq_u32 s98, 139264
    s_cselect_b32 s98, 0, s98
    v_mfma_f32_16x16x32_bf16 v[44:47], a[192:195], a[228:231], v[44:47]
    s_sub_u32 s100, s98, s99
    s_waitcnt lgkmcnt(0)
    s_waitcnt vmcnt(12)
    v_mfma_f32_16x16x32_bf16 v[52:55], a[192:195], a[232:235], v[52:55]
    s_barrier
    s_add_u32 m0, s43, s99
    v_mfma_f32_16x16x32_bf16 v[60:63], a[192:195], a[236:239], v[60:63]
    buffer_load_dwordx4 v9, s[8:11], s48 offen offset:0 nt lds
    v_mfma_f32_16x16x32_bf16 v[68:71], a[192:195], a[240:243], v[68:71]
    v_add_u32 v24, s100, v24
    v_add_u32 v25, s100, v25
    v_mfma_f32_16x16x32_bf16 v[76:79], a[192:195], a[244:247], v[76:79]
    buffer_load_dwordx4 v10, s[8:11], s48 offen offset:1088 nt lds
    v_mfma_f32_16x16x32_bf16 v[40:43], a[196:199], a[224:227], v[40:43]
    v_add_u32 v26, s100, v26
    v_add_u32 v27, s100, v27
    v_mfma_f32_16x16x32_bf16 v[48:51], a[196:199], a[228:231], v[48:51]
    v_add_u32 v29, s101, v29
    ds_read_b128 a[32:35], v29 offset:0
    v_mfma_f32_16x16x32_bf16 v[56:59], a[196:199], a[232:235], v[56:59]
    ds_read_b128 a[36:39], v29 offset:2048
    ds_read_b128 a[40:43], v29 offset:4096
    v_mfma_f32_16x16x32_bf16 v[64:67], a[196:199], a[236:239], v[64:67]
    ds_read_b128 a[44:47], v29 offset:6144
    ds_read_b128 a[48:51], v29 offset:8192
    v_mfma_f32_16x16x32_bf16 v[72:75], a[196:199], a[240:243], v[72:75]
    buffer_load_dwordx4 v11, s[8:11], s48 offen offset:2176 nt lds
    v_mfma_f32_16x16x32_bf16 v[80:83], a[196:199], a[244:247], v[80:83]
    ds_read_b128 a[52:55], v29 offset:10240
    ds_read_b64_tr_b16 a[0:1], v24 offset:0
    v_mfma_f32_16x16x32_bf16 v[84:87], a[200:203], a[224:227], v[84:87]
    ds_read_b64_tr_b16 a[2:3], v24 offset:1088
    ds_read_b64_tr_b16 a[4:5], v25 offset:0
    v_mfma_f32_16x16x32_bf16 v[92:95], a[200:203], a[228:231], v[92:95]
    ds_read_b64_tr_b16 a[6:7], v25 offset:1088
    ds_read_b64_tr_b16 a[8:9], v26 offset:0
    v_mfma_f32_16x16x32_bf16 v[100:103], a[200:203], a[232:235], v[100:103]
    ds_read_b64_tr_b16 a[10:11], v26 offset:1088
    ds_read_b64_tr_b16 a[12:13], v27 offset:0
    v_mfma_f32_16x16x32_bf16 v[108:111], a[200:203], a[236:239], v[108:111]
    ds_read_b64_tr_b16 a[14:15], v27 offset:1088
    ds_read_b64_tr_b16 a[16:17], v24 offset:128
    v_mfma_f32_16x16x32_bf16 v[116:119], a[200:203], a[240:243], v[116:119]
    buffer_load_dwordx4 v12, s[8:11], s48 offen offset:3264 nt lds
    v_mfma_f32_16x16x32_bf16 v[124:127], a[200:203], a[244:247], v[124:127]
    ds_read_b64_tr_b16 a[18:19], v24 offset:1216
    ds_read_b64_tr_b16 a[20:21], v25 offset:128
    v_mfma_f32_16x16x32_bf16 v[88:91], a[204:207], a[224:227], v[88:91]
    ds_read_b64_tr_b16 a[22:23], v25 offset:1216
    ds_read_b64_tr_b16 a[24:25], v26 offset:128
    v_mfma_f32_16x16x32_bf16 v[96:99], a[204:207], a[228:231], v[96:99]
    ds_read_b64_tr_b16 a[26:27], v26 offset:1216
    ds_read_b64_tr_b16 a[28:29], v27 offset:128
    v_mfma_f32_16x16x32_bf16 v[104:107], a[204:207], a[232:235], v[104:107]
    s_add_u32 s48, s48, s96
    s_add_u32 m0, s44, s99
    v_mfma_f32_16x16x32_bf16 v[112:115], a[204:207], a[236:239], v[112:115]
    buffer_load_dwordx4 v13, s[12:15], s49 offen offset:0 nt lds
    v_mfma_f32_16x16x32_bf16 v[120:123], a[204:207], a[240:243], v[120:123]
    ds_read_b64_tr_b16 a[30:31], v27 offset:1216
    v_mfma_f32_16x16x32_bf16 v[128:131], a[204:207], a[244:247], v[128:131]
    v_mfma_f32_16x16x32_bf16 v[132:135], a[208:211], a[224:227], v[132:135]
    v_mfma_f32_16x16x32_bf16 v[140:143], a[208:211], a[228:231], v[140:143]
    v_mfma_f32_16x16x32_bf16 v[148:151], a[208:211], a[232:235], v[148:151]
    buffer_load_dwordx4 v14, s[12:15], s49 offen offset:1088 nt lds
    v_mfma_f32_16x16x32_bf16 v[156:159], a[208:211], a[236:239], v[156:159]
    v_mfma_f32_16x16x32_bf16 v[164:167], a[208:211], a[240:243], v[164:167]
    v_mfma_f32_16x16x32_bf16 v[172:175], a[208:211], a[244:247], v[172:175]
    v_mfma_f32_16x16x32_bf16 v[136:139], a[212:215], a[224:227], v[136:139]
    v_mfma_f32_16x16x32_bf16 v[144:147], a[212:215], a[228:231], v[144:147]
    v_mfma_f32_16x16x32_bf16 v[152:155], a[212:215], a[232:235], v[152:155]
    buffer_load_dwordx4 v15, s[12:15], s49 offen offset:2176 nt lds
    v_mfma_f32_16x16x32_bf16 v[160:163], a[212:215], a[236:239], v[160:163]
    v_mfma_f32_16x16x32_bf16 v[168:171], a[212:215], a[240:243], v[168:171]
    v_mfma_f32_16x16x32_bf16 v[176:179], a[212:215], a[244:247], v[176:179]
    v_mfma_f32_16x16x32_bf16 v[180:183], a[216:219], a[224:227], v[180:183]
    v_mfma_f32_16x16x32_bf16 v[188:191], a[216:219], a[228:231], v[188:191]
    buffer_load_dwordx4 v16, s[12:15], s49 offen offset:3264 nt lds
    v_mfma_f32_16x16x32_bf16 v[196:199], a[216:219], a[232:235], v[196:199]
    s_add_u32 s49, s49, s96
    s_sub_u32 s101, 0, s101
    v_mfma_f32_16x16x32_bf16 v[204:207], a[216:219], a[236:239], v[204:207]
    v_mfma_f32_16x16x32_bf16 v[212:215], a[216:219], a[240:243], v[212:215]
    v_mfma_f32_16x16x32_bf16 v[220:223], a[216:219], a[244:247], v[220:223]
    v_mfma_f32_16x16x32_bf16 v[184:187], a[220:223], a[224:227], v[184:187]
    v_mfma_f32_16x16x32_bf16 v[192:195], a[220:223], a[228:231], v[192:195]
    v_mfma_f32_16x16x32_bf16 v[200:203], a[220:223], a[232:235], v[200:203]
    v_mfma_f32_16x16x32_bf16 v[208:211], a[220:223], a[236:239], v[208:211]
    v_mfma_f32_16x16x32_bf16 v[216:219], a[220:223], a[240:243], v[216:219]
    v_mfma_f32_16x16x32_bf16 v[224:227], a[220:223], a[244:247], v[224:227]
    s_mov_b32 s99, s98
    s_add_u32 s98, s98, 34816
    s_waitcnt lgkmcnt(14)
    v_mfma_f32_16x16x32_bf16 v[36:39], a[0:3], a[32:35], v[36:39]
    s_cmp_eq_u32 s98, 139264
    s_cselect_b32 s98, 0, s98
    v_mfma_f32_16x16x32_bf16 v[44:47], a[0:3], a[36:39], v[44:47]
    s_waitcnt lgkmcnt(0)
    s_waitcnt vmcnt(16)
    s_barrier
    v_mfma_f32_16x16x32_bf16 v[52:55], a[0:3], a[40:43], v[52:55]
    v_add_u32 v4, s98, v4
    ds_read_b128 a[192:195], v4 offset:0
    v_mfma_f32_16x16x32_bf16 v[60:63], a[0:3], a[44:47], v[60:63]
    v_mul_f32 v36, s50, v36
    v_mul_f32 v37, s50, v37
    v_mfma_f32_16x16x32_bf16 v[68:71], a[0:3], a[48:51], v[68:71]
    v_mul_f32 v38, s50, v38
    v_mul_f32 v39, s50, v39
    v_mfma_f32_16x16x32_bf16 v[76:79], a[0:3], a[52:55], v[76:79]
    v_cvt_pk_bf16_f32 v36, v36, v37
    v_cvt_pk_bf16_f32 v37, v38, v39
    v_mfma_f32_16x16x32_bf16 v[40:43], a[4:7], a[32:35], v[40:43]
    ds_read_b128 a[196:199], v4 offset:64
    v_mul_f32 v44, s50, v44
    v_mfma_f32_16x16x32_bf16 v[48:51], a[4:7], a[36:39], v[48:51]
    v_mul_f32 v45, s50, v45
    v_mul_f32 v46, s50, v46
    v_mfma_f32_16x16x32_bf16 v[56:59], a[4:7], a[40:43], v[56:59]
    s_nop 1
    v_mul_f32 v40, s50, v40
    v_mul_f32 v41, s50, v41
    v_mfma_f32_16x16x32_bf16 v[64:67], a[4:7], a[44:47], v[64:67]
    v_mul_f32 v42, s50, v42
    v_mul_f32 v43, s50, v43
    v_mfma_f32_16x16x32_bf16 v[72:75], a[4:7], a[48:51], v[72:75]
    v_cvt_pk_bf16_f32 v38, v40, v41
    v_cvt_pk_bf16_f32 v39, v42, v43
    v_mfma_f32_16x16x32_bf16 v[80:83], a[4:7], a[52:55], v[80:83]
    v_permlane32_swap_b32 v36, v38
    v_permlane32_swap_b32 v37, v39
    v_mfma_f32_16x16x32_bf16 v[84:87], a[8:11], a[32:35], v[84:87]
    v_permlane16_swap_b32 v36, v38
    v_permlane16_swap_b32 v37, v39
    v_mfma_f32_16x16x32_bf16 v[92:95], a[8:11], a[36:39], v[92:95]
    v_mul_f32 v47, s50, v47
    v_mul_f32 v48, s50, v48
    v_mfma_f32_16x16x32_bf16 v[100:103], a[8:11], a[40:43], v[100:103]
    v_mul_f32 v49, s50, v49
    v_mul_f32 v50, s50, v50
    v_mfma_f32_16x16x32_bf16 v[108:111], a[8:11], a[44:47], v[108:111]
    v_mul_f32 v51, s50, v51
    v_cvt_pk_bf16_f32 v44, v44, v45
    v_mfma_f32_16x16x32_bf16 v[116:119], a[8:11], a[48:51], v[116:119]
    v_cvt_pk_bf16_f32 v45, v46, v47
    v_cvt_pk_bf16_f32 v46, v48, v49
    v_mfma_f32_16x16x32_bf16 v[124:127], a[8:11], a[52:55], v[124:127]
    v_cvt_pk_bf16_f32 v47, v50, v51
    v_permlane32_swap_b32 v44, v46
    v_mfma_f32_16x16x32_bf16 v[88:91], a[12:15], a[32:35], v[88:91]
    v_permlane32_swap_b32 v45, v47
    v_permlane16_swap_b32 v44, v46
    v_mfma_f32_16x16x32_bf16 v[96:99], a[12:15], a[36:39], v[96:99]
    v_permlane16_swap_b32 v45, v47
    v_mul_f32 v52, s50, v52
    v_mfma_f32_16x16x32_bf16 v[104:107], a[12:15], a[40:43], v[104:107]
    v_mul_f32 v53, s50, v53
    v_mul_f32 v54, s50, v54
    v_mfma_f32_16x16x32_bf16 v[112:115], a[12:15], a[44:47], v[112:115]
    v_mul_f32 v55, s50, v55
    v_mul_f32 v56, s50, v56
    v_mfma_f32_16x16x32_bf16 v[120:123], a[12:15], a[48:51], v[120:123]
    v_mul_f32 v57, s50, v57
    v_mul_f32 v58, s50, v58
    v_mfma_f32_16x16x32_bf16 v[128:131], a[12:15], a[52:55], v[128:131]
    v_mul_f32 v59, s50, v59
    v_cvt_pk_bf16_f32 v52, v52, v53
    v_mfma_f32_16x16x32_bf16 v[132:135], a[16:19], a[32:35], v[132:135]
    v_cvt_pk_bf16_f32 v53, v54, v55
    v_cvt_pk_bf16_f32 v54, v56, v57
    v_mfma_f32_16x16x32_bf16 v[140:143], a[16:19], a[36:39], v[140:143]
    v_cvt_pk_bf16_f32 v55, v58, v59
    v_permlane32_swap_b32 v52, v54
    v_mfma_f32_16x16x32_bf16 v[148:151], a[16:19], a[40:43], v[148:151]
    v_permlane32_swap_b32 v53, v55
    v_permlane16_swap_b32 v52, v54
    v_mfma_f32_16x16x32_bf16 v[156:159], a[16:19], a[44:47], v[156:159]
    v_permlane16_swap_b32 v53, v55
    v_mul_f32 v60, s50, v60
    v_mfma_f32_16x16x32_bf16 v[164:167], a[16:19], a[48:51], v[164:167]
    v_mul_f32 v61, s50, v61
    v_mul_f32 v62, s50, v62
    v_mfma_f32_16x16x32_bf16 v[172:175], a[16:19], a[52:55], v[172:175]
    v_mul_f32 v63, s50, v63
    v_mul_f32 v64, s50, v64
    v_mfma_f32_16x16x32_bf16 v[136:139], a[20:23], a[32:35], v[136:139]
    v_mul_f32 v65, s50, v65
    v_mul_f32 v66, s50, v66
    v_mfma_f32_16x16x32_bf16 v[144:147], a[20:23], a[36:39], v[144:147]
    v_mul_f32 v67, s50, v67
    v_cvt_pk_bf16_f32 v60, v60, v61
    v_mfma_f32_16x16x32_bf16 v[152:155], a[20:23], a[40:43], v[152:155]
    v_cvt_pk_bf16_f32 v61, v62, v63
    v_cvt_pk_bf16_f32 v62, v64, v65
    v_mfma_f32_16x16x32_bf16 v[160:163], a[20:23], a[44:47], v[160:163]
    v_cvt_pk_bf16_f32 v63, v66, v67
    v_permlane32_swap_b32 v60, v62
    v_mfma_f32_16x16x32_bf16 v[168:171], a[20:23], a[48:51], v[168:171]
    v_permlane32_swap_b32 v61, v63
    v_permlane16_swap_b32 v60, v62
    v_mfma_f32_16x16x32_bf16 v[176:179], a[20:23], a[52:55], v[176:179]
    v_permlane16_swap_b32 v61, v63
    v_mul_f32 v68, s50, v68
    v_mfma_f32_16x16x32_bf16 v[180:183], a[24:27], a[32:35], v[180:183]
    v_mul_f32 v69, s50, v69
    v_mul_f32 v70, s50, v70
    v_mfma_f32_16x16x32_bf16 v[188:191], a[24:27], a[36:39], v[188:191]
    v_mul_f32 v71, s50, v71
    v_mul_f32 v72, s50, v72
    v_mfma_f32_16x16x32_bf16 v[196:199], a[24:27], a[40:43], v[196:199]
    v_mul_f32 v73, s50, v73
    v_mul_f32 v74, s50, v74
    v_mfma_f32_16x16x32_bf16 v[204:207], a[24:27], a[44:47], v[204:207]
    v_mul_f32 v75, s50, v75
    v_cvt_pk_bf16_f32 v68, v68, v69
    v_mfma_f32_16x16x32_bf16 v[212:215], a[24:27], a[48:51], v[212:215]
    v_cvt_pk_bf16_f32 v69, v70, v71
    v_cvt_pk_bf16_f32 v70, v72, v73
    v_mfma_f32_16x16x32_bf16 v[220:223], a[24:27], a[52:55], v[220:223]
    v_cvt_pk_bf16_f32 v71, v74, v75
    v_permlane32_swap_b32 v68, v70
    v_mfma_f32_16x16x32_bf16 v[184:187], a[28:31], a[32:35], v[184:187]
    v_permlane32_swap_b32 v69, v71
    v_permlane16_swap_b32 v68, v70
    v_mfma_f32_16x16x32_bf16 v[192:195], a[28:31], a[36:39], v[192:195]
    v_permlane16_swap_b32 v69, v71
    v_mul_f32 v76, s50, v76
    v_mfma_f32_16x16x32_bf16 v[200:203], a[28:31], a[40:43], v[200:203]
    v_mul_f32 v77, s50, v77
    v_mul_f32 v78, s50, v78
    v_mfma_f32_16x16x32_bf16 v[208:211], a[28:31], a[44:47], v[208:211]
    v_mul_f32 v79, s50, v79
    v_mul_f32 v80, s50, v80
    v_mfma_f32_16x16x32_bf16 v[216:219], a[28:31], a[48:51], v[216:219]
    v_mul_f32 v81, s50, v81
    v_mul_f32 v82, s50, v82
    v_mfma_f32_16x16x32_bf16 v[224:227], a[28:31], a[52:55], v[224:227]
    v_mul_f32 v83, s50, v83
    v_cvt_pk_bf16_f32 v76, v76, v77
    s_waitcnt lgkmcnt(1)
    v_mfma_f32_16x16x32_bf16 v[40:43], a[192:195], v[36:39], 0
    v_cvt_pk_bf16_f32 v77, v78, v79
    v_cvt_pk_bf16_f32 v78, v80, v81
    v_mfma_f32_16x16x32_bf16 v[48:51], a[192:195], v[44:47], 0
    v_cvt_pk_bf16_f32 v79, v82, v83
    v_permlane32_swap_b32 v76, v78
    v_mfma_f32_16x16x32_bf16 v[56:59], a[192:195], v[52:55], 0
    v_permlane32_swap_b32 v77, v79
    v_permlane16_swap_b32 v76, v78
    v_mfma_f32_16x16x32_bf16 v[64:67], a[192:195], v[60:63], 0
    v_permlane16_swap_b32 v77, v79
    v_mul_f32 v84, s50, v84
    v_mfma_f32_16x16x32_bf16 v[72:75], a[192:195], v[68:71], 0
    v_mul_f32 v85, s50, v85
    v_mul_f32 v86, s50, v86
    v_mul_f32 v87, s50, v87
    v_mul_f32 v88, s50, v88
    v_mul_f32 v89, s50, v89
    v_mul_f32 v90, s50, v90
    v_mul_f32 v91, s50, v91
    v_cvt_pk_bf16_f32 v84, v84, v85
    v_cvt_pk_bf16_f32 v85, v86, v87
    v_cvt_pk_bf16_f32 v86, v88, v89
    v_cvt_pk_bf16_f32 v87, v90, v91
    s_nop 0
    v_permlane32_swap_b32 v84, v86
    v_permlane32_swap_b32 v85, v87
    s_nop 0
    v_permlane16_swap_b32 v84, v86
    v_permlane16_swap_b32 v85, v87
    v_mfma_f32_16x16x32_bf16 v[80:83], a[192:195], v[76:79], 0
    v_mul_f32 v92, s50, v92
    v_mul_f32 v93, s50, v93
    v_mul_f32 v94, s50, v94
    v_mul_f32 v95, s50, v95
    v_mul_f32 v96, s50, v96
    v_mul_f32 v97, s50, v97
    v_mul_f32 v98, s50, v98
    v_mul_f32 v99, s50, v99
    v_cvt_pk_bf16_f32 v92, v92, v93
    v_cvt_pk_bf16_f32 v93, v94, v95
    v_cvt_pk_bf16_f32 v94, v96, v97
    v_cvt_pk_bf16_f32 v95, v98, v99
    s_nop 0
    v_permlane32_swap_b32 v92, v94
    v_permlane32_swap_b32 v93, v95
    s_nop 0
    v_permlane16_swap_b32 v92, v94
    v_permlane16_swap_b32 v93, v95
    ds_read_b128 a[200:203], v4 offset:128
    s_waitcnt lgkmcnt(1)
    v_mfma_f32_16x16x32_bf16 v[40:43], a[196:199], v[84:87], v[40:43]
    v_mul_f32 v100, s50, v100
    v_mul_f32 v101, s50, v101
    v_mul_f32 v102, s50, v102
    v_mul_f32 v103, s50, v103
    v_mul_f32 v104, s50, v104
    v_mul_f32 v105, s50, v105
    v_mul_f32 v106, s50, v106
    v_mul_f32 v107, s50, v107
    v_cvt_pk_bf16_f32 v100, v100, v101
    v_cvt_pk_bf16_f32 v101, v102, v103
    v_cvt_pk_bf16_f32 v102, v104, v105
    v_cvt_pk_bf16_f32 v103, v106, v107
    s_nop 0
    v_permlane32_swap_b32 v100, v102
    v_permlane32_swap_b32 v101, v103
    s_nop 0
    v_permlane16_swap_b32 v100, v102
    v_permlane16_swap_b32 v101, v103
    v_mfma_f32_16x16x32_bf16 v[48:51], a[196:199], v[92:95], v[48:51]
    v_mul_f32 v108, s50, v108
    v_mul_f32 v109, s50, v109
    v_mul_f32 v110, s50, v110
    v_mul_f32 v111, s50, v111
    v_mul_f32 v112, s50, v112
    v_mul_f32 v113, s50, v113
    v_mul_f32 v114, s50, v114
    v_mul_f32 v115, s50, v115
    v_cvt_pk_bf16_f32 v108, v108, v109
    v_cvt_pk_bf16_f32 v109, v110, v111
    v_cvt_pk_bf16_f32 v110, v112, v113
    v_cvt_pk_bf16_f32 v111, v114, v115
    s_nop 0
    v_permlane32_swap_b32 v108, v110
    v_permlane32_swap_b32 v109, v111
    s_nop 0
    v_permlane16_swap_b32 v108, v110
    v_permlane16_swap_b32 v109, v111
    v_mfma_f32_16x16x32_bf16 v[56:59], a[196:199], v[100:103], v[56:59]
    v_mul_f32 v116, s50, v116
    v_mul_f32 v117, s50, v117
    v_mul_f32 v118, s50, v118
    v_mul_f32 v119, s50, v119
    v_mul_f32 v120, s50, v120
    v_mul_f32 v121, s50, v121
    v_mul_f32 v122, s50, v122
    v_mul_f32 v123, s50, v123
    v_cvt_pk_bf16_f32 v116, v116, v117
    v_cvt_pk_bf16_f32 v117, v118, v119
    v_cvt_pk_bf16_f32 v118, v120, v121
    v_cvt_pk_bf16_f32 v119, v122, v123
    s_nop 0
    v_permlane32_swap_b32 v116, v118
    v_permlane32_swap_b32 v117, v119
    s_nop 0
    v_permlane16_swap_b32 v116, v118
    v_permlane16_swap_b32 v117, v119
    v_mfma_f32_16x16x32_bf16 v[64:67], a[196:199], v[108:111], v[64:67]
    v_mul_f32 v124, s50, v124
    v_mul_f32 v125, s50, v125
    v_mul_f32 v126, s50, v126
    v_mul_f32 v127, s50, v127
    v_mul_f32 v128, s50, v128
    v_mul_f32 v129, s50, v129
    v_mul_f32 v130, s50, v130
    v_mul_f32 v131, s50, v131
    v_cvt_pk_bf16_f32 v124, v124, v125
    v_cvt_pk_bf16_f32 v125, v126, v127
    v_cvt_pk_bf16_f32 v126, v128, v129
    v_cvt_pk_bf16_f32 v127, v130, v131
    s_nop 0
    v_permlane32_swap_b32 v124, v126
    v_permlane32_swap_b32 v125, v127
    s_nop 0
    v_permlane16_swap_b32 v124, v126
    v_permlane16_swap_b32 v125, v127
    v_mfma_f32_16x16x32_bf16 v[72:75], a[196:199], v[116:119], v[72:75]
    v_mul_f32 v132, s50, v132
    v_mul_f32 v133, s50, v133
    v_mul_f32 v134, s50, v134
    v_mul_f32 v135, s50, v135
    v_mul_f32 v136, s50, v136
    v_mul_f32 v137, s50, v137
    v_mul_f32 v138, s50, v138
    v_mul_f32 v139, s50, v139
    v_cvt_pk_bf16_f32 v132, v132, v133
    v_cvt_pk_bf16_f32 v133, v134, v135
    v_cvt_pk_bf16_f32 v134, v136, v137
    v_cvt_pk_bf16_f32 v135, v138, v139
    s_nop 0
    v_permlane32_swap_b32 v132, v134
    v_permlane32_swap_b32 v133, v135
    s_nop 0
    v_permlane16_swap_b32 v132, v134
    v_permlane16_swap_b32 v133, v135
    v_mfma_f32_16x16x32_bf16 v[80:83], a[196:199], v[124:127], v[80:83]
    v_mul_f32 v140, s50, v140
    v_mul_f32 v141, s50, v141
    v_mul_f32 v142, s50, v142
    v_mul_f32 v143, s50, v143
    v_mul_f32 v144, s50, v144
    v_mul_f32 v145, s50, v145
    v_mul_f32 v146, s50, v146
    v_mul_f32 v147, s50, v147
    v_cvt_pk_bf16_f32 v140, v140, v141
    v_cvt_pk_bf16_f32 v141, v142, v143
    v_cvt_pk_bf16_f32 v142, v144, v145
    v_cvt_pk_bf16_f32 v143, v146, v147
    s_nop 0
    v_permlane32_swap_b32 v140, v142
    v_permlane32_swap_b32 v141, v143
    s_nop 0
    v_permlane16_swap_b32 v140, v142
    v_permlane16_swap_b32 v141, v143
    ds_read_b128 a[204:207], v4 offset:192
    s_waitcnt lgkmcnt(1)
    v_mfma_f32_16x16x32_bf16 v[40:43], a[200:203], v[132:135], v[40:43]
    v_mul_f32 v148, s50, v148
    v_mul_f32 v149, s50, v149
    v_mul_f32 v150, s50, v150
    v_mul_f32 v151, s50, v151
    v_mul_f32 v152, s50, v152
    v_mul_f32 v153, s50, v153
    v_mul_f32 v154, s50, v154
    v_mul_f32 v155, s50, v155
    v_cvt_pk_bf16_f32 v148, v148, v149
    v_cvt_pk_bf16_f32 v149, v150, v151
    v_cvt_pk_bf16_f32 v150, v152, v153
    v_cvt_pk_bf16_f32 v151, v154, v155
    s_nop 0
    v_permlane32_swap_b32 v148, v150
    v_permlane32_swap_b32 v149, v151
    s_nop 0
    v_permlane16_swap_b32 v148, v150
    v_permlane16_swap_b32 v149, v151
    v_mfma_f32_16x16x32_bf16 v[48:51], a[200:203], v[140:143], v[48:51]
    v_mul_f32 v156, s50, v156
    v_mul_f32 v157, s50, v157
    v_mul_f32 v158, s50, v158
    v_mul_f32 v159, s50, v159
    v_mul_f32 v160, s50, v160
    v_mul_f32 v161, s50, v161
    v_mul_f32 v162, s50, v162
    v_mul_f32 v163, s50, v163
    v_cvt_pk_bf16_f32 v156, v156, v157
    v_cvt_pk_bf16_f32 v157, v158, v159
    v_cvt_pk_bf16_f32 v158, v160, v161
    v_cvt_pk_bf16_f32 v159, v162, v163
    s_nop 0
    v_permlane32_swap_b32 v156, v158
    v_permlane32_swap_b32 v157, v159
    s_nop 0
    v_permlane16_swap_b32 v156, v158
    v_permlane16_swap_b32 v157, v159
    v_mfma_f32_16x16x32_bf16 v[56:59], a[200:203], v[148:151], v[56:59]
    v_mul_f32 v164, s50, v164
    v_mul_f32 v165, s50, v165
    v_mul_f32 v166, s50, v166
    v_mul_f32 v167, s50, v167
    v_mul_f32 v168, s50, v168
    v_mul_f32 v169, s50, v169
    v_mul_f32 v170, s50, v170
    v_mul_f32 v171, s50, v171
    v_cvt_pk_bf16_f32 v164, v164, v165
    v_cvt_pk_bf16_f32 v165, v166, v167
    v_cvt_pk_bf16_f32 v166, v168, v169
    v_cvt_pk_bf16_f32 v167, v170, v171
    s_nop 0
    v_permlane32_swap_b32 v164, v166
    v_permlane32_swap_b32 v165, v167
    s_nop 0
    v_permlane16_swap_b32 v164, v166
    v_permlane16_swap_b32 v165, v167
    v_mfma_f32_16x16x32_bf16 v[64:67], a[200:203], v[156:159], v[64:67]
    v_mul_f32 v172, s50, v172
    v_mul_f32 v173, s50, v173
    v_mul_f32 v174, s50, v174
    v_mul_f32 v175, s50, v175
    v_mul_f32 v176, s50, v176
    v_mul_f32 v177, s50, v177
    v_mul_f32 v178, s50, v178
    v_mul_f32 v179, s50, v179
    v_cvt_pk_bf16_f32 v172, v172, v173
    v_cvt_pk_bf16_f32 v173, v174, v175
    v_cvt_pk_bf16_f32 v174, v176, v177
    v_cvt_pk_bf16_f32 v175, v178, v179
    s_nop 0
    v_permlane32_swap_b32 v172, v174
    v_permlane32_swap_b32 v173, v175
    s_nop 0
    v_permlane16_swap_b32 v172, v174
    v_permlane16_swap_b32 v173, v175
    v_mfma_f32_16x16x32_bf16 v[72:75], a[200:203], v[164:167], v[72:75]
    v_mul_f32 v180, s50, v180
    v_mul_f32 v181, s50, v181
    v_mul_f32 v182, s50, v182
    v_mul_f32 v183, s50, v183
    v_mul_f32 v184, s50, v184
    v_mul_f32 v185, s50, v185
    v_mul_f32 v186, s50, v186
    v_mul_f32 v187, s50, v187
    v_cvt_pk_bf16_f32 v180, v180, v181
    v_cvt_pk_bf16_f32 v181, v182, v183
    v_cvt_pk_bf16_f32 v182, v184, v185
    v_cvt_pk_bf16_f32 v183, v186, v187
    s_nop 0
    v_permlane32_swap_b32 v180, v182
    v_permlane32_swap_b32 v181, v183
    s_nop 0
    v_permlane16_swap_b32 v180, v182
    v_permlane16_swap_b32 v181, v183
    v_mfma_f32_16x16x32_bf16 v[80:83], a[200:203], v[172:175], v[80:83]
    v_mul_f32 v188, s50, v188
    v_mul_f32 v189, s50, v189
    v_mul_f32 v190, s50, v190
    v_mul_f32 v191, s50, v191
    v_mul_f32 v192, s50, v192
    v_mul_f32 v193, s50, v193
    v_mul_f32 v194, s50, v194
    v_mul_f32 v195, s50, v195
    v_cvt_pk_bf16_f32 v188, v188, v189
    v_cvt_pk_bf16_f32 v189, v190, v191
    v_cvt_pk_bf16_f32 v190, v192, v193
    v_cvt_pk_bf16_f32 v191, v194, v195
    s_nop 0
    v_permlane32_swap_b32 v188, v190
    v_permlane32_swap_b32 v189, v191
    s_nop 0
    v_permlane16_swap_b32 v188, v190
    v_permlane16_swap_b32 v189, v191
    ds_read_b128 a[192:195], v4 offset:4352
    s_waitcnt lgkmcnt(1)
    v_mfma_f32_16x16x32_bf16 v[40:43], a[204:207], v[180:183], v[40:43]
    v_mul_f32 v196, s50, v196
    v_mul_f32 v197, s50, v197
    v_mul_f32 v198, s50, v198
    v_mul_f32 v199, s50, v199
    v_mul_f32 v200, s50, v200
    v_mul_f32 v201, s50, v201
    v_mul_f32 v202, s50, v202
    v_mul_f32 v203, s50, v203
    v_cvt_pk_bf16_f32 v196, v196, v197
    v_cvt_pk_bf16_f32 v197, v198, v199
    v_cvt_pk_bf16_f32 v198, v200, v201
    v_cvt_pk_bf16_f32 v199, v202, v203
    s_nop 0
    v_permlane32_swap_b32 v196, v198
    v_permlane32_swap_b32 v197, v199
    s_nop 0
    v_permlane16_swap_b32 v196, v198
    v_permlane16_swap_b32 v197, v199
    v_mfma_f32_16x16x32_bf16 v[48:51], a[204:207], v[188:191], v[48:51]
    v_mul_f32 v204, s50, v204
    v_mul_f32 v205, s50, v205
    v_mul_f32 v206, s50, v206
    v_mul_f32 v207, s50, v207
    v_mul_f32 v208, s50, v208
    v_mul_f32 v209, s50, v209
    v_mul_f32 v210, s50, v210
    v_mul_f32 v211, s50, v211
    v_cvt_pk_bf16_f32 v204, v204, v205
    v_cvt_pk_bf16_f32 v205, v206, v207
    v_cvt_pk_bf16_f32 v206, v208, v209
    v_cvt_pk_bf16_f32 v207, v210, v211
    s_nop 0
    v_permlane32_swap_b32 v204, v206
    v_permlane32_swap_b32 v205, v207
    s_nop 0
    v_permlane16_swap_b32 v204, v206
    v_permlane16_swap_b32 v205, v207
    v_mfma_f32_16x16x32_bf16 v[56:59], a[204:207], v[196:199], v[56:59]
    v_mul_f32 v212, s50, v212
    v_mul_f32 v213, s50, v213
    v_mul_f32 v214, s50, v214
    v_mul_f32 v215, s50, v215
    v_mul_f32 v216, s50, v216
    v_mul_f32 v217, s50, v217
    v_mul_f32 v218, s50, v218
    v_mul_f32 v219, s50, v219
    v_cvt_pk_bf16_f32 v212, v212, v213
    v_cvt_pk_bf16_f32 v213, v214, v215
    v_cvt_pk_bf16_f32 v214, v216, v217
    v_cvt_pk_bf16_f32 v215, v218, v219
    s_nop 0
    v_permlane32_swap_b32 v212, v214
    v_permlane32_swap_b32 v213, v215
    s_nop 0
    v_permlane16_swap_b32 v212, v214
    v_permlane16_swap_b32 v213, v215
    v_mfma_f32_16x16x32_bf16 v[64:67], a[204:207], v[204:207], v[64:67]
    v_mul_f32 v220, s50, v220
    v_mul_f32 v221, s50, v221
    v_mul_f32 v222, s50, v222
    v_mul_f32 v223, s50, v223
    v_mul_f32 v224, s50, v224
    v_mul_f32 v225, s50, v225
    v_mul_f32 v226, s50, v226
    v_mul_f32 v227, s50, v227
    v_cvt_pk_bf16_f32 v220, v220, v221
    v_cvt_pk_bf16_f32 v221, v222, v223
    v_cvt_pk_bf16_f32 v222, v224, v225
    v_cvt_pk_bf16_f32 v223, v226, v227
    s_nop 0
    v_permlane32_swap_b32 v220, v222
    v_permlane32_swap_b32 v221, v223
    s_nop 0
    v_permlane16_swap_b32 v220, v222
    v_permlane16_swap_b32 v221, v223
    v_mfma_f32_16x16x32_bf16 v[72:75], a[204:207], v[212:215], v[72:75]
    ds_read_b128 a[196:199], v4 offset:4416
    ds_read_b128 a[200:203], v4 offset:4480
    v_mfma_f32_16x16x32_bf16 v[80:83], a[204:207], v[220:223], v[80:83]
    ds_read_b128 a[204:207], v4 offset:4544
    s_sub_u32 s100, s98, s99
    s_waitcnt lgkmcnt(3)
    v_mfma_f32_16x16x32_bf16 v[88:91], a[192:195], v[36:39], 0
    s_add_u32 m0, s43, s99
    s_mov_b32 s3, s98
    v_mfma_f32_16x16x32_bf16 v[96:99], a[192:195], v[44:47], 0
    buffer_load_dwordx4 v9, s[8:11], s48 offen offset:0 nt lds
    v_mfma_f32_16x16x32_bf16 v[104:107], a[192:195], v[52:55], 0
    buffer_load_dwordx4 v10, s[8:11], s48 offen offset:1088 nt lds
    v_mfma_f32_16x16x32_bf16 v[112:115], a[192:195], v[60:63], 0
    buffer_load_dwordx4 v11, s[8:11], s48 offen offset:2176 nt lds
    v_mfma_f32_16x16x32_bf16 v[120:123], a[192:195], v[68:71], 0
    buffer_load_dwordx4 v12, s[8:11], s48 offen offset:3264 nt lds
    v_mfma_f32_16x16x32_bf16 v[128:131], a[192:195], v[76:79], 0
    s_add_u32 s48, s48, s96
    s_add_u32 m0, s44, s99
    s_waitcnt lgkmcnt(2)
    v_mfma_f32_16x16x32_bf16 v[88:91], a[196:199], v[84:87], v[88:91]
    buffer_load_dwordx4 v13, s[12:15], s49 offen offset:0 nt lds
    v_mfma_f32_16x16x32_bf16 v[96:99], a[196:199], v[92:95], v[96:99]
    buffer_load_dwordx4 v14, s[12:15], s49 offen offset:1088 nt lds
    v_mfma_f32_16x16x32_bf16 v[104:107], a[196:199], v[100:103], v[104:107]
    buffer_load_dwordx4 v15, s[12:15], s49 offen offset:2176 nt lds
    v_mfma_f32_16x16x32_bf16 v[112:115], a[196:199], v[108:111], v[112:115]
    buffer_load_dwordx4 v16, s[12:15], s49 offen offset:3264 nt lds
    v_mfma_f32_16x16x32_bf16 v[120:123], a[196:199], v[116:119], v[120:123]
    s_add_u32 s49, s49, s96
    v_max3_f32 v228, v40, v41, v42
    v_mfma_f32_16x16x32_bf16 v[128:131], a[196:199], v[124:127], v[128:131]
    v_max_f32 v228, v228, v43
    v_mov_b32 v229, v228
    s_waitcnt lgkmcnt(1)
    v_mfma_f32_16x16x32_bf16 v[88:91], a[200:203], v[132:135], v[88:91]
    v_permlane32_swap_b32 v229, v228
    v_max_f32 v228, v228, v229
    v_mfma_f32_16x16x32_bf16 v[96:99], a[200:203], v[140:143], v[96:99]
    s_mov_b32 s99, s98
    s_add_u32 s98, s98, 34816
    v_mfma_f32_16x16x32_bf16 v[104:107], a[200:203], v[148:151], v[104:107]
    s_cmp_eq_u32 s98, 139264
    s_cselect_b32 s98, 0, s98
    v_mfma_f32_16x16x32_bf16 v[112:115], a[200:203], v[156:159], v[112:115]
    s_sub_u32 s100, s98, s99
    v_mov_b32 v229, v228
    v_mfma_f32_16x16x32_bf16 v[120:123], a[200:203], v[164:167], v[120:123]
    s_waitcnt lgkmcnt(0)
    s_waitcnt vmcnt(16)
    s_barrier
    v_mfma_f32_16x16x32_bf16 v[128:131], a[200:203], v[172:175], v[128:131]
    v_add_u32 v4, s100, v4
    ds_read_b128 a[192:195], v4 offset:0
    v_mfma_f32_16x16x32_bf16 v[88:91], a[204:207], v[180:183], v[88:91]
    v_permlane16_swap_b32 v229, v228
    v_max_f32 v228, v228, v229
    v_mfma_f32_16x16x32_bf16 v[96:99], a[204:207], v[188:191], v[96:99]
    v_sub_f32 v228, 0, v228
    v_mov_b32 v229, v228
    v_mfma_f32_16x16x32_bf16 v[104:107], a[204:207], v[196:199], v[104:107]
    v_mov_b32 v230, v228
    v_mov_b32 v231, v228
    v_mfma_f32_16x16x32_bf16 v[112:115], a[204:207], v[204:207], v[112:115]
    ds_read_b128 a[196:199], v4 offset:64
    v_max3_f32 v232, v48, v49, v50
    v_mfma_f32_16x16x32_bf16 v[120:123], a[204:207], v[212:215], v[120:123]
    v_max_f32 v232, v232, v51
    v_mov_b32 v233, v232
    v_mfma_f32_16x16x32_bf16 v[128:131], a[204:207], v[220:223], v[128:131]
    s_nop 0
    v_permlane32_swap_b32 v233, v232
    v_max_f32 v232, v232, v233
    v_mov_b32 v233, v232
    s_nop 1
    v_permlane16_swap_b32 v233, v232
    v_max_f32 v232, v232, v233
    v_sub_f32 v232, 0, v232
    v_mov_b32 v233, v232
    v_mov_b32 v234, v232
    v_mov_b32 v235, v232
    s_waitcnt lgkmcnt(1)
    v_mfma_f32_16x16x32_bf16 v[136:139], a[192:195], v[36:39], v[228:231]
    v_max3_f32 v236, v56, v57, v58
    v_max_f32 v236, v236, v59
    v_mov_b32 v237, v236
    s_nop 1
    v_permlane32_swap_b32 v237, v236
    v_max_f32 v236, v236, v237
    v_mov_b32 v237, v236
    s_nop 1
    v_permlane16_swap_b32 v237, v236
    v_max_f32 v236, v236, v237
    v_sub_f32 v236, 0, v236
    v_mov_b32 v237, v236
    v_mov_b32 v238, v236
    v_mov_b32 v239, v236
    v_mfma_f32_16x16x32_bf16 v[144:147], a[192:195], v[44:47], v[232:235]
    v_max3_f32 v240, v64, v65, v66
    v_max_f32 v240, v240, v67
    v_mov_b32 v241, v240
    s_nop 1
    v_permlane32_swap_b32 v241, v240
    v_max_f32 v240, v240, v241
    v_mov_b32 v241, v240
    s_nop 1
    v_permlane16_swap_b32 v241, v240
    v_max_f32 v240, v240, v241
    v_sub_f32 v240, 0, v240
    v_mov_b32 v241, v240
    v_mov_b32 v242, v240
    v_mov_b32 v243, v240
    v_mfma_f32_16x16x32_bf16 v[152:155], a[192:195], v[52:55], v[236:239]
    v_max3_f32 v244, v72, v73, v74
    v_max_f32 v244, v244, v75
    v_mov_b32 v245, v244
    s_nop 1
    v_permlane32_swap_b32 v245, v244
    v_max_f32 v244, v244, v245
    v_mov_b32 v245, v244
    s_nop 1
    v_permlane16_swap_b32 v245, v244
    v_max_f32 v244, v244, v245
    v_sub_f32 v244, 0, v244
    v_mov_b32 v245, v244
    v_mov_b32 v246, v244
    v_mov_b32 v247, v244
    v_mfma_f32_16x16x32_bf16 v[160:163], a[192:195], v[60:63], v[240:243]
    v_max3_f32 v248, v80, v81, v82
    v_max_f32 v248, v248, v83
    v_mov_b32 v249, v248
    s_nop 1
    v_permlane32_swap_b32 v249, v248
    v_max_f32 v248, v248, v249
    v_mov_b32 v249, v248
    s_nop 1
    v_permlane16_swap_b32 v249, v248
    v_max_f32 v248, v248, v249
    v_sub_f32 v248, 0, v248
    v_mov_b32 v249, v248
    v_mov_b32 v250, v248
    v_mov_b32 v251, v248
    v_mfma_f32_16x16x32_bf16 v[168:171], a[192:195], v[68:71], v[244:247]
    ds_read_b128 a[200:203], v4 offset:128
    ds_read_b128 a[204:207], v4 offset:192
    v_mfma_f32_16x16x32_bf16 v[176:179], a[192:195], v[76:79], v[248:251]
    ds_read_b128 a[192:195], v4 offset:4352
    v_add_u32 v5, s98, v5
    s_waitcnt lgkmcnt(3)
    v_mfma_f32_16x16x32_bf16 v[136:139], a[196:199], v[84:87], v[136:139]
    ds_read_b64_tr_b16 a[208:209], v5 offset:0
    ds_read_b64_tr_b16 a[210:211], v5 offset:4352
    v_mfma_f32_16x16x32_bf16 v[144:147], a[196:199], v[92:95], v[144:147]
    v_add_f32 v40, v40, v228
    v_add_f32 v41, v41, v228
    v_mfma_f32_16x16x32_bf16 v[152:155], a[196:199], v[100:103], v[152:155]
    v_add_f32 v42, v42, v228
    v_add_f32 v43, v43, v228
    v_mfma_f32_16x16x32_bf16 v[160:163], a[196:199], v[108:111], v[160:163]
    v_add_f32 v88, v88, v228
    v_add_f32 v89, v89, v228
    v_mfma_f32_16x16x32_bf16 v[168:171], a[196:199], v[116:119], v[168:171]
    v_add_f32 v90, v90, v228
    v_add_f32 v91, v91, v228
    v_mfma_f32_16x16x32_bf16 v[176:179], a[196:199], v[124:127], v[176:179]
    ds_read_b128 a[196:199], v4 offset:4416
    v_mov_b32 v30, 0
    s_waitcnt lgkmcnt(5)
    v_mfma_f32_16x16x32_bf16 v[136:139], a[200:203], v[132:135], v[136:139]
    v_exp_f32 v40, v40
    v_mfma_f32_16x16x32_bf16 v[144:147], a[200:203], v[140:143], v[144:147]
    v_exp_f32 v41, v41
    v_mfma_f32_16x16x32_bf16 v[152:155], a[200:203], v[148:151], v[152:155]
    v_exp_f32 v42, v42
    v_mfma_f32_16x16x32_bf16 v[160:163], a[200:203], v[156:159], v[160:163]
    v_exp_f32 v43, v43
    v_mfma_f32_16x16x32_bf16 v[168:171], a[200:203], v[164:167], v[168:171]
    v_exp_f32 v88, v88
    v_mfma_f32_16x16x32_bf16 v[176:179], a[200:203], v[172:175], v[176:179]
    ds_read_b128 a[200:203], v4 offset:4480
    v_add_f32 v30, v30, v40
    s_waitcnt lgkmcnt(5)
    v_mfma_f32_16x16x32_bf16 v[136:139], a[204:207], v[180:183], v[136:139]
    v_exp_f32 v89, v89
    v_mfma_f32_16x16x32_bf16 v[144:147], a[204:207], v[188:191], v[144:147]
    v_exp_f32 v90, v90
    v_mfma_f32_16x16x32_bf16 v[152:155], a[204:207], v[196:199], v[152:155]
    v_exp_f32 v91, v91
    v_mfma_f32_16x16x32_bf16 v[160:163], a[204:207], v[204:207], v[160:163]
    v_add_f32 v30, v30, v41
    v_add_f32 v30, v30, v42
    v_mfma_f32_16x16x32_bf16 v[168:171], a[204:207], v[212:215], v[168:171]
    v_add_f32 v30, v30, v43
    v_cvt_pk_bf16_f32 v40, v40, v41
    v_mfma_f32_16x16x32_bf16 v[176:179], a[204:207], v[220:223], v[176:179]
    ds_read_b128 a[204:207], v4 offset:4544
    v_cvt_pk_bf16_f32 v41, v42, v43
    s_waitcnt lgkmcnt(5)
    v_mfma_f32_16x16x32_bf16 v[184:187], a[192:195], v[36:39], v[228:231]
    v_cvt_pk_bf16_f32 v42, v88, v89
    v_cvt_pk_bf16_f32 v43, v90, v91
    v_mfma_f32_16x16x32_bf16 v[192:195], a[192:195], v[44:47], v[232:235]
    v_add_f32 v48, v48, v232
    v_add_f32 v49, v49, v232
    v_mfma_f32_16x16x32_bf16 v[200:203], a[192:195], v[52:55], v[236:239]
    v_add_f32 v50, v50, v232
    v_add_f32 v51, v51, v232
    v_mfma_f32_16x16x32_bf16 v[208:211], a[192:195], v[60:63], v[240:243]
    v_add_f32 v96, v96, v232
    v_add_f32 v97, v97, v232
    v_mfma_f32_16x16x32_bf16 v[216:219], a[192:195], v[68:71], v[244:247]
    v_add_f32 v98, v98, v232
    v_add_f32 v99, v99, v232
    v_mfma_f32_16x16x32_bf16 v[224:227], a[192:195], v[76:79], v[248:251]
    v_mov_b32 v31, 0
    v_add_u32 v6, s98, v6
    s_waitcnt lgkmcnt(2)
    v_mfma_f32_16x16x32_bf16 v[184:187], a[196:199], v[84:87], v[184:187]
    v_exp_f32 v48, v48
    v_mfma_f32_16x16x32_bf16 v[192:195], a[196:199], v[92:95], v[192:195]
    v_exp_f32 v49, v49
    v_mfma_f32_16x16x32_bf16 v[200:203], a[196:199], v[100:103], v[200:203]
    v_exp_f32 v50, v50
    v_mfma_f32_16x16x32_bf16 v[208:211], a[196:199], v[108:111], v[208:211]
    v_exp_f32 v51, v51
    v_mfma_f32_16x16x32_bf16 v[216:219], a[196:199], v[116:119], v[216:219]
    v_exp_f32 v96, v96
    v_mfma_f32_16x16x32_bf16 v[224:227], a[196:199], v[124:127], v[224:227]
    v_exp_f32 v97, v97
    s_waitcnt lgkmcnt(1)
    v_mfma_f32_16x16x32_bf16 v[184:187], a[200:203], v[132:135], v[184:187]
    v_exp_f32 v98, v98
    v_mfma_f32_16x16x32_bf16 v[192:195], a[200:203], v[140:143], v[192:195]
    v_exp_f32 v99, v99
    v_mfma_f32_16x16x32_bf16 v[200:203], a[200:203], v[148:151], v[200:203]
    v_add_f32 v31, v31, v48
    v_add_f32 v31, v31, v49
    v_mfma_f32_16x16x32_bf16 v[208:211], a[200:203], v[156:159], v[208:211]
    v_add_f32 v31, v31, v50
    v_add_f32 v31, v31, v51
    v_mfma_f32_16x16x32_bf16 v[216:219], a[200:203], v[164:167], v[216:219]
    v_cvt_pk_bf16_f32 v48, v48, v49
    v_cvt_pk_bf16_f32 v49, v50, v51
    v_mfma_f32_16x16x32_bf16 v[224:227], a[200:203], v[172:175], v[224:227]
    v_cvt_pk_bf16_f32 v50, v96, v97
    v_cvt_pk_bf16_f32 v51, v98, v99
    s_waitcnt lgkmcnt(0)
    v_mfma_f32_16x16x32_bf16 v[184:187], a[204:207], v[180:183], v[184:187]
    ds_read_b64_tr_b16 a[212:213], v6 offset:0
    ds_read_b64_tr_b16 a[214:215], v6 offset:4352
    v_mfma_f32_16x16x32_bf16 v[192:195], a[204:207], v[188:191], v[192:195]
    v_add_f32 v56, v56, v236
    v_add_f32 v57, v57, v236
    v_mfma_f32_16x16x32_bf16 v[200:203], a[204:207], v[196:199], v[200:203]
    v_add_f32 v58, v58, v236
    v_add_f32 v59, v59, v236
    v_mfma_f32_16x16x32_bf16 v[208:211], a[204:207], v[204:207], v[208:211]
    v_add_f32 v104, v104, v236
    v_add_f32 v105, v105, v236
    v_mfma_f32_16x16x32_bf16 v[216:219], a[204:207], v[212:215], v[216:219]
    v_add_f32 v106, v106, v236
    v_add_f32 v107, v107, v236
    v_mfma_f32_16x16x32_bf16 v[224:227], a[204:207], v[220:223], v[224:227]
    v_mov_b32 v32, 0
    v_add_f32 v64, v64, v240
    v_mfma_f32_16x16x32_bf16 a[0:3], a[208:211], v[40:43], 0
    v_exp_f32 v56, v56
    v_exp_f32 v57, v57
    v_exp_f32 v58, v58
    v_exp_f32 v59, v59
    v_exp_f32 v104, v104
    v_exp_f32 v105, v105
    v_exp_f32 v106, v106
    v_exp_f32 v107, v107
    v_add_f32 v32, v32, v56
    v_add_f32 v32, v32, v57
    v_add_f32 v32, v32, v58
    v_add_f32 v32, v32, v59
    v_cvt_pk_bf16_f32 v56, v56, v57
    v_cvt_pk_bf16_f32 v57, v58, v59
    v_cvt_pk_bf16_f32 v58, v104, v105
    v_cvt_pk_bf16_f32 v59, v106, v107
    v_mfma_f32_16x16x32_bf16 a[4:7], a[208:211], v[48:51], 0
    v_add_f32 v65, v65, v240
    v_add_f32 v66, v66, v240
    v_add_f32 v67, v67, v240
    v_add_f32 v112, v112, v240
    v_add_f32 v113, v113, v240
    v_add_f32 v114, v114, v240
    v_add_f32 v115, v115, v240
    v_mov_b32 v33, 0
    v_exp_f32 v64, v64
    v_exp_f32 v65, v65
    v_exp_f32 v66, v66
    v_exp_f32 v67, v67
    v_exp_f32 v112, v112
    v_exp_f32 v113, v113
    v_exp_f32 v114, v114
    v_exp_f32 v115, v115
    v_add_f32 v33, v33, v64
    v_add_f32 v33, v33, v65
    v_add_f32 v33, v33, v66
    v_add_f32 v33, v33, v67
    v_cvt_pk_bf16_f32 v64, v64, v65
    v_cvt_pk_bf16_f32 v65, v66, v67
    v_cvt_pk_bf16_f32 v66, v112, v113
    v_cvt_pk_bf16_f32 v67, v114, v115
    v_mfma_f32_16x16x32_bf16 a[8:11], a[208:211], v[56:59], 0
    v_add_f32 v72, v72, v244
    v_add_f32 v73, v73, v244
    v_add_f32 v74, v74, v244
    v_add_f32 v75, v75, v244
    v_add_f32 v120, v120, v244
    v_add_f32 v121, v121, v244
    v_add_f32 v122, v122, v244
    v_add_f32 v123, v123, v244
    v_mov_b32 v34, 0
    v_exp_f32 v72, v72
    v_exp_f32 v73, v73
    v_exp_f32 v74, v74
    v_exp_f32 v75, v75
    v_exp_f32 v120, v120
    v_exp_f32 v121, v121
    v_exp_f32 v122, v122
    v_exp_f32 v123, v123
    v_add_f32 v34, v34, v72
    v_add_f32 v34, v34, v73
    v_add_f32 v34, v34, v74
    v_add_f32 v34, v34, v75
    v_cvt_pk_bf16_f32 v72, v72, v73
    v_cvt_pk_bf16_f32 v73, v74, v75
    v_cvt_pk_bf16_f32 v74, v120, v121
    v_cvt_pk_bf16_f32 v75, v122, v123
    v_mfma_f32_16x16x32_bf16 a[12:15], a[208:211], v[64:67], 0
    v_add_f32 v80, v80, v248
    v_add_f32 v81, v81, v248
    v_add_f32 v82, v82, v248
    v_add_f32 v83, v83, v248
    v_add_f32 v128, v128, v248
    v_add_f32 v129, v129, v248
    v_add_f32 v130, v130, v248
    v_add_f32 v131, v131, v248
    v_mov_b32 v35, 0
    v_exp_f32 v80, v80
    v_exp_f32 v81, v81
    v_exp_f32 v82, v82
    v_exp_f32 v83, v83
    v_exp_f32 v128, v128
    v_exp_f32 v129, v129
    v_exp_f32 v130, v130
    v_exp_f32 v131, v131
    v_add_f32 v35, v35, v80
    v_add_f32 v35, v35, v81
    v_add_f32 v35, v35, v82
    v_add_f32 v35, v35, v83
    v_cvt_pk_bf16_f32 v80, v80, v81
    v_cvt_pk_bf16_f32 v81, v82, v83
    v_cvt_pk_bf16_f32 v82, v128, v129
    v_cvt_pk_bf16_f32 v83, v130, v131
    v_mfma_f32_16x16x32_bf16 a[16:19], a[208:211], v[72:75], 0
    v_add_u32 v7, s98, v7
    ds_read_b64_tr_b16 a[216:217], v7 offset:0
    v_mfma_f32_16x16x32_bf16 a[20:23], a[208:211], v[80:83], 0
    ds_read_b64_tr_b16 a[218:219], v7 offset:4352
    v_add_u32 v8, s98, v8
    s_waitcnt lgkmcnt(2)
    v_mfma_f32_16x16x32_bf16 a[24:27], a[212:215], v[40:43], 0
    ds_read_b64_tr_b16 a[220:221], v8 offset:0
    ds_read_b64_tr_b16 a[222:223], v8 offset:4352
    v_mfma_f32_16x16x32_bf16 a[28:31], a[212:215], v[48:51], 0
    ds_read_b64_tr_b16 a[224:225], v5 offset:128
    ds_read_b64_tr_b16 a[226:227], v5 offset:4480
    v_mfma_f32_16x16x32_bf16 a[32:35], a[212:215], v[56:59], 0
    ds_read_b64_tr_b16 a[208:209], v6 offset:128
    ds_read_b64_tr_b16 a[210:211], v6 offset:4480
    v_mfma_f32_16x16x32_bf16 a[36:39], a[212:215], v[64:67], 0
    v_add_f32 v30, v30, v88
    v_add_f32 v30, v30, v89
    v_mfma_f32_16x16x32_bf16 a[40:43], a[212:215], v[72:75], 0
    v_add_f32 v30, v30, v90
    v_add_f32 v30, v30, v91
    v_mfma_f32_16x16x32_bf16 a[44:47], a[212:215], v[80:83], 0
    ds_read_b64_tr_b16 a[212:213], v7 offset:128
    ds_read_b64_tr_b16 a[214:215], v7 offset:4480
    s_waitcnt lgkmcnt(8)
    v_mfma_f32_16x16x32_bf16 a[48:51], a[216:219], v[40:43], 0
    v_add_f32 v31, v31, v96
    v_add_f32 v31, v31, v97
    v_mfma_f32_16x16x32_bf16 a[52:55], a[216:219], v[48:51], 0
    v_add_f32 v31, v31, v98
    v_add_f32 v31, v31, v99
    v_mfma_f32_16x16x32_bf16 a[56:59], a[216:219], v[56:59], 0
    v_add_f32 v32, v32, v104
    v_add_f32 v32, v32, v105
    v_mfma_f32_16x16x32_bf16 a[60:63], a[216:219], v[64:67], 0
    v_add_f32 v32, v32, v106
    v_add_f32 v32, v32, v107
    v_mfma_f32_16x16x32_bf16 a[64:67], a[216:219], v[72:75], 0
    v_add_f32 v33, v33, v112
    v_add_f32 v33, v33, v113
    v_mfma_f32_16x16x32_bf16 a[68:71], a[216:219], v[80:83], 0
    ds_read_b64_tr_b16 a[216:217], v8 offset:128
    ds_read_b64_tr_b16 a[218:219], v8 offset:4480
    s_waitcnt lgkmcnt(8)
    v_mfma_f32_16x16x32_bf16 a[72:75], a[220:223], v[40:43], 0
    v_add_f32 v33, v33, v114
    v_add_f32 v33, v33, v115
    v_mfma_f32_16x16x32_bf16 a[76:79], a[220:223], v[48:51], 0
    v_add_f32 v34, v34, v120
    v_add_f32 v34, v34, v121
    v_mfma_f32_16x16x32_bf16 a[80:83], a[220:223], v[56:59], 0
    v_add_f32 v34, v34, v122
    v_add_f32 v34, v34, v123
    v_mfma_f32_16x16x32_bf16 a[84:87], a[220:223], v[64:67], 0
    v_add_f32 v35, v35, v128
    v_add_f32 v35, v35, v129
    v_mfma_f32_16x16x32_bf16 a[88:91], a[220:223], v[72:75], 0
    v_add_f32 v35, v35, v130
    v_add_f32 v35, v35, v131
    v_mfma_f32_16x16x32_bf16 a[92:95], a[220:223], v[80:83], 0
    s_add_u32 m0, s43, s99
    s_waitcnt lgkmcnt(6)
    v_mfma_f32_16x16x32_bf16 a[96:99], a[224:227], v[40:43], 0
    buffer_load_dwordx4 v9, s[8:11], s48 offen offset:0 nt lds
    v_mfma_f32_16x16x32_bf16 a[100:103], a[224:227], v[48:51], 0
    buffer_load_dwordx4 v10, s[8:11], s48 offen offset:1088 nt lds
    v_mfma_f32_16x16x32_bf16 a[104:107], a[224:227], v[56:59], 0
    buffer_load_dwordx4 v11, s[8:11], s48 offen offset:2176 nt lds
    v_mfma_f32_16x16x32_bf16 a[108:111], a[224:227], v[64:67], 0
    buffer_load_dwordx4 v12, s[8:11], s48 offen offset:3264 nt lds
    v_mfma_f32_16x16x32_bf16 a[112:115], a[224:227], v[72:75], 0
    s_add_u32 s48, s48, s96
    s_add_u32 m0, s44, s99
    v_mfma_f32_16x16x32_bf16 a[116:119], a[224:227], v[80:83], 0
    buffer_load_dwordx4 v13, s[12:15], s49 offen offset:0 nt lds
    s_waitcnt lgkmcnt(4)
    v_mfma_f32_16x16x32_bf16 a[120:123], a[208:211], v[40:43], 0
    buffer_load_dwordx4 v14, s[12:15], s49 offen offset:1088 nt lds
    v_mfma_f32_16x16x32_bf16 a[124:127], a[208:211], v[48:51], 0
    buffer_load_dwordx4 v15, s[12:15], s49 offen offset:2176 nt lds
    v_mfma_f32_16x16x32_bf16 a[128:131], a[208:211], v[56:59], 0
    buffer_load_dwordx4 v16, s[12:15], s49 offen offset:3264 nt lds
    v_mfma_f32_16x16x32_bf16 a[132:135], a[208:211], v[64:67], 0
    s_add_u32 s49, s49, s96
    v_mfma_f32_16x16x32_bf16 a[136:139], a[208:211], v[72:75], 0
    v_exp_f32 v136, v136
    v_mfma_f32_16x16x32_bf16 a[140:143], a[208:211], v[80:83], 0
    v_exp_f32 v137, v137
    s_waitcnt lgkmcnt(2)
    v_mfma_f32_16x16x32_bf16 a[144:147], a[212:215], v[40:43], 0
    v_exp_f32 v138, v138
    v_mfma_f32_16x16x32_bf16 a[148:151], a[212:215], v[48:51], 0
    s_mov_b32 s99, s98
    s_add_u32 s98, s98, 34816
    v_mfma_f32_16x16x32_bf16 a[152:155], a[212:215], v[56:59], 0
    s_cmp_eq_u32 s98, 139264
    s_cselect_b32 s98, 0, s98
    v_mfma_f32_16x16x32_bf16 a[156:159], a[212:215], v[64:67], 0
    s_sub_u32 s100, s98, s99
    v_add_f32 v30, v30, v136
    v_mfma_f32_16x16x32_bf16 a[160:163], a[212:215], v[72:75], 0
    s_waitcnt lgkmcnt(0)
    s_waitcnt vmcnt(16)
    s_barrier
    v_mfma_f32_16x16x32_bf16 a[164:167], a[212:215], v[80:83], 0
    v_add_u32 v4, s100, v4
    ds_read_b128 a[192:195], v4 offset:0
    v_mfma_f32_16x16x32_bf16 a[168:171], a[216:219], v[40:43], 0
    ds_read_b128 a[196:199], v4 offset:64
    v_add_f32 v30, v30, v137
    v_mfma_f32_16x16x32_bf16 a[172:175], a[216:219], v[48:51], 0
    v_exp_f32 v139, v139
    v_mfma_f32_16x16x32_bf16 a[176:179], a[216:219], v[56:59], 0
    v_exp_f32 v184, v184
    v_mfma_f32_16x16x32_bf16 a[180:183], a[216:219], v[64:67], 0
    v_exp_f32 v185, v185
    v_mfma_f32_16x16x32_bf16 a[184:187], a[216:219], v[72:75], 0
    v_exp_f32 v186, v186
    v_mfma_f32_16x16x32_bf16 a[188:191], a[216:219], v[80:83], 0
    v_exp_f32 v187, v187
    v_add_f32 v30, v30, v138
    v_add_f32 v30, v30, v139
    v_add_f32 v30, v30, v184
    v_add_f32 v30, v30, v185
    v_add_f32 v30, v30, v186
    v_add_f32 v30, v30, v187
    v_cvt_pk_bf16_f32 v136, v136, v137
    v_cvt_pk_bf16_f32 v137, v138, v139
    v_cvt_pk_bf16_f32 v138, v184, v185
    v_cvt_pk_bf16_f32 v139, v186, v187
    v_exp_f32 v144, v144
    v_exp_f32 v145, v145
    v_exp_f32 v146, v146
    v_exp_f32 v147, v147
    v_exp_f32 v192, v192
    v_exp_f32 v193, v193
    v_exp_f32 v194, v194
    v_exp_f32 v195, v195
    v_add_f32 v31, v31, v144
    v_add_f32 v31, v31, v145
    v_add_f32 v31, v31, v146
    v_add_f32 v31, v31, v147
    v_add_f32 v31, v31, v192
    v_add_f32 v31, v31, v193
    v_add_f32 v31, v31, v194
    v_add_f32 v31, v31, v195
    v_cvt_pk_bf16_f32 v144, v144, v145
    v_cvt_pk_bf16_f32 v145, v146, v147
    v_cvt_pk_bf16_f32 v146, v192, v193
    v_cvt_pk_bf16_f32 v147, v194, v195
    v_exp_f32 v152, v152
    v_exp_f32 v153, v153
    v_exp_f32 v154, v154
    v_exp_f32 v155, v155
    v_exp_f32 v200, v200
    v_exp_f32 v201, v201
    v_exp_f32 v202, v202
    v_exp_f32 v203, v203
    v_add_f32 v32, v32, v152
    v_add_f32 v32, v32, v153
    v_add_f32 v32, v32, v154
    v_add_f32 v32, v32, v155
    v_add_f32 v32, v32, v200
    v_add_f32 v32, v32, v201
    v_add_f32 v32, v32, v202
    v_add_f32 v32, v32, v203
    v_cvt_pk_bf16_f32 v152, v152, v153
    v_cvt_pk_bf16_f32 v153, v154, v155
    v_cvt_pk_bf16_f32 v154, v200, v201
    v_cvt_pk_bf16_f32 v155, v202, v203
L_rejoin:
    s_mov_b32 s40, 7
L_at:
    ds_read_b128 a[200:203], v4 offset:128
    ds_read_b128 a[204:207], v4 offset:192
    s_waitcnt lgkmcnt(3)
    v_mfma_f32_16x16x32_bf16 v[40:43], a[192:195], v[36:39], v[228:231]
    v_add_u32 v5, s100, v5
    ds_read_b64_tr_b16 a[208:209], v5 offset:0
    v_mfma_f32_16x16x32_bf16 v[48:51], a[192:195], v[44:47], v[232:235]
    ds_read_b64_tr_b16 a[210:211], v5 offset:4352
    v_add_u32 v6, s100, v6
    v_mfma_f32_16x16x32_bf16 v[56:59], a[192:195], v[52:55], v[236:239]
    ds_read_b64_tr_b16 a[212:213], v6 offset:0
    ds_read_b64_tr_b16 a[214:215], v6 offset:4352
    v_mfma_f32_16x16x32_bf16 v[64:67], a[192:195], v[60:63], v[240:243]
    v_exp_f32 v160, v160
    v_mfma_f32_16x16x32_bf16 v[72:75], a[192:195], v[68:71], v[244:247]
    v_exp_f32 v161, v161
    v_mfma_f32_16x16x32_bf16 v[80:83], a[192:195], v[76:79], v[248:251]
    ds_read_b128 a[192:195], v4 offset:4352
    v_add_f32 v33, v33, v160
    s_waitcnt lgkmcnt(7)
    v_mfma_f32_16x16x32_bf16 v[40:43], a[196:199], v[84:87], v[40:43]
    v_exp_f32 v162, v162
    v_mfma_f32_16x16x32_bf16 v[48:51], a[196:199], v[92:95], v[48:51]
    v_exp_f32 v163, v163
    v_mfma_f32_16x16x32_bf16 v[56:59], a[196:199], v[100:103], v[56:59]
    v_exp_f32 v208, v208
    v_mfma_f32_16x16x32_bf16 v[64:67], a[196:199], v[108:111], v[64:67]
    v_exp_f32 v209, v209
    v_mfma_f32_16x16x32_bf16 v[72:75], a[196:199], v[116:119], v[72:75]
    v_exp_f32 v210, v210
    v_mfma_f32_16x16x32_bf16 v[80:83], a[196:199], v[124:127], v[80:83]
    ds_read_b128 a[196:199], v4 offset:4416
    v_add_f32 v33, v33, v161
    s_waitcnt lgkmcnt(7)
    v_mfma_f32_16x16x32_bf16 v[40:43], a[200:203], v[132:135], v[40:43]
    v_exp_f32 v211, v211
    v_mfma_f32_16x16x32_bf16 v[48:51], a[200:203], v[140:143], v[48:51]
    v_add_f32 v33, v33, v162
    v_add_f32 v33, v33, v163
    v_mfma_f32_16x16x32_bf16 v[56:59], a[200:203], v[148:151], v[56:59]
    v_cvt_pk_bf16_f32 v160, v160, v161
    v_cvt_pk_bf16_f32 v161, v162, v163
    v_mfma_f32_16x16x32_bf16 v[64:67], a[200:203], v[156:159], v[64:67]
    v_cvt_pk_bf16_f32 v162, v208, v209
    v_cvt_pk_bf16_f32 v163, v210, v211
    v_mfma_f32_16x16x32_bf16 v[72:75], a[200:203], v[164:167], v[72:75]
    v_exp_f32 v168, v168
    v_mfma_f32_16x16x32_bf16 v[80:83], a[200:203], v[172:175], v[80:83]
    ds_read_b128 a[200:203], v4 offset:4480
    v_add_f32 v34, v34, v168
    s_waitcnt lgkmcnt(7)
    v_mfma_f32_16x16x32_bf16 v[40:43], a[204:207], v[180:183], v[40:43]
    v_exp_f32 v169, v169
    v_mfma_f32_16x16x32_bf16 v[48:51], a[204:207], v[188:191], v[48:51]
    v_exp_f32 v170, v170
    v_mfma_f32_16x16x32_bf16 v[56:59], a[204:207], v[196:199], v[56:59]
    v_exp_f32 v171, v171
    v_mfma_f32_16x16x32_bf16 v[64:67], a[204:207], v[204:207], v[64:67]
    v_exp_f32 v216, v216
    v_mfma_f32_16x16x32_bf16 v[72:75], a[204:207], v[212:215], v[72:75]
    v_exp_f32 v217, v217
    v_mfma_f32_16x16x32_bf16 v[80:83], a[204:207], v[220:223], v[80:83]
    ds_read_b128 a[204:207], v4 offset:4544
    v_add_f32 v34, v34, v169
    s_waitcnt lgkmcnt(3)
    v_mfma_f32_16x16x32_bf16 v[88:91], a[192:195], v[36:39], v[228:231]
    v_exp_f32 v218, v218
    v_mfma_f32_16x16x32_bf16 v[96:99], a[192:195], v[44:47], v[232:235]
    v_exp_f32 v219, v219
    v_mfma_f32_16x16x32_bf16 v[104:107], a[192:195], v[52:55], v[236:239]
    v_add_f32 v34, v34, v170
    v_add_f32 v34, v34, v171
    v_mfma_f32_16x16x32_bf16 v[112:115], a[192:195], v[60:63], v[240:243]
    v_cvt_pk_bf16_f32 v168, v168, v169
    v_cvt_pk_bf16_f32 v169, v170, v171
    v_mfma_f32_16x16x32_bf16 v[120:123], a[192:195], v[68:71], v[244:247]
    v_cvt_pk_bf16_f32 v170, v216, v217
    v_cvt_pk_bf16_f32 v171, v218, v219
    v_mfma_f32_16x16x32_bf16 v[128:131], a[192:195], v[76:79], v[248:251]
    v_exp_f32 v176, v176
    s_waitcnt lgkmcnt(2)
    v_mfma_f32_16x16x32_bf16 v[88:91], a[196:199], v[84:87], v[88:91]
    v_exp_f32 v177, v177
    v_mfma_f32_16x16x32_bf16 v[96:99], a[196:199], v[92:95], v[96:99]
    v_exp_f32 v178, v178
    v_mfma_f32_16x16x32_bf16 v[104:107], a[196:199], v[100:103], v[104:107]
    v_exp_f32 v179, v179
    v_mfma_f32_16x16x32_bf16 v[112:115], a[196:199], v[108:111], v[112:115]
    v_exp_f32 v224, v224
    v_mfma_f32_16x16x32_bf16 v[120:123], a[196:199], v[116:119], v[120:123]
    v_exp_f32 v225, v225
    v_mfma_f32_16x16x32_bf16 v[128:131], a[196:199], v[124:127], v[128:131]
    v_exp_f32 v226, v226
    s_waitcnt lgkmcnt(1)
    v_mfma_f32_16x16x32_bf16 v[88:91], a[200:203], v[132:135], v[88:91]
    v_exp_f32 v227, v227
    v_mfma_f32_16x16x32_bf16 v[96:99], a[200:203], v[140:143], v[96:99]
    v_add_f32 v35, v35, v176
    v_add_f32 v35, v35, v177
    v_mfma_f32_16x16x32_bf16 v[104:107], a[200:203], v[148:151], v[104:107]
    v_add_f32 v35, v35, v178
    v_add_f32 v35, v35, v179
    v_mfma_f32_16x16x32_bf16 v[112:115], a[200:203], v[156:159], v[112:115]
    v_cvt_pk_bf16_f32 v176, v176, v177
    v_cvt_pk_bf16_f32 v177, v178, v179
    v_mfma_f32_16x16x32_bf16 v[120:123], a[200:203], v[164:167], v[120:123]
    v_cvt_pk_bf16_f32 v178, v224, v225
    v_cvt_pk_bf16_f32 v179, v226, v227
    v_mfma_f32_16x16x32_bf16 v[128:131], a[200:203], v[172:175], v[128:131]
    v_add_u32 v7, s100, v7
    ds_read_b64_tr_b16 a[216:217], v7 offset:0
    s_waitcnt lgkmcnt(1)
    v_mfma_f32_16x16x32_bf16 v[88:91], a[204:207], v[180:183], v[88:91]
    ds_read_b64_tr_b16 a[218:219], v7 offset:4352
    v_add_u32 v8, s100, v8
    v_mfma_f32_16x16x32_bf16 v[96:99], a[204:207], v[188:191], v[96:99]
    ds_read_b64_tr_b16 a[220:221], v8 offset:0
    ds_read_b64_tr_b16 a[222:223], v8 offset:4352
    v_mfma_f32_16x16x32_bf16 v[104:107], a[204:207], v[196:199], v[104:107]
    ds_read_b64_tr_b16 a[224:225], v5 offset:128
    ds_read_b64_tr_b16 a[226:227], v5 offset:4480
    v_mfma_f32_16x16x32_bf16 v[112:115], a[204:207], v[204:207], v[112:115]
    v_add_f32 v33, v33, v208
    v_add_f32 v33, v33, v209
    v_mfma_f32_16x16x32_bf16 v[120:123], a[204:207], v[212:215], v[120:123]
    v_add_f32 v33, v33, v210
    v_add_f32 v33, v33, v211
    v_mfma_f32_16x16x32_bf16 v[128:131], a[204:207], v[220:223], v[128:131]
    v_add_f32 v34, v34, v216
    v_add_f32 v34, v34, v217
    v_mfma_f32_16x16x32_bf16 a[0:3], a[208:211], v[136:139], a[0:3]
    v_add_f32 v34, v34, v218
    v_add_f32 v34, v34, v219
    v_mfma_f32_16x16x32_bf16 a[4:7], a[208:211], v[144:147], a[4:7]
    v_add_f32 v35, v35, v224
    v_add_f32 v35, v35, v225
    v_mfma_f32_16x16x32_bf16 a[8:11], a[208:211], v[152:155], a[8:11]
    v_add_f32 v35, v35, v226
    v_add_f32 v35, v35, v227
    v_mfma_f32_16x16x32_bf16 a[12:15], a[208:211], v[160:163], a[12:15]
    s_add_u32 m0, s43, s99
    v_mfma_f32_16x16x32_bf16 a[16:19], a[208:211], v[168:171], a[16:19]
    buffer_load_dwordx4 v9, s[8:11], s48 offen offset:0 nt lds
    v_mfma_f32_16x16x32_bf16 a[20:23], a[208:211], v[176:179], a[20:23]
    ds_read_b64_tr_b16 a[208:209], v6 offset:128
    ds_read_b64_tr_b16 a[210:211], v6 offset:4480
    v_mfma_f32_16x16x32_bf16 a[24:27], a[212:215], v[136:139], a[24:27]
    buffer_load_dwordx4 v10, s[8:11], s48 offen offset:1088 nt lds
    v_mfma_f32_16x16x32_bf16 a[28:31], a[212:215], v[144:147], a[28:31]
    buffer_load_dwordx4 v11, s[8:11], s48 offen offset:2176 nt lds
    v_mfma_f32_16x16x32_bf16 a[32:35], a[212:215], v[152:155], a[32:35]
    buffer_load_dwordx4 v12, s[8:11], s48 offen offset:3264 nt lds
    v_mfma_f32_16x16x32_bf16 a[36:39], a[212:215], v[160:163], a[36:39]
    s_add_u32 s48, s48, s96
    s_add_u32 m0, s44, s99
    v_mfma_f32_16x16x32_bf16 a[40:43], a[212:215], v[168:171], a[40:43]
    buffer_load_dwordx4 v13, s[12:15], s49 offen offset:0 nt lds
    v_mfma_f32_16x16x32_bf16 a[44:47], a[212:215], v[176:179], a[44:47]
    ds_read_b64_tr_b16 a[212:213], v7 offset:128
    ds_read_b64_tr_b16 a[214:215], v7 offset:4480
    s_waitcnt lgkmcnt(8)
    v_mfma_f32_16x16x32_bf16 a[48:51], a[216:219], v[136:139], a[48:51]
    buffer_load_dwordx4 v14, s[12:15], s49 offen offset:1088 nt lds
    v_mfma_f32_16x16x32_bf16 a[52:55], a[216:219], v[144:147], a[52:55]
    buffer_load_dwordx4 v15, s[12:15], s49 offen offset:2176 nt lds
    v_mfma_f32_16x16x32_bf16 a[56:59], a[216:219], v[152:155], a[56:59]
    v_exp_f32 v40, v40
    v_mfma_f32_16x16x32_bf16 a[60:63], a[216:219], v[160:163], a[60:63]
    v_exp_f32 v41, v41
    v_mfma_f32_16x16x32_bf16 a[64:67], a[216:219], v[168:171], a[64:67]
    v_exp_f32 v42, v42
    v_mfma_f32_16x16x32_bf16 a[68:71], a[216:219], v[176:179], a[68:71]
    ds_read_b64_tr_b16 a[216:217], v8 offset:128
    ds_read_b64_tr_b16 a[218:219], v8 offset:4480
    s_waitcnt lgkmcnt(8)
    v_mfma_f32_16x16x32_bf16 a[72:75], a[220:223], v[136:139], a[72:75]
    v_exp_f32 v43, v43
    v_mfma_f32_16x16x32_bf16 a[76:79], a[220:223], v[144:147], a[76:79]
    v_exp_f32 v88, v88
    v_mfma_f32_16x16x32_bf16 a[80:83], a[220:223], v[152:155], a[80:83]
    v_exp_f32 v89, v89
    v_mfma_f32_16x16x32_bf16 a[84:87], a[220:223], v[160:163], a[84:87]
    v_exp_f32 v90, v90
    v_mfma_f32_16x16x32_bf16 a[88:91], a[220:223], v[168:171], a[88:91]
    buffer_load_dwordx4 v16, s[12:15], s49 offen offset:3264 nt lds
    v_mfma_f32_16x16x32_bf16 a[92:95], a[220:223], v[176:179], a[92:95]
    s_add_u32 s49, s49, s96
    v_add_f32 v30, v30, v40
    s_waitcnt lgkmcnt(6)
    v_mfma_f32_16x16x32_bf16 a[96:99], a[224:227], v[136:139], a[96:99]
    v_exp_f32 v91, v91
    v_mfma_f32_16x16x32_bf16 a[100:103], a[224:227], v[144:147], a[100:103]
    v_add_f32 v30, v30, v41
    v_add_f32 v30, v30, v42
    v_mfma_f32_16x16x32_bf16 a[104:107], a[224:227], v[152:155], a[104:107]
    v_add_f32 v30, v30, v43
    v_add_f32 v30, v30, v88
    v_mfma_f32_16x16x32_bf16 a[108:111], a[224:227], v[160:163], a[108:111]
    v_add_f32 v30, v30, v89
    v_add_f32 v30, v30, v90
    v_mfma_f32_16x16x32_bf16 a[112:115], a[224:227], v[168:171], a[112:115]
    v_add_f32 v30, v30, v91
    v_cvt_pk_bf16_f32 v40, v40, v41
    v_mfma_f32_16x16x32_bf16 a[116:119], a[224:227], v[176:179], a[116:119]
    v_cvt_pk_bf16_f32 v41, v42, v43
    v_cvt_pk_bf16_f32 v42, v88, v89
    s_waitcnt lgkmcnt(4)
    v_mfma_f32_16x16x32_bf16 a[120:123], a[208:211], v[136:139], a[120:123]
    v_cvt_pk_bf16_f32 v43, v90, v91
    v_mfma_f32_16x16x32_bf16 a[124:127], a[208:211], v[144:147], a[124:127]
    v_exp_f32 v48, v48
    v_mfma_f32_16x16x32_bf16 a[128:131], a[208:211], v[152:155], a[128:131]
    v_exp_f32 v49, v49
    v_mfma_f32_16x16x32_bf16 a[132:135], a[208:211], v[160:163], a[132:135]
    v_exp_f32 v50, v50
    v_mfma_f32_16x16x32_bf16 a[136:139], a[208:211], v[168:171], a[136:139]
    v_exp_f32 v51, v51
    v_mfma_f32_16x16x32_bf16 a[140:143], a[208:211], v[176:179], a[140:143]
    v_exp_f32 v96, v96
    s_waitcnt lgkmcnt(2)
    v_mfma_f32_16x16x32_bf16 a[144:147], a[212:215], v[136:139], a[144:147]
    v_exp_f32 v97, v97
    v_mfma_f32_16x16x32_bf16 a[148:151], a[212:215], v[144:147], a[148:151]
    s_mov_b32 s99, s98
    s_add_u32 s98, s98, 34816
    v_mfma_f32_16x16x32_bf16 a[152:155], a[212:215], v[152:155], a[152:155]
    s_cmp_eq_u32 s98, 139264
    s_cselect_b32 s98, 0, s98
    v_mfma_f32_16x16x32_bf16 a[156:159], a[212:215], v[160:163], a[156:159]
    s_sub_u32 s100, s98, s99
    v_add_f32 v31, v31, v48
    v_mfma_f32_16x16x32_bf16 a[160:163], a[212:215], v[168:171], a[160:163]
    s_waitcnt lgkmcnt(0)
    s_waitcnt vmcnt(16)
    s_barrier
    v_mfma_f32_16x16x32_bf16 a[164:167], a[212:215], v[176:179], a[164:167]
    v_add_u32 v4, s100, v4
    ds_read_b128 a[192:195], v4 offset:0
    v_mfma_f32_16x16x32_bf16 a[168:171], a[216:219], v[136:139], a[168:171]
    ds_read_b128 a[196:199], v4 offset:64
    v_add_f32 v31, v31, v49
    v_mfma_f32_16x16x32_bf16 a[172:175], a[216:219], v[144:147], a[172:175]
    v_exp_f32 v98, v98
    v_mfma_f32_16x16x32_bf16 a[176:179], a[216:219], v[152:155], a[176:179]
    v_exp_f32 v99, v99
    v_mfma_f32_16x16x32_bf16 a[180:183], a[216:219], v[160:163], a[180:183]
    v_add_f32 v31, v31, v50
    v_add_f32 v31, v31, v51
    v_mfma_f32_16x16x32_bf16 a[184:187], a[216:219], v[168:171], a[184:187]
    v_add_f32 v31, v31, v96
    v_add_f32 v31, v31, v97
    v_mfma_f32_16x16x32_bf16 a[188:191], a[216:219], v[176:179], a[188:191]
    v_add_f32 v31, v31, v98
    v_add_f32 v31, v31, v99
    v_cvt_pk_bf16_f32 v48, v48, v49
    v_cvt_pk_bf16_f32 v49, v50, v51
    v_cvt_pk_bf16_f32 v50, v96, v97
    v_cvt_pk_bf16_f32 v51, v98, v99
    v_exp_f32 v56, v56
    v_exp_f32 v57, v57
    v_exp_f32 v58, v58
    v_exp_f32 v59, v59
    v_exp_f32 v104, v104
    v_exp_f32 v105, v105
    v_exp_f32 v106, v106
    v_exp_f32 v107, v107
    v_add_f32 v32, v32, v56
    v_add_f32 v32, v32, v57
    v_add_f32 v32, v32, v58
    v_add_f32 v32, v32, v59
    v_add_f32 v32, v32, v104
    v_add_f32 v32, v32, v105
    v_add_f32 v32, v32, v106
    v_add_f32 v32, v32, v107
    v_cvt_pk_bf16_f32 v56, v56, v57
    v_cvt_pk_bf16_f32 v57, v58, v59
    v_cvt_pk_bf16_f32 v58, v104, v105
    v_cvt_pk_bf16_f32 v59, v106, v107
    ds_read_b128 a[200:203], v4 offset:128
    ds_read_b128 a[204:207], v4 offset:192
    s_waitcnt lgkmcnt(3)
    v_mfma_f32_16x16x32_bf16 v[136:139], a[192:195], v[36:39], v[228:231]
    v_add_u32 v5, s100, v5
    ds_read_b64_tr_b16 a[208:209], v5 offset:0
    v_mfma_f32_16x16x32_bf16 v[144:147], a[192:195], v[44:47], v[232:235]
    ds_read_b64_tr_b16 a[210:211], v5 offset:4352
    v_add_u32 v6, s100, v6
    v_mfma_f32_16x16x32_bf16 v[152:155], a[192:195], v[52:55], v[236:239]
    ds_read_b64_tr_b16 a[212:213], v6 offset:0
    ds_read_b64_tr_b16 a[214:215], v6 offset:4352
    v_mfma_f32_16x16x32_bf16 v[160:163], a[192:195], v[60:63], v[240:243]
    v_exp_f32 v64, v64
    v_mfma_f32_16x16x32_bf16 v[168:171], a[192:195], v[68:71], v[244:247]
    v_exp_f32 v65, v65
    v_mfma_f32_16x16x32_bf16 v[176:179], a[192:195], v[76:79], v[248:251]
    ds_read_b128 a[192:195], v4 offset:4352
    v_add_f32 v33, v33, v64
    s_waitcnt lgkmcnt(7)
    v_mfma_f32_16x16x32_bf16 v[136:139], a[196:199], v[84:87], v[136:139]
    v_exp_f32 v66, v66
    v_mfma_f32_16x16x32_bf16 v[144:147], a[196:199], v[92:95], v[144:147]
    v_exp_f32 v67, v67
    v_mfma_f32_16x16x32_bf16 v[152:155], a[196:199], v[100:103], v[152:155]
    v_exp_f32 v112, v112
    v_mfma_f32_16x16x32_bf16 v[160:163], a[196:199], v[108:111], v[160:163]
    v_exp_f32 v113, v113
    v_mfma_f32_16x16x32_bf16 v[168:171], a[196:199], v[116:119], v[168:171]
    v_exp_f32 v114, v114
    v_mfma_f32_16x16x32_bf16 v[176:179], a[196:199], v[124:127], v[176:179]
    ds_read_b128 a[196:199], v4 offset:4416
    v_add_f32 v33, v33, v65
    s_waitcnt lgkmcnt(7)
    v_mfma_f32_16x16x32_bf16 v[136:139], a[200:203], v[132:135], v[136:139]
    v_exp_f32 v115, v115
    v_mfma_f32_16x16x32_bf16 v[144:147], a[200:203], v[140:143], v[144:147]
    v_add_f32 v33, v33, v66
    v_add_f32 v33, v33, v67
    v_mfma_f32_16x16x32_bf16 v[152:155], a[200:203], v[148:151], v[152:155]
    v_cvt_pk_bf16_f32 v64, v64, v65
    v_cvt_pk_bf16_f32 v65, v66, v67
    v_mfma_f32_16x16x32_bf16 v[160:163], a[200:203], v[156:159], v[160:163]
    v_cvt_pk_bf16_f32 v66, v112, v113
    v_cvt_pk_bf16_f32 v67, v114, v115
    v_mfma_f32_16x16x32_bf16 v[168:171], a[200:203], v[164:167], v[168:171]
    v_exp_f32 v72, v72
    v_mfma_f32_16x16x32_bf16 v[176:179], a[200:203], v[172:175], v[176:179]
    ds_read_b128 a[200:203], v4 offset:4480
    v_add_f32 v34, v34, v72
    s_waitcnt lgkmcnt(7)
    v_mfma_f32_16x16x32_bf16 v[136:139], a[204:207], v[180:183], v[136:139]
    v_exp_f32 v73, v73
    v_mfma_f32_16x16x32_bf16 v[144:147], a[204:207], v[188:191], v[144:147]
    v_exp_f32 v74, v74
    v_mfma_f32_16x16x32_bf16 v[152:155], a[204:207], v[196:199], v[152:155]
    v_exp_f32 v75, v75
    v_mfma_f32_16x16x32_bf16 v[160:163], a[204:207], v[204:207], v[160:163]
    v_exp_f32 v120, v120
    v_mfma_f32_16x16x32_bf16 v[168:171], a[204:207], v[212:215], v[168:171]
    v_exp_f32 v121, v121
    v_mfma_f32_16x16x32_bf16 v[176:179], a[204:207], v[220:223], v[176:179]
    ds_read_b128 a[204:207], v4 offset:4544
    v_add_f32 v34, v34, v73
    s_waitcnt lgkmcnt(3)
    v_mfma_f32_16x16x32_bf16 v[184:187], a[192:195], v[36:39], v[228:231]
    v_exp_f32 v122, v122
    v_mfma_f32_16x16x32_bf16 v[192:195], a[192:195], v[44:47], v[232:235]
    v_exp_f32 v123, v123
    v_mfma_f32_16x16x32_bf16 v[200:203], a[192:195], v[52:55], v[236:239]
    v_add_f32 v34, v34, v74
    v_add_f32 v34, v34, v75
    v_mfma_f32_16x16x32_bf16 v[208:211], a[192:195], v[60:63], v[240:243]
    v_cvt_pk_bf16_f32 v72, v72, v73
    v_cvt_pk_bf16_f32 v73, v74, v75
    v_mfma_f32_16x16x32_bf16 v[216:219], a[192:195], v[68:71], v[244:247]
    v_cvt_pk_bf16_f32 v74, v120, v121
    v_cvt_pk_bf16_f32 v75, v122, v123
    v_mfma_f32_16x16x32_bf16 v[224:227], a[192:195], v[76:79], v[248:251]
    v_exp_f32 v80, v80
    s_waitcnt lgkmcnt(2)
    v_mfma_f32_16x16x32_bf16 v[184:187], a[196:199], v[84:87], v[184:187]
    v_exp_f32 v81, v81
    v_mfma_f32_16x16x32_bf16 v[192:195], a[196:199], v[92:95], v[192:195]
    v_exp_f32 v82, v82
    v_mfma_f32_16x16x32_bf16 v[200:203], a[196:199], v[100:103], v[200:203]
    v_exp_f32 v83, v83
    v_mfma_f32_16x16x32_bf16 v[208:211], a[196:199], v[108:111], v[208:211]
    v_exp_f32 v128, v128
    v_mfma_f32_16x16x32_bf16 v[216:219], a[196:199], v[116:119], v[216:219]
    v_exp_f32 v129, v129
    v_mfma_f32_16x16x32_bf16 v[224:227], a[196:199], v[124:127], v[224:227]
    v_exp_f32 v130, v130
    s_waitcnt lgkmcnt(1)
    v_mfma_f32_16x16x32_bf16 v[184:187], a[200:203], v[132:135], v[184:187]
    v_exp_f32 v131, v131
    v_mfma_f32_16x16x32_bf16 v[192:195], a[200:203], v[140:143], v[192:195]
    v_add_f32 v35, v35, v80
    v_add_f32 v35, v35, v81
    v_mfma_f32_16x16x32_bf16 v[200:203], a[200:203], v[148:151], v[200:203]
    v_add_f32 v35, v35, v82
    v_add_f32 v35, v35, v83
    v_mfma_f32_16x16x32_bf16 v[208:211], a[200:203], v[156:159], v[208:211]
    v_cvt_pk_bf16_f32 v80, v80, v81
    v_cvt_pk_bf16_f32 v81, v82, v83
    v_mfma_f32_16x16x32_bf16 v[216:219], a[200:203], v[164:167], v[216:219]
    v_cvt_pk_bf16_f32 v82, v128, v129
    v_cvt_pk_bf16_f32 v83, v130, v131
    v_mfma_f32_16x16x32_bf16 v[224:227], a[200:203], v[172:175], v[224:227]
    v_add_u32 v7, s100, v7
    ds_read_b64_tr_b16 a[216:217], v7 offset:0
    s_waitcnt lgkmcnt(1)
    v_mfma_f32_16x16x32_bf16 v[184:187], a[204:207], v[180:183], v[184:187]
    ds_read_b64_tr_b16 a[218:219], v7 offset:4352
    v_add_u32 v8, s100, v8
    v_mfma_f32_16x16x32_bf16 v[192:195], a[204:207], v[188:191], v[192:195]
    ds_read_b64_tr_b16 a[220:221], v8 offset:0
    ds_read_b64_tr_b16 a[222:223], v8 offset:4352
    v_mfma_f32_16x16x32_bf16 v[200:203], a[204:207], v[196:199], v[200:203]
    ds_read_b64_tr_b16 a[224:225], v5 offset:128
    ds_read_b64_tr_b16 a[226:227], v5 offset:4480
    v_mfma_f32_16x16x32_bf16 v[208:211], a[204:207], v[204:207], v[208:211]
    v_add_f32 v33, v33, v112
    v_add_f32 v33, v33, v113
    v_mfma_f32_16x16x32_bf16 v[216:219], a[204:207], v[212:215], v[216:219]
    v_add_f32 v33, v33, v114
    v_add_f32 v33, v33, v115
    v_mfma_f32_16x16x32_bf16 v[224:227], a[204:207], v[220:223], v[224:227]
    v_add_f32 v34, v34, v120
    v_add_f32 v34, v34, v121
    v_mfma_f32_16x16x32_bf16 a[0:3], a[208:211], v[40:43], a[0:3]
    v_add_f32 v34, v34, v122
    v_add_f32 v34, v34, v123
    v_mfma_f32_16x16x32_bf16 a[4:7], a[208:211], v[48:51], a[4:7]
    v_add_f32 v35, v35, v128
    v_add_f32 v35, v35, v129
    v_mfma_f32_16x16x32_bf16 a[8:11], a[208:211], v[56:59], a[8:11]
    v_add_f32 v35, v35, v130
    v_add_f32 v35, v35, v131
    v_mfma_f32_16x16x32_bf16 a[12:15], a[208:211], v[64:67], a[12:15]
    s_add_u32 m0, s43, s99
    v_mfma_f32_16x16x32_bf16 a[16:19], a[208:211], v[72:75], a[16:19]
    buffer_load_dwordx4 v9, s[8:11], s48 offen offset:0 nt lds
    v_mfma_f32_16x16x32_bf16 a[20:23], a[208:211], v[80:83], a[20:23]
    ds_read_b64_tr_b16 a[208:209], v6 offset:128
    ds_read_b64_tr_b16 a[210:211], v6 offset:4480
    v_mfma_f32_16x16x32_bf16 a[24:27], a[212:215], v[40:43], a[24:27]
    buffer_load_dwordx4 v10, s[8:11], s48 offen offset:1088 nt lds
    v_mfma_f32_16x16x32_bf16 a[28:31], a[212:215], v[48:51], a[28:31]
    buffer_load_dwordx4 v11, s[8:11], s48 offen offset:2176 nt lds
    v_mfma_f32_16x16x32_bf16 a[32:35], a[212:215], v[56:59], a[32:35]
    buffer_load_dwordx4 v12, s[8:11], s48 offen offset:3264 nt lds
    v_mfma_f32_16x16x32_bf16 a[36:39], a[212:215], v[64:67], a[36:39]
    s_add_u32 s48, s48, s96
    s_add_u32 m0, s44, s99
    v_mfma_f32_16x16x32_bf16 a[40:43], a[212:215], v[72:75], a[40:43]
    buffer_load_dwordx4 v13, s[12:15], s49 offen offset:0 nt lds
    v_mfma_f32_16x16x32_bf16 a[44:47], a[212:215], v[80:83], a[44:47]
    ds_read_b64_tr_b16 a[212:213], v7 offset:128
    ds_read_b64_tr_b16 a[214:215], v7 offset:4480
    s_waitcnt lgkmcnt(8)
    v_mfma_f32_16x16x32_bf16 a[48:51], a[216:219], v[40:43], a[48:51]
    buffer_load_dwordx4 v14, s[12:15], s49 offen offset:1088 nt lds
    v_mfma_f32_16x16x32_bf16 a[52:55], a[216:219], v[48:51], a[52:55]
    buffer_load_dwordx4 v15, s[12:15], s49 offen offset:2176 nt lds
    v_mfma_f32_16x16x32_bf16 a[56:59], a[216:219], v[56:59], a[56:59]
    v_exp_f32 v136, v136
    v_mfma_f32_16x16x32_bf16 a[60:63], a[216:219], v[64:67], a[60:63]
    v_exp_f32 v137, v137
    v_mfma_f32_16x16x32_bf16 a[64:67], a[216:219], v[72:75], a[64:67]
    v_exp_f32 v138, v138
    v_mfma_f32_16x16x32_bf16 a[68:71], a[216:219], v[80:83], a[68:71]
    ds_read_b64_tr_b16 a[216:217], v8 offset:128
    ds_read_b64_tr_b16 a[218:219], v8 offset:4480
    s_waitcnt lgkmcnt(8)
    v_mfma_f32_16x16x32_bf16 a[72:75], a[220:223], v[40:43], a[72:75]
    v_exp_f32 v139, v139
    v_mfma_f32_16x16x32_bf16 a[76:79], a[220:223], v[48:51], a[76:79]
    v_exp_f32 v184, v184
    v_mfma_f32_16x16x32_bf16 a[80:83], a[220:223], v[56:59], a[80:83]
    v_exp_f32 v185, v185
    v_mfma_f32_16x16x32_bf16 a[84:87], a[220:223], v[64:67], a[84:87]
    v_exp_f32 v186, v186
    v_mfma_f32_16x16x32_bf16 a[88:91], a[220:223], v[72:75], a[88:91]
    buffer_load_dwordx4 v16, s[12:15], s49 offen offset:3264 nt lds
    v_mfma_f32_16x16x32_bf16 a[92:95], a[220:223], v[80:83], a[92:95]
    s_add_u32 s49, s49, s96
    v_add_f32 v30, v30, v136
    s_waitcnt lgkmcnt(6)
    v_mfma_f32_16x16x32_bf16 a[96:99], a[224:227], v[40:43], a[96:99]
    v_exp_f32 v187, v187
    v_mfma_f32_16x16x32_bf16 a[100:103], a[224:227], v[48:51], a[100:103]
    v_add_f32 v30, v30, v137
    v_add_f32 v30, v30, v138
    v_mfma_f32_16x16x32_bf16 a[104:107], a[224:227], v[56:59], a[104:107]
    v_add_f32 v30, v30, v139
    v_add_f32 v30, v30, v184
    v_mfma_f32_16x16x32_bf16 a[108:111], a[224:227], v[64:67], a[108:111]
    v_add_f32 v30, v30, v185
    v_add_f32 v30, v30, v186
    v_mfma_f32_16x16x32_bf16 a[112:115], a[224:227], v[72:75], a[112:115]
    v_add_f32 v30, v30, v187
    v_cvt_pk_bf16_f32 v136, v136, v137
    v_mfma_f32_16x16x32_bf16 a[116:119], a[224:227], v[80:83], a[116:119]
    v_cvt_pk_bf16_f32 v137, v138, v139
    v_cvt_pk_bf16_f32 v138, v184, v185
    s_waitcnt lgkmcnt(4)
    v_mfma_f32_16x16x32_bf16 a[120:123], a[208:211], v[40:43], a[120:123]
    v_cvt_pk_bf16_f32 v139, v186, v187
    v_mfma_f32_16x16x32_bf16 a[124:127], a[208:211], v[48:51], a[124:127]
    v_exp_f32 v144, v144
    v_mfma_f32_16x16x32_bf16 a[128:131], a[208:211], v[56:59], a[128:131]
    v_exp_f32 v145, v145
    v_mfma_f32_16x16x32_bf16 a[132:135], a[208:211], v[64:67], a[132:135]
    v_exp_f32 v146, v146
    v_mfma_f32_16x16x32_bf16 a[136:139], a[208:211], v[72:75], a[136:139]
    v_exp_f32 v147, v147
    v_mfma_f32_16x16x32_bf16 a[140:143], a[208:211], v[80:83], a[140:143]
    v_exp_f32 v192, v192
    s_waitcnt lgkmcnt(2)
    v_mfma_f32_16x16x32_bf16 a[144:147], a[212:215], v[40:43], a[144:147]
    v_exp_f32 v193, v193
    v_mfma_f32_16x16x32_bf16 a[148:151], a[212:215], v[48:51], a[148:151]
    s_mov_b32 s99, s98
    s_add_u32 s98, s98, 34816
    v_mfma_f32_16x16x32_bf16 a[152:155], a[212:215], v[56:59], a[152:155]
    s_cmp_eq_u32 s98, 139264
    s_cselect_b32 s98, 0, s98
    v_mfma_f32_16x16x32_bf16 a[156:159], a[212:215], v[64:67], a[156:159]
    s_sub_u32 s100, s98, s99
    v_add_f32 v31, v31, v144
    v_mfma_f32_16x16x32_bf16 a[160:163], a[212:215], v[72:75], a[160:163]
    s_waitcnt lgkmcnt(0)
    s_waitcnt vmcnt(16)
    s_barrier
    v_mfma_f32_16x16x32_bf16 a[164:167], a[212:215], v[80:83], a[164:167]
    v_add_u32 v4, s100, v4
    ds_read_b128 a[192:195], v4 offset:0
    v_mfma_f32_16x16x32_bf16 a[168:171], a[216:219], v[40:43], a[168:171]
    ds_read_b128 a[196:199], v4 offset:64
    v_add_f32 v31, v31, v145
    v_mfma_f32_16x16x32_bf16 a[172:175], a[216:219], v[48:51], a[172:175]
    v_exp_f32 v194, v194
    v_mfma_f32_16x16x32_bf16 a[176:179], a[216:219], v[56:59], a[176:179]
    v_exp_f32 v195, v195
    v_mfma_f32_16x16x32_bf16 a[180:183], a[216:219], v[64:67], a[180:183]
    v_add_f32 v31, v31, v146
    v_add_f32 v31, v31, v147
    v_mfma_f32_16x16x32_bf16 a[184:187], a[216:219], v[72:75], a[184:187]
    v_add_f32 v31, v31, v192
    v_add_f32 v31, v31, v193
    v_mfma_f32_16x16x32_bf16 a[188:191], a[216:219], v[80:83], a[188:191]
    v_add_f32 v31, v31, v194
    v_add_f32 v31, v31, v195
    v_cvt_pk_bf16_f32 v144, v144, v145
    v_cvt_pk_bf16_f32 v145, v146, v147
    v_cvt_pk_bf16_f32 v146, v192, v193
    v_cvt_pk_bf16_f32 v147, v194, v195
    v_exp_f32 v152, v152
    v_exp_f32 v153, v153
    v_exp_f32 v154, v154
    v_exp_f32 v155, v155
    v_exp_f32 v200, v200
    v_exp_f32 v201, v201
    v_exp_f32 v202, v202
    v_exp_f32 v203, v203
    v_add_f32 v32, v32, v152
    v_add_f32 v32, v32, v153
    v_add_f32 v32, v32, v154
    v_add_f32 v32, v32, v155
    v_add_f32 v32, v32, v200
    v_add_f32 v32, v32, v201
    v_add_f32 v32, v32, v202
    v_add_f32 v32, v32, v203
    v_cvt_pk_bf16_f32 v152, v152, v153
    v_cvt_pk_bf16_f32 v153, v154, v155
    v_cvt_pk_bf16_f32 v154, v200, v201
    v_cvt_pk_bf16_f32 v155, v202, v203
    s_sub_u32 s40, s40, 1
    s_cmp_gt_u32 s40, 1
    s_cbranch_scc1 L_at
    s_cmp_eq_u32 s40, 0
    s_cbranch_scc1 L_at_done
    s_cmp_lg_u32 s61, 0
    s_cbranch_scc1 L_sw1
    s_mov_b32 s8, s16
    s_mov_b32 s9, s17
    s_mov_b32 s10, s18
    s_mov_b32 s11, s19
    s_mov_b32 s12, s16
    s_mov_b32 s13, s17
    s_mov_b32 s14, s18
    s_mov_b32 s15, s19
    v_mov_b32 v9, v17
    v_mov_b32 v10, v18
    v_mov_b32 v11, v19
    v_mov_b32 v12, v20
    v_mov_b32 v13, v17
    v_mov_b32 v14, v18
    v_mov_b32 v15, v19
    v_mov_b32 v16, v20
    s_lshl_b32 s48, s36, 8
    s_add_u32 s48, s48, 1024
    s_lshl_b32 s1, s0, 19
    s_add_u32 s48, s48, s1
    s_add_u32 s49, s48, 131072
    s_mov_b32 s96, 262144
    s_mov_b32 s87, -1
    s_mov_b32 s43, s41
    s_mov_b32 s44, s42
    s_lshl_b32 s47, s0, 7
    s_mul_i32 s94, s36, 3072
    s_add_u32 s94, s94, 151552
    s_mov_b32 m0, s94
    s_nop 0
    buffer_load_dwordx4 v21, s[4:7], s47 offen offset:0 lds
    buffer_load_dwordx4 v22, s[4:7], s47 offen offset:1024 lds
    buffer_load_dwordx4 v23, s[4:7], s47 offen offset:2048 lds
    s_add_u32 s47, s47, 128
    s_sub_u32 s94, s93, s94
    s_cmp_eq_u32 s47, 1152
    s_cselect_b32 s47, 0, s47
    s_mov_b32 m0, s94
    s_nop 0
    buffer_load_dwordx4 v21, s[4:7], s47 offen offset:0 lds
    buffer_load_dwordx4 v22, s[4:7], s47 offen offset:1024 lds
    buffer_load_dwordx4 v23, s[4:7], s47 offen offset:2048 lds
    s_add_u32 s47, s47, 128
    s_sub_u32 s94, s93, s94
    s_cmp_eq_u32 s47, 1152
    s_cselect_b32 s47, 0, s47
    s_branch L_at
L_sw1:
    s_mov_b32 s43, 100000
    s_mov_b32 s44, 100000
    s_mov_b32 s87, -1
    s_mov_b32 s48, 0x40000000
    s_mov_b32 s49, 0x40000000
    s_cmp_lg_u32 s36, 0
    s_cbranch_scc1 L_hsp
    s_lshl_b32 s55, s37, 1
    s_add_u32 s55, s55, s39
    s_lshl_b32 s55, s55, 2
    v_mov_b32 v28, s55
    global_load_dword v27, v28, s[62:63] sc1
L_hsp:
    s_mul_i32 s55, s36, 576
    s_mul_i32 s41, s36, 9216
    s_mul_i32 s47, s36, 1536
    s_mov_b32 s42, s47
    s_mov_b32 s92, 143360
    s_mov_b32 s93, 6144
    s_mov_b32 s45, 0
    s_mov_b32 s88, 69632
    s_mov_b32 s89, 106496
    s_mov_b32 s90, 0
    v_add_u32 v1, s55, v0
    v_add_u32 v1, 0, v1
    v_mul_u32_u24 v2, 1821, v1
    v_bfe_u32 v2, v2, 18, 2
    v_lshlrev_b32 v2, 5, v2
    v_lshlrev_b32 v1, 4, v1
    v_xor_b32 v17, v1, v2
    v_add_u32 v1, s55, v0
    v_add_u32 v1, 64, v1
    v_mul_u32_u24 v2, 1821, v1
    v_bfe_u32 v2, v2, 18, 2
    v_lshlrev_b32 v2, 5, v2
    v_lshlrev_b32 v1, 4, v1
    v_xor_b32 v18, v1, v2
    v_subrev_u32 v18, 1024, v18
    v_add_u32 v1, s55, v0
    v_add_u32 v1, 128, v1
    v_mul_u32_u24 v2, 1821, v1
    v_bfe_u32 v2, v2, 18, 2
    v_lshlrev_b32 v2, 5, v2
    v_lshlrev_b32 v1, 4, v1
    v_xor_b32 v19, v1, v2
    v_subrev_u32 v19, 2048, v19
    v_add_u32 v1, s55, v0
    v_add_u32 v1, 192, v1
    v_mul_u32_u24 v2, 1821, v1
    v_bfe_u32 v2, v2, 18, 2
    v_lshlrev_b32 v2, 5, v2
    v_lshlrev_b32 v1, 4, v1
    v_xor_b32 v20, v1, v2
    v_subrev_u32 v20, 3072, v20
    v_add_u32 v1, s55, v0
    v_add_u32 v1, 256, v1
    v_mul_u32_u24 v2, 1821, v1
    v_bfe_u32 v2, v2, 18, 2
    v_lshlrev_b32 v2, 5, v2
    v_lshlrev_b32 v1, 4, v1
    v_xor_b32 v21, v1, v2
    v_add_u32 v1, s55, v0
    v_add_u32 v1, 320, v1
    v_mul_u32_u24 v2, 1821, v1
    v_bfe_u32 v2, v2, 18, 2
    v_lshlrev_b32 v2, 5, v2
    v_lshlrev_b32 v1, 4, v1
    v_xor_b32 v22, v1, v2
    v_subrev_u32 v22, 1024, v22
    v_add_u32 v1, s55, v0
    v_add_u32 v1, 384, v1
    v_mul_u32_u24 v2, 1821, v1
    v_bfe_u32 v2, v2, 18, 2
    v_lshlrev_b32 v2, 5, v2
    v_lshlrev_b32 v1, 4, v1
    v_xor_b32 v23, v1, v2
    v_subrev_u32 v23, 2048, v23
    v_add_u32 v1, s55, v0
    v_add_u32 v1, 448, v1
    v_mul_u32_u24 v2, 1821, v1
    v_bfe_u32 v2, v2, 18, 2
    v_lshlrev_b32 v2, 5, v2
    v_lshlrev_b32 v1, 4, v1
    v_xor_b32 v24, v1, v2
    v_subrev_u32 v24, 3072, v24
    v_add_u32 v1, s55, v0
    v_add_u32 v1, 512, v1
    v_mul_u32_u24 v2, 1821, v1
    v_bfe_u32 v2, v2, 18, 2
    v_lshlrev_b32 v2, 5, v2
    v_lshlrev_b32 v1, 4, v1
    v_xor_b32 v25, v1, v2
    v_lshlrev_b32 v26, 4, v0
    s_and_b32 s0, s37, 15
    s_mov_b32 s1, 0
    s_add_u32 s58, s1, s0
    s_and_b32 s58, s58, 15
    s_andn2_b32 s59, s1, 15
    s_add_u32 s58, s58, s59
    s_mul_i32 s45, s58, 36864
    s_mul_i32 s47, s58, 6144
    s_add_u32 s47, s47, s42
    s_add_u32 s1, s1, 1
    s_branch L_at

L_at_done:
    s_cmp_lg_u32 s61, 0
    s_cbranch_scc1 L_tail1
    s_and_b32 s55, s37, 15
    s_lshl_b32 s55, s55, 2
    s_add_u32 s55, s55, s36
    s_mul_i32 s55, s55, 72
    v_add_u32 v1, s55, v0
    v_lshrrev_b32 v2, 3, v1
    v_and_b32 v1, 7, v1
    v_lshlrev_b32 v1, 7, v1
    v_lshl_add_u32 v1, v2, 13, v1
    v_lshlrev_b32 v2, 7, v0
    s_and_b32 s55, s38, 1
    s_lshl_b32 s55, s55, 2
    s_add_u32 s55, s55, s36
    s_mul_i32 s55, s55, 13824
    v_add_u32 v5, s100, v5
    ds_read_b64_tr_b16 a[208:209], v5 offset:0
    ds_read_b64_tr_b16 a[210:211], v5 offset:4352
    v_add_u32 v6, s100, v6
    ds_read_b64_tr_b16 a[212:213], v6 offset:0
    ds_read_b64_tr_b16 a[214:215], v6 offset:4352
    s_waitcnt lgkmcnt(2)
    v_mfma_f32_16x16x32_bf16 a[0:3], a[208:211], v[136:139], a[0:3]
    v_exp_f32 v160, v160
    v_mfma_f32_16x16x32_bf16 a[4:7], a[208:211], v[144:147], a[4:7]
    v_exp_f32 v161, v161
    v_exp_f32 v162, v162
    v_exp_f32 v163, v163
    v_exp_f32 v208, v208
    v_exp_f32 v209, v209
    v_exp_f32 v210, v210
    v_exp_f32 v211, v211
    v_add_f32 v33, v33, v160
    v_add_f32 v33, v33, v161
    v_add_f32 v33, v33, v162
    v_add_f32 v33, v33, v163
    v_cvt_pk_bf16_f32 v160, v160, v161
    v_cvt_pk_bf16_f32 v161, v162, v163
    v_cvt_pk_bf16_f32 v162, v208, v209
    v_cvt_pk_bf16_f32 v163, v210, v211
    v_mfma_f32_16x16x32_bf16 a[8:11], a[208:211], v[152:155], a[8:11]
    v_exp_f32 v168, v168
    v_exp_f32 v169, v169
    v_exp_f32 v170, v170
    v_exp_f32 v171, v171
    v_exp_f32 v216, v216
    v_exp_f32 v217, v217
    v_exp_f32 v218, v218
    v_exp_f32 v219, v219
    v_add_f32 v34, v34, v168
    v_add_f32 v34, v34, v169
    v_add_f32 v34, v34, v170
    v_add_f32 v34, v34, v171
    v_cvt_pk_bf16_f32 v168, v168, v169
    v_cvt_pk_bf16_f32 v169, v170, v171
    v_cvt_pk_bf16_f32 v170, v216, v217
    v_cvt_pk_bf16_f32 v171, v218, v219
    v_mfma_f32_16x16x32_bf16 a[12:15], a[208:211], v[160:163], a[12:15]
    v_exp_f32 v176, v176
    v_exp_f32 v177, v177
    v_exp_f32 v178, v178
    v_exp_f32 v179, v179
    v_exp_f32 v224, v224
    v_exp_f32 v225, v225
    v_exp_f32 v226, v226
    v_exp_f32 v227, v227
    v_add_f32 v35, v35, v176
    v_add_f32 v35, v35, v177
    v_add_f32 v35, v35, v178
    v_add_f32 v35, v35, v179
    v_cvt_pk_bf16_f32 v176, v176, v177
    v_cvt_pk_bf16_f32 v177, v178, v179
    v_cvt_pk_bf16_f32 v178, v224, v225
    v_cvt_pk_bf16_f32 v179, v226, v227
    v_mfma_f32_16x16x32_bf16 a[16:19], a[208:211], v[168:171], a[16:19]
    v_add_u32 v7, s100, v7
    ds_read_b64_tr_b16 a[216:217], v7 offset:0
    v_mfma_f32_16x16x32_bf16 a[20:23], a[208:211], v[176:179], a[20:23]
    ds_read_b64_tr_b16 a[218:219], v7 offset:4352
    v_add_u32 v8, s100, v8
    s_waitcnt lgkmcnt(2)
    v_mfma_f32_16x16x32_bf16 a[24:27], a[212:215], v[136:139], a[24:27]
    ds_read_b64_tr_b16 a[220:221], v8 offset:0
    ds_read_b64_tr_b16 a[222:223], v8 offset:4352
    v_mfma_f32_16x16x32_bf16 a[28:31], a[212:215], v[144:147], a[28:31]
    ds_read_b64_tr_b16 a[224:225], v5 offset:128
    ds_read_b64_tr_b16 a[226:227], v5 offset:4480
    v_mfma_f32_16x16x32_bf16 a[32:35], a[212:215], v[152:155], a[32:35]
    ds_read_b64_tr_b16 a[208:209], v6 offset:128
    ds_read_b64_tr_b16 a[210:211], v6 offset:4480
    v_mfma_f32_16x16x32_bf16 a[36:39], a[212:215], v[160:163], a[36:39]
    s_mov_b32 s45, s48
    s_cmp_ge_u32 s45, 4718592
    v_mfma_f32_16x16x32_bf16 a[40:43], a[212:215], v[168:171], a[40:43]
    s_cselect_b32 s46, 4718592, 0
    s_sub_u32 s45, s45, s46
    v_mfma_f32_16x16x32_bf16 a[44:47], a[212:215], v[176:179], a[44:47]
    ds_read_b64_tr_b16 a[212:213], v7 offset:128
    ds_read_b64_tr_b16 a[214:215], v7 offset:4480
    s_waitcnt lgkmcnt(8)
    v_mfma_f32_16x16x32_bf16 a[48:51], a[216:219], v[136:139], a[48:51]
    v_add_f32 v33, v33, v208
    v_add_f32 v33, v33, v209
    v_mfma_f32_16x16x32_bf16 a[52:55], a[216:219], v[144:147], a[52:55]
    v_add_f32 v33, v33, v210
    v_add_f32 v33, v33, v211
    v_mfma_f32_16x16x32_bf16 a[56:59], a[216:219], v[152:155], a[56:59]
    v_add_f32 v34, v34, v216
    v_add_f32 v34, v34, v217
    v_mfma_f32_16x16x32_bf16 a[60:63], a[216:219], v[160:163], a[60:63]
    v_add_f32 v34, v34, v218
    v_add_f32 v34, v34, v219
    v_mfma_f32_16x16x32_bf16 a[64:67], a[216:219], v[168:171], a[64:67]
    v_add_f32 v35, v35, v224
    v_add_f32 v35, v35, v225
    v_mfma_f32_16x16x32_bf16 a[68:71], a[216:219], v[176:179], a[68:71]
    ds_read_b64_tr_b16 a[216:217], v8 offset:128
    ds_read_b64_tr_b16 a[218:219], v8 offset:4480
    s_waitcnt lgkmcnt(8)
    v_mfma_f32_16x16x32_bf16 a[72:75], a[220:223], v[136:139], a[72:75]
    v_add_f32 v35, v35, v226
    v_add_f32 v35, v35, v227
    v_mfma_f32_16x16x32_bf16 a[76:79], a[220:223], v[144:147], a[76:79]
    s_add_u32 m0, s41, s99
    s_add_u32 s46, s45, 131072
    v_mfma_f32_16x16x32_bf16 a[80:83], a[220:223], v[152:155], a[80:83]
    buffer_load_dwordx4 v17, s[16:19], s45 offen offset:0 lds
    v_mfma_f32_16x16x32_bf16 a[84:87], a[220:223], v[160:163], a[84:87]
    buffer_load_dwordx4 v18, s[16:19], s45 offen offset:1088 lds
    v_mfma_f32_16x16x32_bf16 a[88:91], a[220:223], v[168:171], a[88:91]
    buffer_load_dwordx4 v19, s[16:19], s45 offen offset:2176 lds
    v_mfma_f32_16x16x32_bf16 a[92:95], a[220:223], v[176:179], a[92:95]
    buffer_load_dwordx4 v20, s[16:19], s45 offen offset:3264 lds
    s_waitcnt lgkmcnt(6)
    v_mfma_f32_16x16x32_bf16 a[96:99], a[224:227], v[136:139], a[96:99]
    s_add_u32 m0, s42, s99
    s_add_u32 s45, s45, 262144
    v_mfma_f32_16x16x32_bf16 a[100:103], a[224:227], v[144:147], a[100:103]
    buffer_load_dwordx4 v17, s[16:19], s46 offen offset:0 lds
    v_mfma_f32_16x16x32_bf16 a[104:107], a[224:227], v[152:155], a[104:107]
    buffer_load_dwordx4 v18, s[16:19], s46 offen offset:1088 lds
    v_mfma_f32_16x16x32_bf16 a[108:111], a[224:227], v[160:163], a[108:111]
    buffer_load_dwordx4 v19, s[16:19], s46 offen offset:2176 lds
    v_mfma_f32_16x16x32_bf16 a[112:115], a[224:227], v[168:171], a[112:115]
    buffer_load_dwordx4 v20, s[16:19], s46 offen offset:3264 lds
    v_mfma_f32_16x16x32_bf16 a[116:119], a[224:227], v[176:179], a[116:119]
    s_cmp_ge_u32 s45, 4718592
    s_cselect_b32 s46, 4718592, 0
    s_waitcnt lgkmcnt(4)
    v_mfma_f32_16x16x32_bf16 a[120:123], a[208:211], v[136:139], a[120:123]
    s_sub_u32 s45, s45, s46
    v_mov_b32 v245, v30
    v_mfma_f32_16x16x32_bf16 a[124:127], a[208:211], v[144:147], a[124:127]
    s_nop 0
    v_permlane32_swap_b32 v245, v30
    v_add_f32 v30, v30, v245
    v_mfma_f32_16x16x32_bf16 a[128:131], a[208:211], v[152:155], a[128:131]
    v_mov_b32 v245, v30
    s_nop 1
    v_permlane16_swap_b32 v245, v30
    v_mfma_f32_16x16x32_bf16 a[132:135], a[208:211], v[160:163], a[132:135]
    v_add_f32 v30, v30, v245
    v_mov_b32 v247, v31
    v_mfma_f32_16x16x32_bf16 a[136:139], a[208:211], v[168:171], a[136:139]
    s_nop 0
    v_permlane32_swap_b32 v247, v31
    v_add_f32 v31, v31, v247
    v_mfma_f32_16x16x32_bf16 a[140:143], a[208:211], v[176:179], a[140:143]
    v_mov_b32 v247, v31
    s_nop 1
    v_permlane16_swap_b32 v247, v31
    s_waitcnt lgkmcnt(2)
    v_mfma_f32_16x16x32_bf16 a[144:147], a[212:215], v[136:139], a[144:147]
    v_add_f32 v31, v31, v247
    v_mov_b32 v249, v32
    v_mfma_f32_16x16x32_bf16 a[148:151], a[212:215], v[144:147], a[148:151]
    s_nop 0
    v_permlane32_swap_b32 v249, v32
    v_add_f32 v32, v32, v249
    v_mov_b32 v249, v32
    s_nop 1
    v_permlane16_swap_b32 v249, v32
    v_add_f32 v32, v32, v249
    v_mov_b32 v251, v33
    s_nop 1
    v_permlane32_swap_b32 v251, v33
    v_add_f32 v33, v33, v251
    v_mov_b32 v251, v33
    s_nop 1
    v_permlane16_swap_b32 v251, v33
    v_add_f32 v33, v33, v251
    v_mov_b32 v253, v34
    s_nop 1
    v_permlane32_swap_b32 v253, v34
    v_add_f32 v34, v34, v253
    v_mov_b32 v253, v34
    s_nop 1
    v_permlane16_swap_b32 v253, v34
    v_add_f32 v34, v34, v253
    v_mov_b32 v255, v35
    s_nop 1
    v_permlane32_swap_b32 v255, v35
    v_add_f32 v35, v35, v255
    v_mov_b32 v255, v35
    s_nop 1
    v_permlane16_swap_b32 v255, v35
    v_add_f32 v35, v35, v255
    v_add_f32 v1, v30, v31
    v_add_f32 v2, v32, v33
    v_add_f32 v1, v1, v34
    v_add_f32 v2, v2, v35
    v_add_f32 v1, v1, v2
    v_cmp_ngt_f32 vcc, 0x49800000, v1
    s_nop 0
    s_cmp_lg_u64 vcc, 0
    s_cselect_b32 s55, 1, 0
    s_lshl_b32 s56, s36, 2
    s_add_u32 s56, s56, 0
    v_mov_b32 v1, s55
    v_mov_b32 v2, s56
    ds_write_b32 v2, v1 offset:8640
    s_waitcnt lgkmcnt(0)
    v_mov_b32 v3, 0
    v_mfma_f32_16x16x32_bf16 a[152:155], a[212:215], v[152:155], a[152:155]
    s_mov_b32 s99, s98
    s_add_u32 s98, s98, 34816
    v_mfma_f32_16x16x32_bf16 a[156:159], a[212:215], v[160:163], a[156:159]
    s_cmp_eq_u32 s98, 139264
    s_cselect_b32 s98, 0, s98
    v_mfma_f32_16x16x32_bf16 a[160:163], a[212:215], v[168:171], a[160:163]
    s_waitcnt vmcnt(16)
    s_barrier
    ds_read_b128 v[228:231], v3 offset:8640
    v_mfma_f32_16x16x32_bf16 a[164:167], a[212:215], v[176:179], a[164:167]
    s_sub_u32 s100, s98, s99
    s_waitcnt lgkmcnt(0)
    v_or3_b32 v228, v228, v229, v230
    v_or_b32 v228, v228, v231
    s_nop 0
    v_readfirstlane_b32 s55, v228
    s_nop 0
    s_cmp_gt_u32 s55, s95
    s_cbranch_scc1 L_slow0
    s_mov_b32 s95, 0
    v_add_u32 v24, 69632, v24
    v_add_u32 v28, s101, v28
    ds_read_b128 a[224:227], v28 offset:0
    ds_read_b64_tr_b16 a[192:193], v24 offset:0
    ds_read_b64_tr_b16 a[194:195], v24 offset:1088
    v_mfma_f32_16x16x32_bf16 a[168:171], a[216:219], v[136:139], a[168:171]
    ds_read_b128 a[228:231], v28 offset:2048
    ds_read_b128 a[232:235], v28 offset:4096
    v_mfma_f32_16x16x32_bf16 a[172:175], a[216:219], v[144:147], a[172:175]
    ds_read_b128 a[236:239], v28 offset:6144
    ds_read_b128 a[240:243], v28 offset:8192
    v_mfma_f32_16x16x32_bf16 a[176:179], a[216:219], v[152:155], a[176:179]
    ds_read_b128 a[244:247], v28 offset:10240
    v_add_u32 v25, 69632, v25
    v_mfma_f32_16x16x32_bf16 a[180:183], a[216:219], v[160:163], a[180:183]
    ds_read_b64_tr_b16 a[196:197], v25 offset:0
    ds_read_b64_tr_b16 a[198:199], v25 offset:1088
    v_mfma_f32_16x16x32_bf16 a[184:187], a[216:219], v[168:171], a[184:187]
    v_add_u32 v26, 69632, v26
    ds_read_b64_tr_b16 a[200:201], v26 offset:0
    v_mfma_f32_16x16x32_bf16 a[188:191], a[216:219], v[176:179], a[188:191]
    ds_read_b64_tr_b16 a[202:203], v26 offset:1088
    v_add_u32 v27, 69632, v27
    s_waitcnt lgkmcnt(9)
    v_mfma_f32_16x16x32_bf16 v[36:39], a[192:195], a[224:227], 0
    ds_read_b64_tr_b16 a[204:205], v27 offset:0
    ds_read_b64_tr_b16 a[206:207], v27 offset:1088
    s_waitcnt lgkmcnt(10)
    v_mfma_f32_16x16x32_bf16 v[44:47], a[192:195], a[228:231], 0
    ds_read_b64_tr_b16 a[208:209], v24 offset:128
    ds_read_b64_tr_b16 a[210:211], v24 offset:1216
    s_waitcnt lgkmcnt(11)
    v_mfma_f32_16x16x32_bf16 v[52:55], a[192:195], a[232:235], 0
    ds_read_b64_tr_b16 a[212:213], v25 offset:128
    ds_read_b64_tr_b16 a[214:215], v25 offset:1216
    s_waitcnt lgkmcnt(12)
    v_mfma_f32_16x16x32_bf16 v[60:63], a[192:195], a[236:239], 0
    ds_read_b64_tr_b16 a[216:217], v26 offset:128
    ds_read_b64_tr_b16 a[218:219], v26 offset:1216
    s_waitcnt lgkmcnt(13)
    v_mfma_f32_16x16x32_bf16 v[68:71], a[192:195], a[240:243], 0
    ds_read_b64_tr_b16 a[220:221], v27 offset:128
    ds_read_b64_tr_b16 a[222:223], v27 offset:1216
    s_waitcnt lgkmcnt(14)
    v_mfma_f32_16x16x32_bf16 v[76:79], a[192:195], a[244:247], 0
    v_rcp_f32 v244, v30
    s_waitcnt lgkmcnt(12)
    v_mfma_f32_16x16x32_bf16 v[40:43], a[196:199], a[224:227], 0
    v_rcp_f32 v246, v31
    v_mfma_f32_16x16x32_bf16 v[48:51], a[196:199], a[228:231], 0
    v_rcp_f32 v248, v32
    v_mfma_f32_16x16x32_bf16 v[56:59], a[196:199], a[232:235], 0
    v_rcp_f32 v250, v33
    v_mfma_f32_16x16x32_bf16 v[64:67], a[196:199], a[236:239], 0
    v_rcp_f32 v252, v34
    v_mfma_f32_16x16x32_bf16 v[72:75], a[196:199], a[240:243], 0
    v_rcp_f32 v254, v35
    v_mfma_f32_16x16x32_bf16 v[80:83], a[196:199], a[244:247], 0
    s_add_u32 m0, s41, s99
    s_add_u32 s46, s45, 131072
    s_waitcnt lgkmcnt(10)
    v_mfma_f32_16x16x32_bf16 v[84:87], a[200:203], a[224:227], 0
    buffer_load_dwordx4 v17, s[16:19], s45 offen offset:0 lds
    v_mfma_f32_16x16x32_bf16 v[92:95], a[200:203], a[228:231], 0
    buffer_load_dwordx4 v18, s[16:19], s45 offen offset:1088 lds
    v_mfma_f32_16x16x32_bf16 v[100:103], a[200:203], a[232:235], 0
    buffer_load_dwordx4 v19, s[16:19], s45 offen offset:2176 lds
    v_mfma_f32_16x16x32_bf16 v[108:111], a[200:203], a[236:239], 0
    buffer_load_dwordx4 v20, s[16:19], s45 offen offset:3264 lds
    v_mfma_f32_16x16x32_bf16 v[116:119], a[200:203], a[240:243], 0
    s_add_u32 m0, s42, s99
    s_add_u32 s45, s45, 262144
    v_mfma_f32_16x16x32_bf16 v[124:127], a[200:203], a[244:247], 0
    buffer_load_dwordx4 v17, s[16:19], s46 offen offset:0 lds
    s_waitcnt lgkmcnt(8)
    v_mfma_f32_16x16x32_bf16 v[88:91], a[204:207], a[224:227], 0
    buffer_load_dwordx4 v18, s[16:19], s46 offen offset:1088 lds
    v_mfma_f32_16x16x32_bf16 v[96:99], a[204:207], a[228:231], 0
    buffer_load_dwordx4 v19, s[16:19], s46 offen offset:2176 lds
    v_mfma_f32_16x16x32_bf16 v[104:107], a[204:207], a[232:235], 0
    buffer_load_dwordx4 v20, s[16:19], s46 offen offset:3264 lds
    v_mfma_f32_16x16x32_bf16 v[112:115], a[204:207], a[236:239], 0
    s_cmp_ge_u32 s45, 4718592
    s_cselect_b32 s46, 4718592, 0
    v_mfma_f32_16x16x32_bf16 v[120:123], a[204:207], a[240:243], 0
    s_sub_u32 s45, s45, s46
    s_mul_i32 s52, s36, 24576
    v_mfma_f32_16x16x32_bf16 v[128:131], a[204:207], a[244:247], 0
    s_add_u32 s52, s52, 0
    v_lshlrev_b32 v1, 4, v0
    s_waitcnt lgkmcnt(6)
    v_mfma_f32_16x16x32_bf16 v[132:135], a[208:211], a[224:227], 0
    v_accvgpr_read_b32 v228, a0
    v_accvgpr_read_b32 v229, a1
    v_mfma_f32_16x16x32_bf16 v[140:143], a[208:211], a[228:231], 0
    v_accvgpr_read_b32 v230, a2
    v_accvgpr_read_b32 v231, a3
    v_mfma_f32_16x16x32_bf16 v[148:151], a[208:211], a[232:235], 0
    v_accvgpr_read_b32 v232, a24
    v_accvgpr_read_b32 v233, a25
    v_mfma_f32_16x16x32_bf16 v[156:159], a[208:211], a[236:239], 0
    v_accvgpr_read_b32 v234, a26
    v_accvgpr_read_b32 v235, a27
    v_mfma_f32_16x16x32_bf16 v[164:167], a[208:211], a[240:243], 0
    v_mul_f32 v228, v244, v228
    v_mul_f32 v229, v244, v229
    v_mfma_f32_16x16x32_bf16 v[172:175], a[208:211], a[244:247], 0
    v_mul_f32 v230, v244, v230
    v_mul_f32 v231, v244, v231
    s_waitcnt lgkmcnt(4)
    v_mfma_f32_16x16x32_bf16 v[136:139], a[212:215], a[224:227], 0
    v_mul_f32 v232, v244, v232
    v_mul_f32 v233, v244, v233
    v_mfma_f32_16x16x32_bf16 v[144:147], a[212:215], a[228:231], 0
    v_mul_f32 v234, v244, v234
    v_mul_f32 v235, v244, v235
    v_mfma_f32_16x16x32_bf16 v[152:155], a[212:215], a[232:235], 0
    v_cvt_pk_bf16_f32 v228, v228, v229
    v_cvt_pk_bf16_f32 v229, v230, v231
    v_mfma_f32_16x16x32_bf16 v[160:163], a[212:215], a[236:239], 0
    v_cvt_pk_bf16_f32 v230, v232, v233
    v_cvt_pk_bf16_f32 v231, v234, v235
    v_mfma_f32_16x16x32_bf16 v[168:171], a[212:215], a[240:243], 0
    buffer_store_dwordx4 v[228:231], v1, s[28:31], s52 offen offset:0
    v_mfma_f32_16x16x32_bf16 v[176:179], a[212:215], a[244:247], 0
    v_accvgpr_read_b32 v236, a4
    v_accvgpr_read_b32 v237, a5
    s_waitcnt lgkmcnt(2)
    v_mfma_f32_16x16x32_bf16 v[180:183], a[216:219], a[224:227], 0
    v_accvgpr_read_b32 v238, a6
    v_accvgpr_read_b32 v239, a7
    v_mfma_f32_16x16x32_bf16 v[188:191], a[216:219], a[228:231], 0
    v_accvgpr_read_b32 v240, a28
    v_accvgpr_read_b32 v241, a29
    v_mfma_f32_16x16x32_bf16 v[196:199], a[216:219], a[232:235], 0
    v_accvgpr_read_b32 v242, a30
    v_accvgpr_read_b32 v243, a31
    v_mfma_f32_16x16x32_bf16 v[204:207], a[216:219], a[236:239], 0
    v_mul_f32 v236, v246, v236
    v_mul_f32 v237, v246, v237
    v_mfma_f32_16x16x32_bf16 v[212:215], a[216:219], a[240:243], 0
    v_mul_f32 v238, v246, v238
    v_mul_f32 v239, v246, v239
    v_mfma_f32_16x16x32_bf16 v[220:223], a[216:219], a[244:247], 0
    v_mul_f32 v240, v246, v240
    v_mul_f32 v241, v246, v241
    v_mul_f32 v242, v246, v242
    v_mul_f32 v243, v246, v243
    v_cvt_pk_bf16_f32 v236, v236, v237
    v_cvt_pk_bf16_f32 v237, v238, v239
    v_cvt_pk_bf16_f32 v238, v240, v241
    v_cvt_pk_bf16_f32 v239, v242, v243
    buffer_store_dwordx4 v[236:239], v1, s[28:31], s52 offen offset:1024
    v_accvgpr_read_b32 v228, a8
    v_accvgpr_read_b32 v229, a9
    v_accvgpr_read_b32 v230, a10
    v_accvgpr_read_b32 v231, a11
    v_accvgpr_read_b32 v232, a32
    v_accvgpr_read_b32 v233, a33
    v_accvgpr_read_b32 v234, a34
    v_accvgpr_read_b32 v235, a35
    v_mul_f32 v228, v248, v228
    v_mul_f32 v229, v248, v229
    v_mul_f32 v230, v248, v230
    v_mul_f32 v231, v248, v231
    v_mul_f32 v232, v248, v232
    v_mul_f32 v233, v248, v233
    v_mul_f32 v234, v248, v234
    v_mul_f32 v235, v248, v235
    v_cvt_pk_bf16_f32 v228, v228, v229
    v_cvt_pk_bf16_f32 v229, v230, v231
    v_cvt_pk_bf16_f32 v230, v232, v233
    v_cvt_pk_bf16_f32 v231, v234, v235
    buffer_store_dwordx4 v[228:231], v1, s[28:31], s52 offen offset:2048
    v_accvgpr_read_b32 v236, a12
    v_accvgpr_read_b32 v237, a13
    v_accvgpr_read_b32 v238, a14
    v_accvgpr_read_b32 v239, a15
    v_accvgpr_read_b32 v240, a36
    v_accvgpr_read_b32 v241, a37
    v_accvgpr_read_b32 v242, a38
    v_accvgpr_read_b32 v243, a39
    v_mul_f32 v236, v250, v236
    v_mul_f32 v237, v250, v237
    v_mul_f32 v238, v250, v238
    v_mul_f32 v239, v250, v239
    v_mul_f32 v240, v250, v240
    v_mul_f32 v241, v250, v241
    v_mul_f32 v242, v250, v242
    v_mul_f32 v243, v250, v243
    v_cvt_pk_bf16_f32 v236, v236, v237
    v_cvt_pk_bf16_f32 v237, v238, v239
    v_cvt_pk_bf16_f32 v238, v240, v241
    v_cvt_pk_bf16_f32 v239, v242, v243
    buffer_store_dwordx4 v[236:239], v1, s[28:31], s52 offen offset:3072
    v_accvgpr_read_b32 v228, a16
    v_accvgpr_read_b32 v229, a17
    v_accvgpr_read_b32 v230, a18
    v_accvgpr_read_b32 v231, a19
    v_accvgpr_read_b32 v232, a40
    v_accvgpr_read_b32 v233, a41
    v_accvgpr_read_b32 v234, a42
    v_accvgpr_read_b32 v235, a43
    v_mul_f32 v228, v252, v228
    v_mul_f32 v229, v252, v229
    v_mul_f32 v230, v252, v230
    v_mul_f32 v231, v252, v231
    v_mul_f32 v232, v252, v232
    v_mul_f32 v233, v252, v233
    v_mul_f32 v234, v252, v234
    v_mul_f32 v235, v252, v235
    v_cvt_pk_bf16_f32 v228, v228, v229
    v_cvt_pk_bf16_f32 v229, v230, v231
    v_cvt_pk_bf16_f32 v230, v232, v233
    v_cvt_pk_bf16_f32 v231, v234, v235
    s_add_u32 s52, s52, 4096
    buffer_store_dwordx4 v[228:231], v1, s[28:31], s52 offen offset:0
    v_accvgpr_read_b32 v236, a20
    v_accvgpr_read_b32 v237, a21
    v_accvgpr_read_b32 v238, a22
    v_accvgpr_read_b32 v239, a23
    v_accvgpr_read_b32 v240, a44
    v_accvgpr_read_b32 v241, a45
    v_accvgpr_read_b32 v242, a46
    v_accvgpr_read_b32 v243, a47
    v_mul_f32 v236, v254, v236
    v_mul_f32 v237, v254, v237
    v_mul_f32 v238, v254, v238
    v_mul_f32 v239, v254, v239
    v_mul_f32 v240, v254, v240
    v_mul_f32 v241, v254, v241
    v_mul_f32 v242, v254, v242
    v_mul_f32 v243, v254, v243
    v_cvt_pk_bf16_f32 v236, v236, v237
    v_cvt_pk_bf16_f32 v237, v238, v239
    v_cvt_pk_bf16_f32 v238, v240, v241
    v_cvt_pk_bf16_f32 v239, v242, v243
    buffer_store_dwordx4 v[236:239], v1, s[28:31], s52 offen offset:1024
    v_accvgpr_read_b32 v228, a48
    v_accvgpr_read_b32 v229, a49
    v_accvgpr_read_b32 v230, a50
    v_accvgpr_read_b32 v231, a51
    v_accvgpr_read_b32 v232, a72
    v_accvgpr_read_b32 v233, a73
    v_accvgpr_read_b32 v234, a74
    v_accvgpr_read_b32 v235, a75
    v_mul_f32 v228, v244, v228
    v_mul_f32 v229, v244, v229
    v_mul_f32 v230, v244, v230
    v_mul_f32 v231, v244, v231
    v_mul_f32 v232, v244, v232
    v_mul_f32 v233, v244, v233
    v_mul_f32 v234, v244, v234
    v_mul_f32 v235, v244, v235
    v_cvt_pk_bf16_f32 v228, v228, v229
    v_cvt_pk_bf16_f32 v229, v230, v231
    v_cvt_pk_bf16_f32 v230, v232, v233
    v_cvt_pk_bf16_f32 v231, v234, v235
    buffer_store_dwordx4 v[228:231], v1, s[28:31], s52 offen offset:2048
    v_accvgpr_read_b32 v236, a52
    v_accvgpr_read_b32 v237, a53
    v_accvgpr_read_b32 v238, a54
    v_accvgpr_read_b32 v239, a55
    v_accvgpr_read_b32 v240, a76
    v_accvgpr_read_b32 v241, a77
    v_accvgpr_read_b32 v242, a78
    v_accvgpr_read_b32 v243, a79
    v_mul_f32 v236, v246, v236
    v_mul_f32 v237, v246, v237
    v_mul_f32 v238, v246, v238
    v_mul_f32 v239, v246, v239
    v_mul_f32 v240, v246, v240
    v_mul_f32 v241, v246, v241
    v_mul_f32 v242, v246, v242
    v_mul_f32 v243, v246, v243
    v_cvt_pk_bf16_f32 v236, v236, v237
    v_cvt_pk_bf16_f32 v237, v238, v239
    v_cvt_pk_bf16_f32 v238, v240, v241
    v_cvt_pk_bf16_f32 v239, v242, v243
    buffer_store_dwordx4 v[236:239], v1, s[28:31], s52 offen offset:3072
    v_accvgpr_read_b32 v228, a56
    v_accvgpr_read_b32 v229, a57
    v_accvgpr_read_b32 v230, a58
    v_accvgpr_read_b32 v231, a59
    v_accvgpr_read_b32 v232, a80
    v_accvgpr_read_b32 v233, a81
    v_accvgpr_read_b32 v234, a82
    v_accvgpr_read_b32 v235, a83
    v_mul_f32 v228, v248, v228
    v_mul_f32 v229, v248, v229
    v_mul_f32 v230, v248, v230
    v_mul_f32 v231, v248, v231
    v_mul_f32 v232, v248, v232
    v_mul_f32 v233, v248, v233
    v_mul_f32 v234, v248, v234
    v_mul_f32 v235, v248, v235
    v_cvt_pk_bf16_f32 v228, v228, v229
    v_cvt_pk_bf16_f32 v229, v230, v231
    v_cvt_pk_bf16_f32 v230, v232, v233
    v_cvt_pk_bf16_f32 v231, v234, v235
    s_add_u32 s52, s52, 4096
    buffer_store_dwordx4 v[228:231], v1, s[28:31], s52 offen offset:0
    v_accvgpr_read_b32 v236, a60
    v_accvgpr_read_b32 v237, a61
    v_accvgpr_read_b32 v238, a62
    v_accvgpr_read_b32 v239, a63
    v_accvgpr_read_b32 v240, a84
    v_accvgpr_read_b32 v241, a85
    v_accvgpr_read_b32 v242, a86
    v_accvgpr_read_b32 v243, a87
    v_mul_f32 v236, v250, v236
    v_mul_f32 v237, v250, v237
    v_mul_f32 v238, v250, v238
    v_mul_f32 v239, v250, v239
    v_mul_f32 v240, v250, v240
    v_mul_f32 v241, v250, v241
    v_mul_f32 v242, v250, v242
    v_mul_f32 v243, v250, v243
    v_cvt_pk_bf16_f32 v236, v236, v237
    v_cvt_pk_bf16_f32 v237, v238, v239
    v_cvt_pk_bf16_f32 v238, v240, v241
    v_cvt_pk_bf16_f32 v239, v242, v243
    buffer_store_dwordx4 v[236:239], v1, s[28:31], s52 offen offset:1024
    v_accvgpr_read_b32 v228, a64
    v_accvgpr_read_b32 v229, a65
    v_accvgpr_read_b32 v230, a66
    v_accvgpr_read_b32 v231, a67
    v_accvgpr_read_b32 v232, a88
    v_accvgpr_read_b32 v233, a89
    v_accvgpr_read_b32 v234, a90
    v_accvgpr_read_b32 v235, a91
    v_mul_f32 v228, v252, v228
    v_mul_f32 v229, v252, v229
    v_mul_f32 v230, v252, v230
    v_mul_f32 v231, v252, v231
    v_mul_f32 v232, v252, v232
    v_mul_f32 v233, v252, v233
    v_mul_f32 v234, v252, v234
    v_mul_f32 v235, v252, v235
    v_cvt_pk_bf16_f32 v228, v228, v229
    v_cvt_pk_bf16_f32 v229, v230, v231
    v_cvt_pk_bf16_f32 v230, v232, v233
    v_cvt_pk_bf16_f32 v231, v234, v235
    buffer_store_dwordx4 v[228:231], v1, s[28:31], s52 offen offset:2048
    v_accvgpr_read_b32 v236, a68
    v_accvgpr_read_b32 v237, a69
    v_accvgpr_read_b32 v238, a70
    v_accvgpr_read_b32 v239, a71
    v_accvgpr_read_b32 v240, a92
    v_accvgpr_read_b32 v241, a93
    v_accvgpr_read_b32 v242, a94
    v_accvgpr_read_b32 v243, a95
    v_mul_f32 v236, v254, v236
    v_mul_f32 v237, v254, v237
    v_mul_f32 v238, v254, v238
    v_mul_f32 v239, v254, v239
    v_mul_f32 v240, v254, v240
    v_mul_f32 v241, v254, v241
    v_mul_f32 v242, v254, v242
    v_mul_f32 v243, v254, v243
    v_cvt_pk_bf16_f32 v236, v236, v237
    v_cvt_pk_bf16_f32 v237, v238, v239
    v_cvt_pk_bf16_f32 v238, v240, v241
    v_cvt_pk_bf16_f32 v239, v242, v243
    buffer_store_dwordx4 v[236:239], v1, s[28:31], s52 offen offset:3072
    s_mov_b32 s99, s98
    s_add_u32 s98, s98, 34816
    s_cmp_eq_u32 s98, 139264
    s_cselect_b32 s98, 0, s98
    s_sub_u32 s100, s98, s99
    s_waitcnt lgkmcnt(0)
    s_waitcnt vmcnt(28)
    s_barrier
    v_add_u32 v24, s100, v24
    v_add_u32 v29, s101, v29
    ds_read_b128 a[32:35], v29 offset:0
    ds_read_b64_tr_b16 a[0:1], v24 offset:0
    ds_read_b64_tr_b16 a[2:3], v24 offset:1088
    v_mfma_f32_16x16x32_bf16 v[184:187], a[220:223], a[224:227], 0
    ds_read_b128 a[36:39], v29 offset:2048
    ds_read_b128 a[40:43], v29 offset:4096
    v_mfma_f32_16x16x32_bf16 v[192:195], a[220:223], a[228:231], 0
    ds_read_b128 a[44:47], v29 offset:6144
    ds_read_b128 a[48:51], v29 offset:8192
    v_mfma_f32_16x16x32_bf16 v[200:203], a[220:223], a[232:235], 0
    ds_read_b128 a[52:55], v29 offset:10240
    v_add_u32 v25, s100, v25
    v_mfma_f32_16x16x32_bf16 v[208:211], a[220:223], a[236:239], 0
    ds_read_b64_tr_b16 a[4:5], v25 offset:0
    ds_read_b64_tr_b16 a[6:7], v25 offset:1088
    v_mfma_f32_16x16x32_bf16 v[216:219], a[220:223], a[240:243], 0
    v_add_u32 v26, s100, v26
    ds_read_b64_tr_b16 a[8:9], v26 offset:0
    v_mfma_f32_16x16x32_bf16 v[224:227], a[220:223], a[244:247], 0
    ds_read_b64_tr_b16 a[10:11], v26 offset:1088
    v_add_u32 v27, s100, v27
    s_waitcnt lgkmcnt(9)
    v_mfma_f32_16x16x32_bf16 v[36:39], a[0:3], a[32:35], v[36:39]
    ds_read_b64_tr_b16 a[12:13], v27 offset:0
    ds_read_b64_tr_b16 a[14:15], v27 offset:1088
    s_waitcnt lgkmcnt(10)
    v_mfma_f32_16x16x32_bf16 v[44:47], a[0:3], a[36:39], v[44:47]
    ds_read_b64_tr_b16 a[16:17], v24 offset:128
    ds_read_b64_tr_b16 a[18:19], v24 offset:1216
    s_waitcnt lgkmcnt(11)
    v_mfma_f32_16x16x32_bf16 v[52:55], a[0:3], a[40:43], v[52:55]
    ds_read_b64_tr_b16 a[20:21], v25 offset:128
    ds_read_b64_tr_b16 a[22:23], v25 offset:1216
    s_waitcnt lgkmcnt(12)
    v_mfma_f32_16x16x32_bf16 v[60:63], a[0:3], a[44:47], v[60:63]
    ds_read_b64_tr_b16 a[24:25], v26 offset:128
    ds_read_b64_tr_b16 a[26:27], v26 offset:1216
    s_waitcnt lgkmcnt(13)
    v_mfma_f32_16x16x32_bf16 v[68:71], a[0:3], a[48:51], v[68:71]
    ds_read_b64_tr_b16 a[28:29], v27 offset:128
    ds_read_b64_tr_b16 a[30:31], v27 offset:1216
    s_waitcnt lgkmcnt(14)
    v_mfma_f32_16x16x32_bf16 v[76:79], a[0:3], a[52:55], v[76:79]
    s_add_u32 m0, s41, s99
    s_add_u32 s46, s45, 131072
    s_waitcnt lgkmcnt(12)
    v_mfma_f32_16x16x32_bf16 v[40:43], a[4:7], a[32:35], v[40:43]
    buffer_load_dwordx4 v17, s[16:19], s45 offen offset:0 lds
    v_mfma_f32_16x16x32_bf16 v[48:51], a[4:7], a[36:39], v[48:51]
    buffer_load_dwordx4 v18, s[16:19], s45 offen offset:1088 lds
    v_mfma_f32_16x16x32_bf16 v[56:59], a[4:7], a[40:43], v[56:59]
    buffer_load_dwordx4 v19, s[16:19], s45 offen offset:2176 lds
    v_mfma_f32_16x16x32_bf16 v[64:67], a[4:7], a[44:47], v[64:67]
    buffer_load_dwordx4 v20, s[16:19], s45 offen offset:3264 lds
    v_mfma_f32_16x16x32_bf16 v[72:75], a[4:7], a[48:51], v[72:75]
    s_add_u32 m0, s42, s99
    s_add_u32 s45, s45, 262144
    v_mfma_f32_16x16x32_bf16 v[80:83], a[4:7], a[52:55], v[80:83]
    buffer_load_dwordx4 v17, s[16:19], s46 offen offset:0 lds
    s_waitcnt lgkmcnt(10)
    v_mfma_f32_16x16x32_bf16 v[84:87], a[8:11], a[32:35], v[84:87]
    buffer_load_dwordx4 v18, s[16:19], s46 offen offset:1088 lds
    v_mfma_f32_16x16x32_bf16 v[92:95], a[8:11], a[36:39], v[92:95]
    buffer_load_dwordx4 v19, s[16:19], s46 offen offset:2176 lds
    v_mfma_f32_16x16x32_bf16 v[100:103], a[8:11], a[40:43], v[100:103]
    buffer_load_dwordx4 v20, s[16:19], s46 offen offset:3264 lds
    v_mfma_f32_16x16x32_bf16 v[108:111], a[8:11], a[44:47], v[108:111]
    s_cmp_ge_u32 s45, 4718592
    s_cselect_b32 s46, 4718592, 0
    v_mfma_f32_16x16x32_bf16 v[116:119], a[8:11], a[48:51], v[116:119]
    s_sub_u32 s45, s45, s46
    s_sub_u32 s101, 0, s101
    v_mfma_f32_16x16x32_bf16 v[124:127], a[8:11], a[52:55], v[124:127]
    v_accvgpr_read_b32 v228, a96
    v_accvgpr_read_b32 v229, a97
    s_waitcnt lgkmcnt(8)
    v_mfma_f32_16x16x32_bf16 v[88:91], a[12:15], a[32:35], v[88:91]
    v_accvgpr_read_b32 v230, a98
    v_accvgpr_read_b32 v231, a99
    v_mfma_f32_16x16x32_bf16 v[96:99], a[12:15], a[36:39], v[96:99]
    v_accvgpr_read_b32 v232, a120
    v_accvgpr_read_b32 v233, a121
    v_mfma_f32_16x16x32_bf16 v[104:107], a[12:15], a[40:43], v[104:107]
    v_accvgpr_read_b32 v234, a122
    v_accvgpr_read_b32 v235, a123
    v_mfma_f32_16x16x32_bf16 v[112:115], a[12:15], a[44:47], v[112:115]
    v_mul_f32 v228, v244, v228
    v_mul_f32 v229, v244, v229
    v_mfma_f32_16x16x32_bf16 v[120:123], a[12:15], a[48:51], v[120:123]
    v_mul_f32 v230, v244, v230
    v_mul_f32 v231, v244, v231
    v_mfma_f32_16x16x32_bf16 v[128:131], a[12:15], a[52:55], v[128:131]
    v_mul_f32 v232, v244, v232
    v_mul_f32 v233, v244, v233
    s_waitcnt lgkmcnt(6)
    v_mfma_f32_16x16x32_bf16 v[132:135], a[16:19], a[32:35], v[132:135]
    v_mul_f32 v234, v244, v234
    v_mul_f32 v235, v244, v235
    v_mfma_f32_16x16x32_bf16 v[140:143], a[16:19], a[36:39], v[140:143]
    v_cvt_pk_bf16_f32 v228, v228, v229
    v_cvt_pk_bf16_f32 v229, v230, v231
    v_mfma_f32_16x16x32_bf16 v[148:151], a[16:19], a[40:43], v[148:151]
    v_cvt_pk_bf16_f32 v230, v232, v233
    v_cvt_pk_bf16_f32 v231, v234, v235
    v_mfma_f32_16x16x32_bf16 v[156:159], a[16:19], a[44:47], v[156:159]
    s_add_u32 s52, s52, 4096
    v_accvgpr_read_b32 v236, a100
    v_mfma_f32_16x16x32_bf16 v[164:167], a[16:19], a[48:51], v[164:167]
    buffer_store_dwordx4 v[228:231], v1, s[28:31], s52 offen offset:0
    v_mfma_f32_16x16x32_bf16 v[172:175], a[16:19], a[52:55], v[172:175]
    v_accvgpr_read_b32 v237, a101
    v_accvgpr_read_b32 v238, a102
    s_waitcnt lgkmcnt(4)
    v_mfma_f32_16x16x32_bf16 v[136:139], a[20:23], a[32:35], v[136:139]
    v_accvgpr_read_b32 v239, a103
    v_accvgpr_read_b32 v240, a124
    v_mfma_f32_16x16x32_bf16 v[144:147], a[20:23], a[36:39], v[144:147]
    v_accvgpr_read_b32 v241, a125
    v_accvgpr_read_b32 v242, a126
    v_mfma_f32_16x16x32_bf16 v[152:155], a[20:23], a[40:43], v[152:155]
    v_accvgpr_read_b32 v243, a127
    v_mul_f32 v236, v246, v236
    v_mfma_f32_16x16x32_bf16 v[160:163], a[20:23], a[44:47], v[160:163]
    v_mul_f32 v237, v246, v237
    v_mul_f32 v238, v246, v238
    v_mfma_f32_16x16x32_bf16 v[168:171], a[20:23], a[48:51], v[168:171]
    v_mul_f32 v239, v246, v239
    v_mul_f32 v240, v246, v240
    v_mfma_f32_16x16x32_bf16 v[176:179], a[20:23], a[52:55], v[176:179]
    v_mul_f32 v241, v246, v241
    v_mul_f32 v242, v246, v242
    s_waitcnt lgkmcnt(2)
    v_mfma_f32_16x16x32_bf16 v[180:183], a[24:27], a[32:35], v[180:183]
    v_mul_f32 v243, v246, v243
    v_cvt_pk_bf16_f32 v236, v236, v237
    v_mfma_f32_16x16x32_bf16 v[188:191], a[24:27], a[36:39], v[188:191]
    v_cvt_pk_bf16_f32 v237, v238, v239
    v_cvt_pk_bf16_f32 v238, v240, v241
    v_mfma_f32_16x16x32_bf16 v[196:199], a[24:27], a[40:43], v[196:199]
    v_cvt_pk_bf16_f32 v239, v242, v243
    v_accvgpr_read_b32 v228, a104
    v_mfma_f32_16x16x32_bf16 v[204:207], a[24:27], a[44:47], v[204:207]
    buffer_store_dwordx4 v[236:239], v1, s[28:31], s52 offen offset:1024
    v_mfma_f32_16x16x32_bf16 v[212:215], a[24:27], a[48:51], v[212:215]
    v_accvgpr_read_b32 v229, a105
    v_accvgpr_read_b32 v230, a106
    v_mfma_f32_16x16x32_bf16 v[220:223], a[24:27], a[52:55], v[220:223]
    v_accvgpr_read_b32 v231, a107
    v_accvgpr_read_b32 v232, a128
    v_accvgpr_read_b32 v233, a129
    v_accvgpr_read_b32 v234, a130
    v_accvgpr_read_b32 v235, a131
    v_mul_f32 v228, v248, v228
    v_mul_f32 v229, v248, v229
    v_mul_f32 v230, v248, v230
    v_mul_f32 v231, v248, v231
    v_mul_f32 v232, v248, v232
    v_mul_f32 v233, v248, v233
    v_mul_f32 v234, v248, v234
    v_mul_f32 v235, v248, v235
    v_cvt_pk_bf16_f32 v228, v228, v229
    v_cvt_pk_bf16_f32 v229, v230, v231
    v_cvt_pk_bf16_f32 v230, v232, v233
    v_cvt_pk_bf16_f32 v231, v234, v235
    buffer_store_dwordx4 v[228:231], v1, s[28:31], s52 offen offset:2048
    v_accvgpr_read_b32 v236, a108
    v_accvgpr_read_b32 v237, a109
    v_accvgpr_read_b32 v238, a110
    v_accvgpr_read_b32 v239, a111
    v_accvgpr_read_b32 v240, a132
    v_accvgpr_read_b32 v241, a133
    v_accvgpr_read_b32 v242, a134
    v_accvgpr_read_b32 v243, a135
    v_mul_f32 v236, v250, v236
    v_mul_f32 v237, v250, v237
    v_mul_f32 v238, v250, v238
    v_mul_f32 v239, v250, v239
    v_mul_f32 v240, v250, v240
    v_mul_f32 v241, v250, v241
    v_mul_f32 v242, v250, v242
    v_mul_f32 v243, v250, v243
    v_cvt_pk_bf16_f32 v236, v236, v237
    v_cvt_pk_bf16_f32 v237, v238, v239
    v_cvt_pk_bf16_f32 v238, v240, v241
    v_cvt_pk_bf16_f32 v239, v242, v243
    buffer_store_dwordx4 v[236:239], v1, s[28:31], s52 offen offset:3072
    v_accvgpr_read_b32 v228, a112
    v_accvgpr_read_b32 v229, a113
    v_accvgpr_read_b32 v230, a114
    v_accvgpr_read_b32 v231, a115
    v_accvgpr_read_b32 v232, a136
    v_accvgpr_read_b32 v233, a137
    v_accvgpr_read_b32 v234, a138
    v_accvgpr_read_b32 v235, a139
    v_mul_f32 v228, v252, v228
    v_mul_f32 v229, v252, v229
    v_mul_f32 v230, v252, v230
    v_mul_f32 v231, v252, v231
    v_mul_f32 v232, v252, v232
    v_mul_f32 v233, v252, v233
    v_mul_f32 v234, v252, v234
    v_mul_f32 v235, v252, v235
    v_cvt_pk_bf16_f32 v228, v228, v229
    v_cvt_pk_bf16_f32 v229, v230, v231
    v_cvt_pk_bf16_f32 v230, v232, v233
    v_cvt_pk_bf16_f32 v231, v234, v235
    s_add_u32 s52, s52, 4096
    buffer_store_dwordx4 v[228:231], v1, s[28:31], s52 offen offset:0
    v_accvgpr_read_b32 v236, a116
    v_accvgpr_read_b32 v237, a117
    v_accvgpr_read_b32 v238, a118
    v_accvgpr_read_b32 v239, a119
    v_accvgpr_read_b32 v240, a140
    v_accvgpr_read_b32 v241, a141
    v_accvgpr_read_b32 v242, a142
    v_accvgpr_read_b32 v243, a143
    v_mul_f32 v236, v254, v236
    v_mul_f32 v237, v254, v237
    v_mul_f32 v238, v254, v238
    v_mul_f32 v239, v254, v239
    v_mul_f32 v240, v254, v240
    v_mul_f32 v241, v254, v241
    v_mul_f32 v242, v254, v242
    v_mul_f32 v243, v254, v243
    v_cvt_pk_bf16_f32 v236, v236, v237
    v_cvt_pk_bf16_f32 v237, v238, v239
    v_cvt_pk_bf16_f32 v238, v240, v241
    v_cvt_pk_bf16_f32 v239, v242, v243
    buffer_store_dwordx4 v[236:239], v1, s[28:31], s52 offen offset:1024
    s_mov_b32 s99, s98
    s_add_u32 s98, s98, 34816
    s_cmp_eq_u32 s98, 139264
    s_cselect_b32 s98, 0, s98
    s_sub_u32 s100, s98, s99
    s_waitcnt lgkmcnt(0)
    s_waitcnt vmcnt(34)
    s_barrier
    v_add_u32 v24, s100, v24
    v_add_u32 v28, s101, v28
    ds_read_b128 a[224:227], v28 offset:0
    ds_read_b64_tr_b16 a[192:193], v24 offset:0
    ds_read_b64_tr_b16 a[194:195], v24 offset:1088
    v_mfma_f32_16x16x32_bf16 v[184:187], a[28:31], a[32:35], v[184:187]
    ds_read_b128 a[228:231], v28 offset:2048
    ds_read_b128 a[232:235], v28 offset:4096
    v_mfma_f32_16x16x32_bf16 v[192:195], a[28:31], a[36:39], v[192:195]
    ds_read_b128 a[236:239], v28 offset:6144
    ds_read_b128 a[240:243], v28 offset:8192
    v_mfma_f32_16x16x32_bf16 v[200:203], a[28:31], a[40:43], v[200:203]
    ds_read_b128 a[244:247], v28 offset:10240
    v_add_u32 v25, s100, v25
    v_mfma_f32_16x16x32_bf16 v[208:211], a[28:31], a[44:47], v[208:211]
    ds_read_b64_tr_b16 a[196:197], v25 offset:0
    ds_read_b64_tr_b16 a[198:199], v25 offset:1088
    v_mfma_f32_16x16x32_bf16 v[216:219], a[28:31], a[48:51], v[216:219]
    v_add_u32 v26, s100, v26
    ds_read_b64_tr_b16 a[200:201], v26 offset:0
    v_mfma_f32_16x16x32_bf16 v[224:227], a[28:31], a[52:55], v[224:227]
    ds_read_b64_tr_b16 a[202:203], v26 offset:1088
    v_add_u32 v27, s100, v27
    s_waitcnt lgkmcnt(9)
    v_mfma_f32_16x16x32_bf16 v[36:39], a[192:195], a[224:227], v[36:39]
    ds_read_b64_tr_b16 a[204:205], v27 offset:0
    ds_read_b64_tr_b16 a[206:207], v27 offset:1088
    s_waitcnt lgkmcnt(10)
    v_mfma_f32_16x16x32_bf16 v[44:47], a[192:195], a[228:231], v[44:47]
    ds_read_b64_tr_b16 a[208:209], v24 offset:128
    ds_read_b64_tr_b16 a[210:211], v24 offset:1216
    s_waitcnt lgkmcnt(11)
    v_mfma_f32_16x16x32_bf16 v[52:55], a[192:195], a[232:235], v[52:55]
    ds_read_b64_tr_b16 a[212:213], v25 offset:128
    ds_read_b64_tr_b16 a[214:215], v25 offset:1216
    s_waitcnt lgkmcnt(12)
    v_mfma_f32_16x16x32_bf16 v[60:63], a[192:195], a[236:239], v[60:63]
    ds_read_b64_tr_b16 a[216:217], v26 offset:128
    ds_read_b64_tr_b16 a[218:219], v26 offset:1216
    s_waitcnt lgkmcnt(13)
    v_mfma_f32_16x16x32_bf16 v[68:71], a[192:195], a[240:243], v[68:71]
    ds_read_b64_tr_b16 a[220:221], v27 offset:128
    ds_read_b64_tr_b16 a[222:223], v27 offset:1216
    s_waitcnt lgkmcnt(14)
    v_mfma_f32_16x16x32_bf16 v[76:79], a[192:195], a[244:247], v[76:79]
    s_mov_b32 m0, s94
    v_accvgpr_read_b32 v228, a144
    s_waitcnt lgkmcnt(12)
    v_mfma_f32_16x16x32_bf16 v[40:43], a[196:199], a[224:227], v[40:43]
    buffer_load_dwordx4 v21, s[4:7], s47 offen offset:0 lds
    v_mfma_f32_16x16x32_bf16 v[48:51], a[196:199], a[228:231], v[48:51]
    buffer_load_dwordx4 v22, s[4:7], s47 offen offset:1024 lds
    v_mfma_f32_16x16x32_bf16 v[56:59], a[196:199], a[232:235], v[56:59]
    buffer_load_dwordx4 v23, s[4:7], s47 offen offset:2048 lds
    v_mfma_f32_16x16x32_bf16 v[64:67], a[196:199], a[236:239], v[64:67]
    s_add_u32 s47, s47, 128
    s_sub_u32 s94, s93, s94
    v_mfma_f32_16x16x32_bf16 v[72:75], a[196:199], a[240:243], v[72:75]
    s_cmp_eq_u32 s47, 1152
    s_cselect_b32 s47, 0, s47
    v_mfma_f32_16x16x32_bf16 v[80:83], a[196:199], a[244:247], v[80:83]
    s_add_u32 m0, s41, s99
    s_add_u32 s46, s45, 131072
    s_waitcnt lgkmcnt(10)
    v_mfma_f32_16x16x32_bf16 v[84:87], a[200:203], a[224:227], v[84:87]
    buffer_load_dwordx4 v17, s[16:19], s45 offen offset:0 lds
    v_mfma_f32_16x16x32_bf16 v[92:95], a[200:203], a[228:231], v[92:95]
    buffer_load_dwordx4 v18, s[16:19], s45 offen offset:1088 lds
    v_mfma_f32_16x16x32_bf16 v[100:103], a[200:203], a[232:235], v[100:103]
    buffer_load_dwordx4 v19, s[16:19], s45 offen offset:2176 lds
    v_mfma_f32_16x16x32_bf16 v[108:111], a[200:203], a[236:239], v[108:111]
    buffer_load_dwordx4 v20, s[16:19], s45 offen offset:3264 lds
    v_mfma_f32_16x16x32_bf16 v[116:119], a[200:203], a[240:243], v[116:119]
    s_add_u32 m0, s42, s99
    s_add_u32 s45, s45, 262144
    v_mfma_f32_16x16x32_bf16 v[124:127], a[200:203], a[244:247], v[124:127]
    buffer_load_dwordx4 v17, s[16:19], s46 offen offset:0 lds
    s_waitcnt lgkmcnt(8)
    v_mfma_f32_16x16x32_bf16 v[88:91], a[204:207], a[224:227], v[88:91]
    buffer_load_dwordx4 v18, s[16:19], s46 offen offset:1088 lds
    v_mfma_f32_16x16x32_bf16 v[96:99], a[204:207], a[228:231], v[96:99]
    buffer_load_dwordx4 v19, s[16:19], s46 offen offset:2176 lds
    v_mfma_f32_16x16x32_bf16 v[104:107], a[204:207], a[232:235], v[104:107]
    buffer_load_dwordx4 v20, s[16:19], s46 offen offset:3264 lds
    v_mfma_f32_16x16x32_bf16 v[112:115], a[204:207], a[236:239], v[112:115]
    s_cmp_ge_u32 s45, 4718592
    s_cselect_b32 s46, 4718592, 0
    v_mfma_f32_16x16x32_bf16 v[120:123], a[204:207], a[240:243], v[120:123]
    s_sub_u32 s45, s45, s46
    v_accvgpr_read_b32 v229, a145
    v_mfma_f32_16x16x32_bf16 v[128:131], a[204:207], a[244:247], v[128:131]
    v_accvgpr_read_b32 v230, a146
    v_accvgpr_read_b32 v231, a147
    s_waitcnt lgkmcnt(6)
    v_mfma_f32_16x16x32_bf16 v[132:135], a[208:211], a[224:227], v[132:135]
    v_accvgpr_read_b32 v232, a168
    v_accvgpr_read_b32 v233, a169
    v_mfma_f32_16x16x32_bf16 v[140:143], a[208:211], a[228:231], v[140:143]
    v_accvgpr_read_b32 v234, a170
    v_accvgpr_read_b32 v235, a171
    v_mfma_f32_16x16x32_bf16 v[148:151], a[208:211], a[232:235], v[148:151]
    v_mul_f32 v228, v244, v228
    v_mul_f32 v229, v244, v229
    v_mfma_f32_16x16x32_bf16 v[156:159], a[208:211], a[236:239], v[156:159]
    v_mul_f32 v230, v244, v230
    v_mul_f32 v231, v244, v231
    v_mfma_f32_16x16x32_bf16 v[164:167], a[208:211], a[240:243], v[164:167]
    v_mul_f32 v232, v244, v232
    v_mul_f32 v233, v244, v233
    v_mfma_f32_16x16x32_bf16 v[172:175], a[208:211], a[244:247], v[172:175]
    v_mul_f32 v234, v244, v234
    v_mul_f32 v235, v244, v235
    s_waitcnt lgkmcnt(4)
    v_mfma_f32_16x16x32_bf16 v[136:139], a[212:215], a[224:227], v[136:139]
    v_cvt_pk_bf16_f32 v228, v228, v229
    v_cvt_pk_bf16_f32 v229, v230, v231
    v_mfma_f32_16x16x32_bf16 v[144:147], a[212:215], a[228:231], v[144:147]
    v_cvt_pk_bf16_f32 v230, v232, v233
    v_cvt_pk_bf16_f32 v231, v234, v235
    v_mfma_f32_16x16x32_bf16 v[152:155], a[212:215], a[232:235], v[152:155]
    buffer_store_dwordx4 v[228:231], v1, s[28:31], s52 offen offset:2048
    v_mfma_f32_16x16x32_bf16 v[160:163], a[212:215], a[236:239], v[160:163]
    v_accvgpr_read_b32 v236, a148
    v_accvgpr_read_b32 v237, a149
    v_mfma_f32_16x16x32_bf16 v[168:171], a[212:215], a[240:243], v[168:171]
    v_accvgpr_read_b32 v238, a150
    v_accvgpr_read_b32 v239, a151
    v_mfma_f32_16x16x32_bf16 v[176:179], a[212:215], a[244:247], v[176:179]
    v_accvgpr_read_b32 v240, a172
    v_accvgpr_read_b32 v241, a173
    s_waitcnt lgkmcnt(2)
    v_mfma_f32_16x16x32_bf16 v[180:183], a[216:219], a[224:227], v[180:183]
    v_accvgpr_read_b32 v242, a174
    v_accvgpr_read_b32 v243, a175
    v_mfma_f32_16x16x32_bf16 v[188:191], a[216:219], a[228:231], v[188:191]
    v_mul_f32 v236, v246, v236
    v_mul_f32 v237, v246, v237
    v_mfma_f32_16x16x32_bf16 v[196:199], a[216:219], a[232:235], v[196:199]
    v_mul_f32 v238, v246, v238
    v_mul_f32 v239, v246, v239
    v_mfma_f32_16x16x32_bf16 v[204:207], a[216:219], a[236:239], v[204:207]
    v_mul_f32 v240, v246, v240
    v_mul_f32 v241, v246, v241
    v_mfma_f32_16x16x32_bf16 v[212:215], a[216:219], a[240:243], v[212:215]
    v_mul_f32 v242, v246, v242
    v_mul_f32 v243, v246, v243
    v_mfma_f32_16x16x32_bf16 v[220:223], a[216:219], a[244:247], v[220:223]
    v_cvt_pk_bf16_f32 v236, v236, v237
    v_cvt_pk_bf16_f32 v237, v238, v239
    v_cvt_pk_bf16_f32 v238, v240, v241
    v_cvt_pk_bf16_f32 v239, v242, v243
    buffer_store_dwordx4 v[236:239], v1, s[28:31], s52 offen offset:3072
    v_accvgpr_read_b32 v228, a152
    v_accvgpr_read_b32 v229, a153
    v_accvgpr_read_b32 v230, a154
    v_accvgpr_read_b32 v231, a155
    v_accvgpr_read_b32 v232, a176
    v_accvgpr_read_b32 v233, a177
    v_accvgpr_read_b32 v234, a178
    v_accvgpr_read_b32 v235, a179
    v_mul_f32 v228, v248, v228
    v_mul_f32 v229, v248, v229
    v_mul_f32 v230, v248, v230
    v_mul_f32 v231, v248, v231
    v_mul_f32 v232, v248, v232
    v_mul_f32 v233, v248, v233
    v_mul_f32 v234, v248, v234
    v_mul_f32 v235, v248, v235
    v_cvt_pk_bf16_f32 v228, v228, v229
    v_cvt_pk_bf16_f32 v229, v230, v231
    v_cvt_pk_bf16_f32 v230, v232, v233
    v_cvt_pk_bf16_f32 v231, v234, v235
    s_add_u32 s52, s52, 4096
    buffer_store_dwordx4 v[228:231], v1, s[28:31], s52 offen offset:0
    v_accvgpr_read_b32 v236, a156
    v_accvgpr_read_b32 v237, a157
    v_accvgpr_read_b32 v238, a158
    v_accvgpr_read_b32 v239, a159
    v_accvgpr_read_b32 v240, a180
    v_accvgpr_read_b32 v241, a181
    v_accvgpr_read_b32 v242, a182
    v_accvgpr_read_b32 v243, a183
    v_mul_f32 v236, v250, v236
    v_mul_f32 v237, v250, v237
    v_mul_f32 v238, v250, v238
    v_mul_f32 v239, v250, v239
    v_mul_f32 v240, v250, v240
    v_mul_f32 v241, v250, v241
    v_mul_f32 v242, v250, v242
    v_mul_f32 v243, v250, v243
    v_cvt_pk_bf16_f32 v236, v236, v237
    v_cvt_pk_bf16_f32 v237, v238, v239
    v_cvt_pk_bf16_f32 v238, v240, v241
    v_cvt_pk_bf16_f32 v239, v242, v243
    buffer_store_dwordx4 v[236:239], v1, s[28:31], s52 offen offset:1024
    v_accvgpr_read_b32 v228, a160
    v_accvgpr_read_b32 v229, a161
    v_accvgpr_read_b32 v230, a162
    v_accvgpr_read_b32 v231, a163
    v_accvgpr_read_b32 v232, a184
    v_accvgpr_read_b32 v233, a185
    v_accvgpr_read_b32 v234, a186
    v_accvgpr_read_b32 v235, a187
    v_mul_f32 v228, v252, v228
    v_mul_f32 v229, v252, v229
    v_mul_f32 v230, v252, v230
    v_mul_f32 v231, v252, v231
    v_mul_f32 v232, v252, v232
    v_mul_f32 v233, v252, v233
    v_mul_f32 v234, v252, v234
    v_mul_f32 v235, v252, v235
    v_cvt_pk_bf16_f32 v228, v228, v229
    v_cvt_pk_bf16_f32 v229, v230, v231
    v_cvt_pk_bf16_f32 v230, v232, v233
    v_cvt_pk_bf16_f32 v231, v234, v235
    buffer_store_dwordx4 v[228:231], v1, s[28:31], s52 offen offset:2048
    v_accvgpr_read_b32 v236, a164
    v_accvgpr_read_b32 v237, a165
    v_accvgpr_read_b32 v238, a166
    v_accvgpr_read_b32 v239, a167
    v_accvgpr_read_b32 v240, a188
    v_accvgpr_read_b32 v241, a189
    v_accvgpr_read_b32 v242, a190
    v_accvgpr_read_b32 v243, a191
    v_mul_f32 v236, v254, v236
    v_mul_f32 v237, v254, v237
    v_mul_f32 v238, v254, v238
    v_mul_f32 v239, v254, v239
    v_mul_f32 v240, v254, v240
    v_mul_f32 v241, v254, v241
    v_mul_f32 v242, v254, v242
    v_mul_f32 v243, v254, v243
    v_cvt_pk_bf16_f32 v236, v236, v237
    v_cvt_pk_bf16_f32 v237, v238, v239
    v_cvt_pk_bf16_f32 v238, v240, v241
    v_cvt_pk_bf16_f32 v239, v242, v243
    buffer_store_dwordx4 v[236:239], v1, s[28:31], s52 offen offset:3072
    s_mov_b32 s99, s98
    s_add_u32 s98, s98, 34816
    s_cmp_eq_u32 s98, 139264
    s_cselect_b32 s98, 0, s98
    s_sub_u32 s100, s98, s99
    s_waitcnt lgkmcnt(0)
    s_waitcnt vmcnt(43)
    s_barrier
    v_add_u32 v24, s100, v24
    v_add_u32 v29, s101, v29
    ds_read_b128 a[32:35], v29 offset:0
    ds_read_b64_tr_b16 a[0:1], v24 offset:0
    ds_read_b64_tr_b16 a[2:3], v24 offset:1088
    v_mfma_f32_16x16x32_bf16 v[184:187], a[220:223], a[224:227], v[184:187]
    ds_read_b128 a[36:39], v29 offset:2048
    ds_read_b128 a[40:43], v29 offset:4096
    v_mfma_f32_16x16x32_bf16 v[192:195], a[220:223], a[228:231], v[192:195]
    ds_read_b128 a[44:47], v29 offset:6144
    ds_read_b128 a[48:51], v29 offset:8192
    v_mfma_f32_16x16x32_bf16 v[200:203], a[220:223], a[232:235], v[200:203]
    ds_read_b128 a[52:55], v29 offset:10240
    v_add_u32 v25, s100, v25
    v_mfma_f32_16x16x32_bf16 v[208:211], a[220:223], a[236:239], v[208:211]
    ds_read_b64_tr_b16 a[4:5], v25 offset:0
    ds_read_b64_tr_b16 a[6:7], v25 offset:1088
    v_mfma_f32_16x16x32_bf16 v[216:219], a[220:223], a[240:243], v[216:219]
    v_add_u32 v26, s100, v26
    ds_read_b64_tr_b16 a[8:9], v26 offset:0
    v_mfma_f32_16x16x32_bf16 v[224:227], a[220:223], a[244:247], v[224:227]
    ds_read_b64_tr_b16 a[10:11], v26 offset:1088
    v_add_u32 v27, s100, v27
    s_waitcnt lgkmcnt(9)
    v_mfma_f32_16x16x32_bf16 v[36:39], a[0:3], a[32:35], v[36:39]
    ds_read_b64_tr_b16 a[12:13], v27 offset:0
    ds_read_b64_tr_b16 a[14:15], v27 offset:1088
    s_waitcnt lgkmcnt(10)
    v_mfma_f32_16x16x32_bf16 v[44:47], a[0:3], a[36:39], v[44:47]
    ds_read_b64_tr_b16 a[16:17], v24 offset:128
    ds_read_b64_tr_b16 a[18:19], v24 offset:1216
    s_waitcnt lgkmcnt(11)
    v_mfma_f32_16x16x32_bf16 v[52:55], a[0:3], a[40:43], v[52:55]
    ds_read_b64_tr_b16 a[20:21], v25 offset:128
    ds_read_b64_tr_b16 a[22:23], v25 offset:1216
    s_waitcnt lgkmcnt(12)
    v_mfma_f32_16x16x32_bf16 v[60:63], a[0:3], a[44:47], v[60:63]
    ds_read_b64_tr_b16 a[24:25], v26 offset:128
    ds_read_b64_tr_b16 a[26:27], v26 offset:1216
    s_waitcnt lgkmcnt(13)
    v_mfma_f32_16x16x32_bf16 v[68:71], a[0:3], a[48:51], v[68:71]
    ds_read_b64_tr_b16 a[28:29], v27 offset:128
    ds_read_b64_tr_b16 a[30:31], v27 offset:1216
    s_waitcnt lgkmcnt(14)
    v_mfma_f32_16x16x32_bf16 v[76:79], a[0:3], a[52:55], v[76:79]
    v_mov_b32 v245, v244
    v_mov_b32 v247, v246
    s_waitcnt lgkmcnt(12)
    v_mfma_f32_16x16x32_bf16 v[40:43], a[4:7], a[32:35], v[40:43]
    v_mov_b32 v249, v248
    v_mov_b32 v251, v250
    v_mfma_f32_16x16x32_bf16 v[48:51], a[4:7], a[36:39], v[48:51]
    v_mov_b32 v253, v252
    v_mov_b32 v255, v254
    v_mfma_f32_16x16x32_bf16 v[56:59], a[4:7], a[40:43], v[56:59]
    v_subrev_u32 v4, 69632, v4
    v_subrev_u32 v5, 69632, v5
    v_mfma_f32_16x16x32_bf16 v[64:67], a[4:7], a[44:47], v[64:67]
    v_subrev_u32 v6, 69632, v6
    v_subrev_u32 v7, 69632, v7
    v_mfma_f32_16x16x32_bf16 v[72:75], a[4:7], a[48:51], v[72:75]
    v_subrev_u32 v8, 69632, v8
    s_add_u32 m0, s41, s99
    v_mfma_f32_16x16x32_bf16 v[80:83], a[4:7], a[52:55], v[80:83]
    buffer_load_dwordx4 v17, s[16:19], s45 offen offset:0 lds
    s_waitcnt lgkmcnt(10)
    v_mfma_f32_16x16x32_bf16 v[84:87], a[8:11], a[32:35], v[84:87]
    buffer_load_dwordx4 v18, s[16:19], s45 offen offset:1088 lds
    v_mfma_f32_16x16x32_bf16 v[92:95], a[8:11], a[36:39], v[92:95]
    buffer_load_dwordx4 v19, s[16:19], s45 offen offset:2176 lds
    v_mfma_f32_16x16x32_bf16 v[100:103], a[8:11], a[40:43], v[100:103]
    buffer_load_dwordx4 v20, s[16:19], s45 offen offset:3264 lds
    v_mfma_f32_16x16x32_bf16 v[108:111], a[8:11], a[44:47], v[108:111]
    s_add_u32 s46, s45, 131072
    s_add_u32 m0, s42, s99
    v_mfma_f32_16x16x32_bf16 v[116:119], a[8:11], a[48:51], v[116:119]
    buffer_load_dwordx4 v17, s[16:19], s46 offen offset:0 lds
    v_mfma_f32_16x16x32_bf16 v[124:127], a[8:11], a[52:55], v[124:127]
    buffer_load_dwordx4 v18, s[16:19], s46 offen offset:1088 lds
    s_waitcnt lgkmcnt(8)
    v_mfma_f32_16x16x32_bf16 v[88:91], a[12:15], a[32:35], v[88:91]
    buffer_load_dwordx4 v19, s[16:19], s46 offen offset:2176 lds
    v_mfma_f32_16x16x32_bf16 v[96:99], a[12:15], a[36:39], v[96:99]
    buffer_load_dwordx4 v20, s[16:19], s46 offen offset:3264 lds
    v_mfma_f32_16x16x32_bf16 v[104:107], a[12:15], a[40:43], v[104:107]
    s_add_u32 s45, s45, 262144
    s_cmp_ge_u32 s45, 4718592
    v_mfma_f32_16x16x32_bf16 v[112:115], a[12:15], a[44:47], v[112:115]
    s_cselect_b32 s46, 4718592, 0
    s_sub_u32 s45, s45, s46
    v_mfma_f32_16x16x32_bf16 v[120:123], a[12:15], a[48:51], v[120:123]
    s_sub_u32 s101, 0, s101
    s_mov_b32 s99, s98
    v_mfma_f32_16x16x32_bf16 v[128:131], a[12:15], a[52:55], v[128:131]
    s_add_u32 s98, s98, 34816
    s_cmp_eq_u32 s98, 139264
    s_waitcnt lgkmcnt(6)
    v_mfma_f32_16x16x32_bf16 v[132:135], a[16:19], a[32:35], v[132:135]
    s_cselect_b32 s98, 0, s98
    s_sub_u32 s100, s98, s99
    v_mfma_f32_16x16x32_bf16 v[140:143], a[16:19], a[36:39], v[140:143]
    s_waitcnt lgkmcnt(0)
    s_waitcnt vmcnt(22)
    s_barrier
    v_mfma_f32_16x16x32_bf16 v[148:151], a[16:19], a[40:43], v[148:151]
    s_mov_b32 m0, s94
    v_add_u32 v24, s100, v24
    v_mfma_f32_16x16x32_bf16 v[156:159], a[16:19], a[44:47], v[156:159]
    buffer_load_dwordx4 v21, s[4:7], s47 offen offset:0 lds
    v_mfma_f32_16x16x32_bf16 v[164:167], a[16:19], a[48:51], v[164:167]
    buffer_load_dwordx4 v22, s[4:7], s47 offen offset:1024 lds
    v_mfma_f32_16x16x32_bf16 v[172:175], a[16:19], a[52:55], v[172:175]
    buffer_load_dwordx4 v23, s[4:7], s47 offen offset:2048 lds
    v_mfma_f32_16x16x32_bf16 v[136:139], a[20:23], a[32:35], v[136:139]
    s_add_u32 s47, s47, 128
    s_sub_u32 s94, s93, s94
    v_mfma_f32_16x16x32_bf16 v[144:147], a[20:23], a[36:39], v[144:147]
    s_cmp_eq_u32 s47, 1152
    s_cselect_b32 s47, 0, s47
    v_mfma_f32_16x16x32_bf16 v[152:155], a[20:23], a[40:43], v[152:155]
    s_add_u32 m0, s41, s99
    s_add_u32 s46, s45, 131072
    v_mfma_f32_16x16x32_bf16 v[160:163], a[20:23], a[44:47], v[160:163]
    buffer_load_dwordx4 v17, s[16:19], s45 offen offset:0 lds
    v_mfma_f32_16x16x32_bf16 v[168:171], a[20:23], a[48:51], v[168:171]
    buffer_load_dwordx4 v18, s[16:19], s45 offen offset:1088 lds
    v_mfma_f32_16x16x32_bf16 v[176:179], a[20:23], a[52:55], v[176:179]
    buffer_load_dwordx4 v19, s[16:19], s45 offen offset:2176 lds
    v_mfma_f32_16x16x32_bf16 v[180:183], a[24:27], a[32:35], v[180:183]
    buffer_load_dwordx4 v20, s[16:19], s45 offen offset:3264 lds
    v_mfma_f32_16x16x32_bf16 v[188:191], a[24:27], a[36:39], v[188:191]
    s_add_u32 m0, s42, s99
    s_add_u32 s45, s45, 262144
    v_mfma_f32_16x16x32_bf16 v[196:199], a[24:27], a[40:43], v[196:199]
    buffer_load_dwordx4 v17, s[16:19], s46 offen offset:0 lds
    v_mfma_f32_16x16x32_bf16 v[204:207], a[24:27], a[44:47], v[204:207]
    buffer_load_dwordx4 v18, s[16:19], s46 offen offset:1088 lds
    v_mfma_f32_16x16x32_bf16 v[212:215], a[24:27], a[48:51], v[212:215]
    buffer_load_dwordx4 v19, s[16:19], s46 offen offset:2176 lds
    v_mfma_f32_16x16x32_bf16 v[220:223], a[24:27], a[52:55], v[220:223]
    buffer_load_dwordx4 v20, s[16:19], s46 offen offset:3264 lds
    v_mfma_f32_16x16x32_bf16 v[184:187], a[28:31], a[32:35], v[184:187]
    s_cmp_ge_u32 s45, 4718592
    s_cselect_b32 s46, 4718592, 0
    v_mfma_f32_16x16x32_bf16 v[192:195], a[28:31], a[36:39], v[192:195]
    s_sub_u32 s45, s45, s46
    v_add_u32 v25, s100, v25
    v_mfma_f32_16x16x32_bf16 v[200:203], a[28:31], a[40:43], v[200:203]
    v_add_u32 v26, s100, v26
    v_add_u32 v27, s100, v27
    v_mfma_f32_16x16x32_bf16 v[208:211], a[28:31], a[44:47], v[208:211]
    v_add_u32 v28, s101, v28
    ds_read_b128 a[224:227], v28 offset:0
    v_mfma_f32_16x16x32_bf16 v[216:219], a[28:31], a[48:51], v[216:219]
    ds_read_b128 a[228:231], v28 offset:2048
    ds_read_b128 a[232:235], v28 offset:4096
    v_mfma_f32_16x16x32_bf16 v[224:227], a[28:31], a[52:55], v[224:227]
    ds_read_b128 a[236:239], v28 offset:6144
    ds_read_b128 a[240:243], v28 offset:8192
    ds_read_b128 a[244:247], v28 offset:10240
    ds_read_b64_tr_b16 a[192:193], v24 offset:0
    ds_read_b64_tr_b16 a[194:195], v24 offset:1088
    ds_read_b64_tr_b16 a[196:197], v25 offset:0
    ds_read_b64_tr_b16 a[198:199], v25 offset:1088
    ds_read_b64_tr_b16 a[200:201], v26 offset:0
    ds_read_b64_tr_b16 a[202:203], v26 offset:1088
    ds_read_b64_tr_b16 a[204:205], v27 offset:0
    ds_read_b64_tr_b16 a[206:207], v27 offset:1088
    ds_read_b64_tr_b16 a[208:209], v24 offset:128
    ds_read_b64_tr_b16 a[210:211], v24 offset:1216
    ds_read_b64_tr_b16 a[212:213], v25 offset:128
    ds_read_b64_tr_b16 a[214:215], v25 offset:1216
    ds_read_b64_tr_b16 a[216:217], v26 offset:128
    ds_read_b64_tr_b16 a[218:219], v26 offset:1216
    ds_read_b64_tr_b16 a[220:221], v27 offset:128
    ds_read_b64_tr_b16 a[222:223], v27 offset:1216
    s_cmp_lg_u32 s36, 0
    s_cbranch_scc1 L_hs
    s_lshl_b32 s55, s37, 1
    s_add_u32 s55, s55, s39
    s_lshl_b32 s55, s55, 2
    v_mov_b32 v1, s55
    v_mov_b32 v2, 1
    s_mov_b64 s[82:83], exec
    s_mov_b64 exec, 1
    global_atomic_add v1, v2, s[62:63] sc1
    s_mov_b64 exec, s[82:83]
L_hs:
    s_mov_b32 s61, 1
    s_add_u32 s60, s60, 262144
    s_mov_b32 s40, 5
    s_branch L_qp
L_tail1:
    s_cmp_lg_u32 s36, 0
    s_cbranch_scc1 L_hsok
    s_waitcnt vmcnt(16)
L_hschk:
    v_readfirstlane_b32 s55, v27
    s_nop 0
    s_cmp_ge_u32 s55, 4
    s_cbranch_scc1 L_hsok
    s_sleep 4
    global_load_dword v27, v28, s[62:63] sc1
    s_waitcnt vmcnt(0)
    s_branch L_hschk
L_hsok:
    s_and_b32 s55, s37, 15
    s_lshl_b32 s55, s55, 2
    s_add_u32 s55, s55, s36
    s_mul_i32 s55, s55, 9216
    v_lshlrev_b32 v1, 7, v0
    s_add_u32 s56, s55, 589824
    buffer_load_dword a255, v1, s[20:23], s56 offen
    s_add_u32 s57, s55, 590848
    buffer_load_dword a255, v1, s[20:23], s57 offen
    v_add_u32 v5, s100, v5
    ds_read_b64_tr_b16 a[208:209], v5 offset:0
    ds_read_b64_tr_b16 a[210:211], v5 offset:4352
    v_add_u32 v6, s100, v6
    ds_read_b64_tr_b16 a[212:213], v6 offset:0
    ds_read_b64_tr_b16 a[214:215], v6 offset:4352
    s_waitcnt lgkmcnt(2)
    v_mfma_f32_16x16x32_bf16 a[0:3], a[208:211], v[136:139], a[0:3]
    v_exp_f32 v160, v160
    v_mfma_f32_16x16x32_bf16 a[4:7], a[208:211], v[144:147], a[4:7]
    v_exp_f32 v161, v161
    v_exp_f32 v162, v162
    v_exp_f32 v163, v163
    v_exp_f32 v208, v208
    v_exp_f32 v209, v209
    v_exp_f32 v210, v210
    v_exp_f32 v211, v211
    v_add_f32 v33, v33, v160
    v_add_f32 v33, v33, v161
    v_add_f32 v33, v33, v162
    v_add_f32 v33, v33, v163
    v_cvt_pk_bf16_f32 v160, v160, v161
    v_cvt_pk_bf16_f32 v161, v162, v163
    v_cvt_pk_bf16_f32 v162, v208, v209
    v_cvt_pk_bf16_f32 v163, v210, v211
    v_mfma_f32_16x16x32_bf16 a[8:11], a[208:211], v[152:155], a[8:11]
    v_exp_f32 v168, v168
    v_exp_f32 v169, v169
    v_exp_f32 v170, v170
    v_exp_f32 v171, v171
    v_exp_f32 v216, v216
    v_exp_f32 v217, v217
    v_exp_f32 v218, v218
    v_exp_f32 v219, v219
    v_add_f32 v34, v34, v168
    v_add_f32 v34, v34, v169
    v_add_f32 v34, v34, v170
    v_add_f32 v34, v34, v171
    v_cvt_pk_bf16_f32 v168, v168, v169
    v_cvt_pk_bf16_f32 v169, v170, v171
    v_cvt_pk_bf16_f32 v170, v216, v217
    v_cvt_pk_bf16_f32 v171, v218, v219
    v_mfma_f32_16x16x32_bf16 a[12:15], a[208:211], v[160:163], a[12:15]
    v_exp_f32 v176, v176
    v_exp_f32 v177, v177
    v_exp_f32 v178, v178
    v_exp_f32 v179, v179
    v_exp_f32 v224, v224
    v_exp_f32 v225, v225
    v_exp_f32 v226, v226
    v_exp_f32 v227, v227
    v_add_f32 v35, v35, v176
    v_add_f32 v35, v35, v177
    v_add_f32 v35, v35, v178
    v_add_f32 v35, v35, v179
    v_cvt_pk_bf16_f32 v176, v176, v177
    v_cvt_pk_bf16_f32 v177, v178, v179
    v_cvt_pk_bf16_f32 v178, v224, v225
    v_cvt_pk_bf16_f32 v179, v226, v227
    v_mfma_f32_16x16x32_bf16 a[16:19], a[208:211], v[168:171], a[16:19]
    v_add_u32 v7, s100, v7
    ds_read_b64_tr_b16 a[216:217], v7 offset:0
    v_mfma_f32_16x16x32_bf16 a[20:23], a[208:211], v[176:179], a[20:23]
    ds_read_b64_tr_b16 a[218:219], v7 offset:4352
    v_add_u32 v8, s100, v8
    s_waitcnt lgkmcnt(2)
    v_mfma_f32_16x16x32_bf16 a[24:27], a[212:215], v[136:139], a[24:27]
    ds_read_b64_tr_b16 a[220:221], v8 offset:0
    ds_read_b64_tr_b16 a[222:223], v8 offset:4352
    v_mfma_f32_16x16x32_bf16 a[28:31], a[212:215], v[144:147], a[28:31]
    ds_read_b64_tr_b16 a[224:225], v5 offset:128
    ds_read_b64_tr_b16 a[226:227], v5 offset:4480
    v_mfma_f32_16x16x32_bf16 a[32:35], a[212:215], v[152:155], a[32:35]
    ds_read_b64_tr_b16 a[208:209], v6 offset:128
    ds_read_b64_tr_b16 a[210:211], v6 offset:4480
    v_mfma_f32_16x16x32_bf16 a[36:39], a[212:215], v[160:163], a[36:39]
    v_add_f32 v33, v33, v208
    v_add_f32 v33, v33, v209
    v_mfma_f32_16x16x32_bf16 a[40:43], a[212:215], v[168:171], a[40:43]
    v_add_f32 v33, v33, v210
    v_add_f32 v33, v33, v211
    v_mfma_f32_16x16x32_bf16 a[44:47], a[212:215], v[176:179], a[44:47]
    ds_read_b64_tr_b16 a[212:213], v7 offset:128
    ds_read_b64_tr_b16 a[214:215], v7 offset:4480
    s_waitcnt lgkmcnt(8)
    v_mfma_f32_16x16x32_bf16 a[48:51], a[216:219], v[136:139], a[48:51]
    v_add_f32 v34, v34, v216
    v_add_f32 v34, v34, v217
    v_mfma_f32_16x16x32_bf16 a[52:55], a[216:219], v[144:147], a[52:55]
    v_add_f32 v34, v34, v218
    v_add_f32 v34, v34, v219
    v_mfma_f32_16x16x32_bf16 a[56:59], a[216:219], v[152:155], a[56:59]
    v_add_f32 v35, v35, v224
    v_add_f32 v35, v35, v225
    v_mfma_f32_16x16x32_bf16 a[60:63], a[216:219], v[160:163], a[60:63]
    v_add_f32 v35, v35, v226
    v_add_f32 v35, v35, v227
    v_mfma_f32_16x16x32_bf16 a[64:67], a[216:219], v[168:171], a[64:67]
    s_add_u32 m0, s41, 69632
    v_mov_b32 v245, v30
    v_mfma_f32_16x16x32_bf16 a[68:71], a[216:219], v[176:179], a[68:71]
    ds_read_b64_tr_b16 a[216:217], v8 offset:128
    ds_read_b64_tr_b16 a[218:219], v8 offset:4480
    s_waitcnt lgkmcnt(8)
    v_mfma_f32_16x16x32_bf16 a[72:75], a[220:223], v[136:139], a[72:75]
    buffer_load_dwordx4 v17, s[20:23], s45 offen offset:0 lds
    v_mfma_f32_16x16x32_bf16 a[76:79], a[220:223], v[144:147], a[76:79]
    buffer_load_dwordx4 v18, s[20:23], s45 offen offset:1024 lds
    v_mfma_f32_16x16x32_bf16 a[80:83], a[220:223], v[152:155], a[80:83]
    buffer_load_dwordx4 v19, s[20:23], s45 offen offset:2048 lds
    v_mfma_f32_16x16x32_bf16 a[84:87], a[220:223], v[160:163], a[84:87]
    buffer_load_dwordx4 v20, s[20:23], s45 offen offset:3072 lds
    v_mfma_f32_16x16x32_bf16 a[88:91], a[220:223], v[168:171], a[88:91]
    s_add_u32 m0, s41, 73728
    v_permlane32_swap_b32 v245, v30
    v_mfma_f32_16x16x32_bf16 a[92:95], a[220:223], v[176:179], a[92:95]
    buffer_load_dwordx4 v21, s[20:23], s45 offen offset:0 lds
    s_waitcnt lgkmcnt(6)
    v_mfma_f32_16x16x32_bf16 a[96:99], a[224:227], v[136:139], a[96:99]
    buffer_load_dwordx4 v22, s[20:23], s45 offen offset:1024 lds
    v_mfma_f32_16x16x32_bf16 a[100:103], a[224:227], v[144:147], a[100:103]
    buffer_load_dwordx4 v23, s[20:23], s45 offen offset:2048 lds
    v_mfma_f32_16x16x32_bf16 a[104:107], a[224:227], v[152:155], a[104:107]
    buffer_load_dwordx4 v24, s[20:23], s45 offen offset:3072 lds
    v_mfma_f32_16x16x32_bf16 a[108:111], a[224:227], v[160:163], a[108:111]
    s_add_u32 m0, s41, 77824
    v_add_f32 v30, v30, v245
    v_mfma_f32_16x16x32_bf16 a[112:115], a[224:227], v[168:171], a[112:115]
    buffer_load_dwordx4 v25, s[20:23], s45 offen offset:0 lds
    v_mfma_f32_16x16x32_bf16 a[116:119], a[224:227], v[176:179], a[116:119]
    s_add_u32 m0, s42, 143360
    s_add_u32 s58, s1, s0
    s_waitcnt lgkmcnt(4)
    v_mfma_f32_16x16x32_bf16 a[120:123], a[208:211], v[136:139], a[120:123]
    buffer_load_dwordx4 v26, s[28:31], s47 offen lds
    v_mfma_f32_16x16x32_bf16 a[124:127], a[208:211], v[144:147], a[124:127]
    s_mov_b32 exec_hi, 0
    buffer_load_dwordx4 v26, s[28:31], s47 offen offset:1024 lds
    s_mov_b32 exec_hi, -1
    v_mfma_f32_16x16x32_bf16 a[128:131], a[208:211], v[152:155], a[128:131]
    s_and_b32 s58, s58, 15
    s_andn2_b32 s59, s1, 15
    v_mfma_f32_16x16x32_bf16 a[132:135], a[208:211], v[160:163], a[132:135]
    s_add_u32 s58, s58, s59
    s_mul_i32 s45, s58, 36864
    v_mfma_f32_16x16x32_bf16 a[136:139], a[208:211], v[168:171], a[136:139]
    s_mul_i32 s47, s58, 6144
    s_add_u32 s47, s47, s42
    v_mfma_f32_16x16x32_bf16 a[140:143], a[208:211], v[176:179], a[140:143]
    s_add_u32 s1, s1, 1
    s_add_u32 m0, s41, 106496
    s_waitcnt lgkmcnt(2)
    v_mfma_f32_16x16x32_bf16 a[144:147], a[212:215], v[136:139], a[144:147]
    buffer_load_dwordx4 v17, s[20:23], s45 offen offset:0 lds
    v_mfma_f32_16x16x32_bf16 a[148:151], a[212:215], v[144:147], a[148:151]
    buffer_load_dwordx4 v18, s[20:23], s45 offen offset:1024 lds
    buffer_load_dwordx4 v19, s[20:23], s45 offen offset:2048 lds
    buffer_load_dwordx4 v20, s[20:23], s45 offen offset:3072 lds
    s_add_u32 m0, s41, 110592
    s_nop 0
    buffer_load_dwordx4 v21, s[20:23], s45 offen offset:0 lds
    buffer_load_dwordx4 v22, s[20:23], s45 offen offset:1024 lds
    buffer_load_dwordx4 v23, s[20:23], s45 offen offset:2048 lds
    buffer_load_dwordx4 v24, s[20:23], s45 offen offset:3072 lds
    s_add_u32 m0, s41, 114688
    s_nop 0
    buffer_load_dwordx4 v25, s[20:23], s45 offen offset:0 lds
    s_add_u32 m0, s42, 149504
    s_nop 0
    buffer_load_dwordx4 v26, s[28:31], s47 offen lds
    s_mov_b32 exec_hi, 0
    buffer_load_dwordx4 v26, s[28:31], s47 offen offset:1024 lds
    s_mov_b32 exec_hi, -1
    s_add_u32 s58, s1, s0
    s_and_b32 s58, s58, 15
    s_andn2_b32 s59, s1, 15
    s_add_u32 s58, s58, s59
    s_mul_i32 s45, s58, 36864
    s_mul_i32 s47, s58, 6144
    s_add_u32 s47, s47, s42
    s_add_u32 s1, s1, 1
    s_add_u32 m0, s41, 0
    s_nop 0
    buffer_load_dwordx4 v17, s[20:23], s45 offen offset:0 lds
    buffer_load_dwordx4 v18, s[20:23], s45 offen offset:1024 lds
    buffer_load_dwordx4 v19, s[20:23], s45 offen offset:2048 lds
    buffer_load_dwordx4 v20, s[20:23], s45 offen offset:3072 lds
    s_add_u32 m0, s41, 4096
    s_nop 0
    buffer_load_dwordx4 v21, s[20:23], s45 offen offset:0 lds
    buffer_load_dwordx4 v22, s[20:23], s45 offen offset:1024 lds
    buffer_load_dwordx4 v23, s[20:23], s45 offen offset:2048 lds
    buffer_load_dwordx4 v24, s[20:23], s45 offen offset:3072 lds
    s_add_u32 m0, s41, 8192
    s_nop 0
    buffer_load_dwordx4 v25, s[20:23], s45 offen offset:0 lds
    s_add_u32 m0, s42, 155648
    s_nop 0
    buffer_load_dwordx4 v26, s[28:31], s47 offen lds
    s_mov_b32 exec_hi, 0
    buffer_load_dwordx4 v26, s[28:31], s47 offen offset:1024 lds
    s_mov_b32 exec_hi, -1
    s_add_u32 s58, s1, s0
    s_and_b32 s58, s58, 15
    s_andn2_b32 s59, s1, 15
    s_add_u32 s58, s58, s59
    s_mul_i32 s47, s58, 6144
    s_add_u32 s47, s47, s42
    s_add_u32 s1, s1, 1
    v_mov_b32 v245, v30
    s_nop 1
    v_permlane16_swap_b32 v245, v30
    v_add_f32 v30, v30, v245
    v_mov_b32 v247, v31
    s_nop 1
    v_permlane32_swap_b32 v247, v31
    v_add_f32 v31, v31, v247
    v_mov_b32 v247, v31
    s_nop 1
    v_permlane16_swap_b32 v247, v31
    v_add_f32 v31, v31, v247
    v_mov_b32 v249, v32
    s_nop 1
    v_permlane32_swap_b32 v249, v32
    v_add_f32 v32, v32, v249
    v_mov_b32 v249, v32
    s_nop 1
    v_permlane16_swap_b32 v249, v32
    v_add_f32 v32, v32, v249
    v_mov_b32 v251, v33
    s_nop 1
    v_permlane32_swap_b32 v251, v33
    v_add_f32 v33, v33, v251
    v_mov_b32 v251, v33
    s_nop 1
    v_permlane16_swap_b32 v251, v33
    v_add_f32 v33, v33, v251
    v_mov_b32 v253, v34
    s_nop 1
    v_permlane32_swap_b32 v253, v34
    v_add_f32 v34, v34, v253
    v_mov_b32 v253, v34
    s_nop 1
    v_permlane16_swap_b32 v253, v34
    v_add_f32 v34, v34, v253
    v_mov_b32 v255, v35
    s_nop 1
    v_permlane32_swap_b32 v255, v35
    v_add_f32 v35, v35, v255
    v_mov_b32 v255, v35
    s_nop 1
    v_permlane16_swap_b32 v255, v35
    v_add_f32 v35, v35, v255
    v_add_f32 v1, v30, v31
    v_add_f32 v2, v32, v33
    v_add_f32 v1, v1, v34
    v_add_f32 v2, v2, v35
    v_add_f32 v1, v1, v2
    v_cmp_ngt_f32 vcc, 0x49800000, v1
    s_nop 0
    s_cmp_lg_u64 vcc, 0
    s_cselect_b32 s55, 1, 0
    s_lshl_b32 s56, s36, 2
    s_add_u32 s56, s56, 131072
    v_mov_b32 v1, s55
    v_mov_b32 v2, s56
    ds_write_b32 v2, v1 offset:31920
    s_waitcnt lgkmcnt(0)
    v_mov_b32 v3, 131072
    v_mfma_f32_16x16x32_bf16 a[152:155], a[212:215], v[152:155], a[152:155]
    s_mul_i32 s45, s58, 36864
    s_mov_b32 s99, s98
    v_mfma_f32_16x16x32_bf16 a[156:159], a[212:215], v[160:163], a[156:159]
    v_rcp_f32 v244, v30
    v_mfma_f32_16x16x32_bf16 a[160:163], a[212:215], v[168:171], a[160:163]
    s_waitcnt vmcnt(22)
    s_barrier
    ds_read_b128 v[228:231], v3 offset:31920
    v_mfma_f32_16x16x32_bf16 a[164:167], a[212:215], v[176:179], a[164:167]
    v_rcp_f32 v246, v31
    v_rcp_f32 v248, v32
    v_rcp_f32 v250, v33
    v_rcp_f32 v252, v34
    v_rcp_f32 v254, v35
    s_add_u32 s98, s98, 34816
    s_cmp_eq_u32 s98, 139264
    s_cselect_b32 s98, 0, s98
    s_sub_u32 s100, s98, s99
    s_waitcnt lgkmcnt(0)
    v_or3_b32 v228, v228, v229, v230
    v_or_b32 v228, v228, v231
    s_nop 0
    v_readfirstlane_b32 s55, v228
    s_nop 0
    s_cmp_gt_u32 s55, s95
    s_cbranch_scc1 L_slow1
    s_mov_b32 s95, 0
    s_mul_i32 s52, s36, 24576
    s_add_u32 s52, s52, 98304
    v_lshlrev_b32 v1, 4, v0
    v_accvgpr_read_b32 v228, a0
    v_accvgpr_read_b32 v229, a1
    v_accvgpr_read_b32 v230, a2
    v_accvgpr_read_b32 v231, a3
    v_accvgpr_read_b32 v232, a24
    v_accvgpr_read_b32 v233, a25
    v_accvgpr_read_b32 v234, a26
    v_accvgpr_read_b32 v235, a27
    v_mul_f32 v228, v244, v228
    v_mul_f32 v229, v244, v229
    v_mul_f32 v230, v244, v230
    v_mul_f32 v231, v244, v231
    v_mul_f32 v232, v244, v232
    v_mul_f32 v233, v244, v233
    v_mul_f32 v234, v244, v234
    v_mul_f32 v235, v244, v235
    v_cvt_pk_bf16_f32 v228, v228, v229
    v_cvt_pk_bf16_f32 v229, v230, v231
    v_cvt_pk_bf16_f32 v230, v232, v233
    v_cvt_pk_bf16_f32 v231, v234, v235
    buffer_store_dwordx4 v[228:231], v1, s[28:31], s52 offen offset:0
    v_accvgpr_read_b32 v236, a4
    v_accvgpr_read_b32 v237, a5
    v_accvgpr_read_b32 v238, a6
    v_accvgpr_read_b32 v239, a7
    v_accvgpr_read_b32 v240, a28
    v_accvgpr_read_b32 v241, a29
    v_accvgpr_read_b32 v242, a30
    v_accvgpr_read_b32 v243, a31
    v_mul_f32 v236, v246, v236
    v_mul_f32 v237, v246, v237
    v_mul_f32 v238, v246, v238
    v_mul_f32 v239, v246, v239
    v_mul_f32 v240, v246, v240
    v_mul_f32 v241, v246, v241
    v_mul_f32 v242, v246, v242
    v_mul_f32 v243, v246, v243
    v_cvt_pk_bf16_f32 v236, v236, v237
    v_cvt_pk_bf16_f32 v237, v238, v239
    v_cvt_pk_bf16_f32 v238, v240, v241
    v_cvt_pk_bf16_f32 v239, v242, v243
    buffer_store_dwordx4 v[236:239], v1, s[28:31], s52 offen offset:1024
    v_accvgpr_read_b32 v228, a8
    v_accvgpr_read_b32 v229, a9
    v_accvgpr_read_b32 v230, a10
    v_accvgpr_read_b32 v231, a11
    v_accvgpr_read_b32 v232, a32
    v_accvgpr_read_b32 v233, a33
    v_accvgpr_read_b32 v234, a34
    v_accvgpr_read_b32 v235, a35
    v_mul_f32 v228, v248, v228
    v_mul_f32 v229, v248, v229
    v_mul_f32 v230, v248, v230
    v_mul_f32 v231, v248, v231
    v_mul_f32 v232, v248, v232
    v_mul_f32 v233, v248, v233
    v_mul_f32 v234, v248, v234
    v_mul_f32 v235, v248, v235
    v_cvt_pk_bf16_f32 v228, v228, v229
    v_cvt_pk_bf16_f32 v229, v230, v231
    v_cvt_pk_bf16_f32 v230, v232, v233
    v_cvt_pk_bf16_f32 v231, v234, v235
    buffer_store_dwordx4 v[228:231], v1, s[28:31], s52 offen offset:2048
    v_accvgpr_read_b32 v236, a12
    v_accvgpr_read_b32 v237, a13
    v_accvgpr_read_b32 v238, a14
    v_accvgpr_read_b32 v239, a15
    v_accvgpr_read_b32 v240, a36
    v_accvgpr_read_b32 v241, a37
    v_accvgpr_read_b32 v242, a38
    v_accvgpr_read_b32 v243, a39
    v_mul_f32 v236, v250, v236
    v_mul_f32 v237, v250, v237
    v_mul_f32 v238, v250, v238
    v_mul_f32 v239, v250, v239
    v_mul_f32 v240, v250, v240
    v_mul_f32 v241, v250, v241
    v_mul_f32 v242, v250, v242
    v_mul_f32 v243, v250, v243
    v_cvt_pk_bf16_f32 v236, v236, v237
    v_cvt_pk_bf16_f32 v237, v238, v239
    v_cvt_pk_bf16_f32 v238, v240, v241
    v_cvt_pk_bf16_f32 v239, v242, v243
    buffer_store_dwordx4 v[236:239], v1, s[28:31], s52 offen offset:3072
    v_accvgpr_read_b32 v228, a16
    v_accvgpr_read_b32 v229, a17
    v_accvgpr_read_b32 v230, a18
    v_accvgpr_read_b32 v231, a19
    v_accvgpr_read_b32 v232, a40
    v_accvgpr_read_b32 v233, a41
    v_accvgpr_read_b32 v234, a42
    v_accvgpr_read_b32 v235, a43
    v_mul_f32 v228, v252, v228
    v_mul_f32 v229, v252, v229
    v_mul_f32 v230, v252, v230
    v_mul_f32 v231, v252, v231
    v_mul_f32 v232, v252, v232
    v_mul_f32 v233, v252, v233
    v_mul_f32 v234, v252, v234
    v_mul_f32 v235, v252, v235
    v_cvt_pk_bf16_f32 v228, v228, v229
    v_cvt_pk_bf16_f32 v229, v230, v231
    v_cvt_pk_bf16_f32 v230, v232, v233
    v_cvt_pk_bf16_f32 v231, v234, v235
    s_add_u32 s52, s52, 4096
    buffer_store_dwordx4 v[228:231], v1, s[28:31], s52 offen offset:0
    v_accvgpr_read_b32 v236, a20
    v_accvgpr_read_b32 v237, a21
    v_accvgpr_read_b32 v238, a22
    v_accvgpr_read_b32 v239, a23
    v_accvgpr_read_b32 v240, a44
    v_accvgpr_read_b32 v241, a45
    v_accvgpr_read_b32 v242, a46
    v_accvgpr_read_b32 v243, a47
    v_mul_f32 v236, v254, v236
    v_mul_f32 v237, v254, v237
    v_mul_f32 v238, v254, v238
    v_mul_f32 v239, v254, v239
    v_mul_f32 v240, v254, v240
    v_mul_f32 v241, v254, v241
    v_mul_f32 v242, v254, v242
    v_mul_f32 v243, v254, v243
    v_cvt_pk_bf16_f32 v236, v236, v237
    v_cvt_pk_bf16_f32 v237, v238, v239
    v_cvt_pk_bf16_f32 v238, v240, v241
    v_cvt_pk_bf16_f32 v239, v242, v243
    buffer_store_dwordx4 v[236:239], v1, s[28:31], s52 offen offset:1024
    v_accvgpr_read_b32 v228, a48
    v_accvgpr_read_b32 v229, a49
    v_accvgpr_read_b32 v230, a50
    v_accvgpr_read_b32 v231, a51
    v_accvgpr_read_b32 v232, a72
    v_accvgpr_read_b32 v233, a73
    v_accvgpr_read_b32 v234, a74
    v_accvgpr_read_b32 v235, a75
    v_mul_f32 v228, v244, v228
    v_mul_f32 v229, v244, v229
    v_mul_f32 v230, v244, v230
    v_mul_f32 v231, v244, v231
    v_mul_f32 v232, v244, v232
    v_mul_f32 v233, v244, v233
    v_mul_f32 v234, v244, v234
    v_mul_f32 v235, v244, v235
    v_cvt_pk_bf16_f32 v228, v228, v229
    v_cvt_pk_bf16_f32 v229, v230, v231
    v_cvt_pk_bf16_f32 v230, v232, v233
    v_cvt_pk_bf16_f32 v231, v234, v235
    buffer_store_dwordx4 v[228:231], v1, s[28:31], s52 offen offset:2048
    v_accvgpr_read_b32 v236, a52
    v_accvgpr_read_b32 v237, a53
    v_accvgpr_read_b32 v238, a54
    v_accvgpr_read_b32 v239, a55
    v_accvgpr_read_b32 v240, a76
    v_accvgpr_read_b32 v241, a77
    v_accvgpr_read_b32 v242, a78
    v_accvgpr_read_b32 v243, a79
    v_mul_f32 v236, v246, v236
    v_mul_f32 v237, v246, v237
    v_mul_f32 v238, v246, v238
    v_mul_f32 v239, v246, v239
    v_mul_f32 v240, v246, v240
    v_mul_f32 v241, v246, v241
    v_mul_f32 v242, v246, v242
    v_mul_f32 v243, v246, v243
    v_cvt_pk_bf16_f32 v236, v236, v237
    v_cvt_pk_bf16_f32 v237, v238, v239
    v_cvt_pk_bf16_f32 v238, v240, v241
    v_cvt_pk_bf16_f32 v239, v242, v243
    buffer_store_dwordx4 v[236:239], v1, s[28:31], s52 offen offset:3072
    s_add_u32 s52, s52, 4096
    v_lshrrev_b32 v2, 2, v0
    v_mul_u32_u24 v2, 1152, v2
    v_and_b32 v3, 3, v0
    v_lshl_add_u32 v2, v3, 3, v2
    v_add_u32 v2, 69632, v2
    v_bfe_u32 v3, v0, 3, 2
    v_lshlrev_b32 v4, 4, v0
    v_add_u32 v4, 143360, v4
    s_mul_i32 s55, s36, 9
    s_add_u32 s56, s55, 0
    s_and_b32 s58, s56, 3
    s_lshr_b32 s56, s56, 2
    s_lshl_b32 s56, s56, 7
    v_xor_b32 v9, s58, v3
    v_lshl_add_u32 v9, v9, 5, v2
    v_add_u32 v9, s56, v9
    ds_read_b128 a[228:231], v4 offset:0
    ds_read_b64_tr_b16 a[192:193], v9 offset:0
    ds_read_b64_tr_b16 a[194:195], v9 offset:18432
    v_mfma_f32_16x16x32_bf16 a[168:171], a[216:219], v[136:139], a[168:171]
    ds_read_b128 a[232:235], v4 offset:1024
    ds_read_b128 a[236:239], v4 offset:2048
    v_mfma_f32_16x16x32_bf16 a[172:175], a[216:219], v[144:147], a[172:175]
    ds_read_b128 a[240:243], v4 offset:3072
    ds_read_b128 a[244:247], v4 offset:4096
    v_mfma_f32_16x16x32_bf16 a[176:179], a[216:219], v[152:155], a[176:179]
    ds_read_b128 a[248:251], v4 offset:5120
    s_add_u32 s56, s55, 1
    v_mfma_f32_16x16x32_bf16 a[180:183], a[216:219], v[160:163], a[180:183]
    s_and_b32 s58, s56, 3
    s_lshr_b32 s56, s56, 2
    v_mfma_f32_16x16x32_bf16 a[184:187], a[216:219], v[168:171], a[184:187]
    s_lshl_b32 s56, s56, 7
    v_xor_b32 v10, s58, v3
    v_mfma_f32_16x16x32_bf16 a[188:191], a[216:219], v[176:179], a[188:191]
    v_lshl_add_u32 v10, v10, 5, v2
    v_add_u32 v10, s56, v10
    ds_read_b64_tr_b16 a[196:197], v10 offset:0
    ds_read_b64_tr_b16 a[198:199], v10 offset:18432
    s_waitcnt lgkmcnt(7)
    v_mfma_f32_16x16x32_bf16 v[36:39], a[192:195], a[228:231], 0
    s_add_u32 s56, s55, 2
    s_and_b32 s58, s56, 3
    s_waitcnt lgkmcnt(6)
    v_mfma_f32_16x16x32_bf16 v[40:43], a[192:195], a[232:235], 0
    s_lshr_b32 s56, s56, 2
    s_lshl_b32 s56, s56, 7
    s_waitcnt lgkmcnt(5)
    v_mfma_f32_16x16x32_bf16 v[44:47], a[192:195], a[236:239], 0
    v_xor_b32 v11, s58, v3
    v_lshl_add_u32 v11, v11, 5, v2
    s_waitcnt lgkmcnt(4)
    v_mfma_f32_16x16x32_bf16 v[48:51], a[192:195], a[240:243], 0
    v_add_u32 v11, s56, v11
    ds_read_b64_tr_b16 a[200:201], v11 offset:0
    s_waitcnt lgkmcnt(4)
    v_mfma_f32_16x16x32_bf16 v[52:55], a[192:195], a[244:247], 0
    ds_read_b64_tr_b16 a[202:203], v11 offset:18432
    s_add_u32 s56, s55, 3
    s_waitcnt lgkmcnt(4)
    v_mfma_f32_16x16x32_bf16 v[56:59], a[192:195], a[248:251], 0
    s_and_b32 s58, s56, 3
    s_lshr_b32 s56, s56, 2
    s_waitcnt lgkmcnt(2)
    v_mfma_f32_16x16x32_bf16 v[60:63], a[196:199], a[228:231], 0
    s_lshl_b32 s56, s56, 7
    v_xor_b32 v12, s58, v3
    v_mfma_f32_16x16x32_bf16 v[64:67], a[196:199], a[232:235], 0
    v_lshl_add_u32 v12, v12, 5, v2
    v_add_u32 v12, s56, v12
    v_mfma_f32_16x16x32_bf16 v[68:71], a[196:199], a[236:239], 0
    ds_read_b64_tr_b16 a[204:205], v12 offset:0
    ds_read_b64_tr_b16 a[206:207], v12 offset:18432
    v_mfma_f32_16x16x32_bf16 v[72:75], a[196:199], a[240:243], 0
    ds_read_b64_tr_b16 a[208:209], v9 offset:128
    ds_read_b64_tr_b16 a[210:211], v9 offset:18560
    v_mfma_f32_16x16x32_bf16 v[76:79], a[196:199], a[244:247], 0
    ds_read_b64_tr_b16 a[212:213], v10 offset:128
    ds_read_b64_tr_b16 a[214:215], v10 offset:18560
    v_mfma_f32_16x16x32_bf16 v[80:83], a[196:199], a[248:251], 0
    ds_read_b64_tr_b16 a[216:217], v11 offset:128
    ds_read_b64_tr_b16 a[218:219], v11 offset:18560
    s_waitcnt lgkmcnt(8)
    v_mfma_f32_16x16x32_bf16 v[84:87], a[200:203], a[228:231], 0
    ds_read_b64_tr_b16 a[220:221], v12 offset:128
    ds_read_b64_tr_b16 a[222:223], v12 offset:18560
    v_mfma_f32_16x16x32_bf16 v[88:91], a[200:203], a[232:235], 0
    ds_read_b64_tr_b16 a[224:225], v9 offset:256
    ds_read_b64_tr_b16 a[226:227], v9 offset:18688
    v_mfma_f32_16x16x32_bf16 v[92:95], a[200:203], a[236:239], 0
    v_accvgpr_read_b32 v228, a56
    v_accvgpr_read_b32 v229, a57
    v_mfma_f32_16x16x32_bf16 v[96:99], a[200:203], a[240:243], 0
    v_accvgpr_read_b32 v230, a58
    v_accvgpr_read_b32 v231, a59
    v_mfma_f32_16x16x32_bf16 v[100:103], a[200:203], a[244:247], 0
    v_accvgpr_read_b32 v232, a80
    v_accvgpr_read_b32 v233, a81
    v_mfma_f32_16x16x32_bf16 v[104:107], a[200:203], a[248:251], 0
    v_accvgpr_read_b32 v234, a82
    v_accvgpr_read_b32 v235, a83
    s_waitcnt lgkmcnt(10)
    v_mfma_f32_16x16x32_bf16 v[108:111], a[204:207], a[228:231], 0
    v_mul_f32 v228, v248, v228
    v_mul_f32 v229, v248, v229
    v_mfma_f32_16x16x32_bf16 v[112:115], a[204:207], a[232:235], 0
    v_mul_f32 v230, v248, v230
    v_mul_f32 v231, v248, v231
    v_mfma_f32_16x16x32_bf16 v[116:119], a[204:207], a[236:239], 0
    v_mul_f32 v232, v248, v232
    v_mul_f32 v233, v248, v233
    v_mfma_f32_16x16x32_bf16 v[120:123], a[204:207], a[240:243], 0
    v_mul_f32 v234, v248, v234
    v_mul_f32 v235, v248, v235
    v_mfma_f32_16x16x32_bf16 v[124:127], a[204:207], a[244:247], 0
    v_cvt_pk_bf16_f32 v228, v228, v229
    v_cvt_pk_bf16_f32 v229, v230, v231
    v_mfma_f32_16x16x32_bf16 v[128:131], a[204:207], a[248:251], 0
    v_cvt_pk_bf16_f32 v230, v232, v233
    v_cvt_pk_bf16_f32 v231, v234, v235
    s_waitcnt lgkmcnt(8)
    v_mfma_f32_16x16x32_bf16 v[132:135], a[208:211], a[228:231], 0
    buffer_store_dwordx4 v[228:231], v1, s[28:31], s52 offen offset:0
    v_mfma_f32_16x16x32_bf16 v[136:139], a[208:211], a[232:235], 0
    v_accvgpr_read_b32 v236, a60
    v_accvgpr_read_b32 v237, a61
    v_mfma_f32_16x16x32_bf16 v[140:143], a[208:211], a[236:239], 0
    v_accvgpr_read_b32 v238, a62
    v_accvgpr_read_b32 v239, a63
    v_mfma_f32_16x16x32_bf16 v[144:147], a[208:211], a[240:243], 0
    v_accvgpr_read_b32 v240, a84
    v_accvgpr_read_b32 v241, a85
    v_mfma_f32_16x16x32_bf16 v[148:151], a[208:211], a[244:247], 0
    v_accvgpr_read_b32 v242, a86
    v_accvgpr_read_b32 v243, a87
    v_mfma_f32_16x16x32_bf16 v[152:155], a[208:211], a[248:251], 0
    v_mul_f32 v236, v250, v236
    v_mul_f32 v237, v250, v237
    s_waitcnt lgkmcnt(6)
    v_mfma_f32_16x16x32_bf16 v[156:159], a[212:215], a[228:231], 0
    v_mul_f32 v238, v250, v238
    v_mul_f32 v239, v250, v239
    v_mfma_f32_16x16x32_bf16 v[160:163], a[212:215], a[232:235], 0
    v_mul_f32 v240, v250, v240
    v_mul_f32 v241, v250, v241
    v_mfma_f32_16x16x32_bf16 v[164:167], a[212:215], a[236:239], 0
    v_mul_f32 v242, v250, v242
    v_mul_f32 v243, v250, v243
    v_mfma_f32_16x16x32_bf16 v[168:171], a[212:215], a[240:243], 0
    v_cvt_pk_bf16_f32 v236, v236, v237
    v_cvt_pk_bf16_f32 v237, v238, v239
    v_mfma_f32_16x16x32_bf16 v[172:175], a[212:215], a[244:247], 0
    v_cvt_pk_bf16_f32 v238, v240, v241
    v_cvt_pk_bf16_f32 v239, v242, v243
    v_mfma_f32_16x16x32_bf16 v[176:179], a[212:215], a[248:251], 0
    buffer_store_dwordx4 v[236:239], v1, s[28:31], s52 offen offset:1024
    s_waitcnt lgkmcnt(4)
    v_mfma_f32_16x16x32_bf16 v[180:183], a[216:219], a[228:231], 0
    v_accvgpr_read_b32 v228, a64
    v_accvgpr_read_b32 v229, a65
    v_mfma_f32_16x16x32_bf16 v[184:187], a[216:219], a[232:235], 0
    v_accvgpr_read_b32 v230, a66
    v_accvgpr_read_b32 v231, a67
    v_mfma_f32_16x16x32_bf16 v[188:191], a[216:219], a[236:239], 0
    v_accvgpr_read_b32 v232, a88
    v_accvgpr_read_b32 v233, a89
    v_mfma_f32_16x16x32_bf16 v[192:195], a[216:219], a[240:243], 0
    v_accvgpr_read_b32 v234, a90
    v_accvgpr_read_b32 v235, a91
    v_mfma_f32_16x16x32_bf16 v[196:199], a[216:219], a[244:247], 0
    v_mul_f32 v228, v252, v228
    v_mul_f32 v229, v252, v229
    v_mfma_f32_16x16x32_bf16 v[200:203], a[216:219], a[248:251], 0
    v_mul_f32 v230, v252, v230
    v_mul_f32 v231, v252, v231
    s_waitcnt lgkmcnt(2)
    v_mfma_f32_16x16x32_bf16 v[204:207], a[220:223], a[228:231], 0
    v_mul_f32 v232, v252, v232
    v_mul_f32 v233, v252, v233
    v_mfma_f32_16x16x32_bf16 v[208:211], a[220:223], a[232:235], 0
    v_mul_f32 v234, v252, v234
    v_mul_f32 v235, v252, v235
    v_mfma_f32_16x16x32_bf16 v[212:215], a[220:223], a[236:239], 0
    v_cvt_pk_bf16_f32 v228, v228, v229
    v_cvt_pk_bf16_f32 v229, v230, v231
    v_mfma_f32_16x16x32_bf16 v[216:219], a[220:223], a[240:243], 0
    v_cvt_pk_bf16_f32 v230, v232, v233
    v_cvt_pk_bf16_f32 v231, v234, v235
    v_mfma_f32_16x16x32_bf16 v[220:223], a[220:223], a[244:247], 0
    buffer_store_dwordx4 v[228:231], v1, s[28:31], s52 offen offset:2048
    v_mfma_f32_16x16x32_bf16 v[224:227], a[220:223], a[248:251], 0
    v_accvgpr_read_b32 v236, a68
    v_accvgpr_read_b32 v237, a69
    v_accvgpr_read_b32 v238, a70
    v_accvgpr_read_b32 v239, a71
    v_accvgpr_read_b32 v240, a92
    v_accvgpr_read_b32 v241, a93
    v_accvgpr_read_b32 v242, a94
    v_accvgpr_read_b32 v243, a95
    v_mul_f32 v236, v254, v236
    v_mul_f32 v237, v254, v237
    v_mul_f32 v238, v254, v238
    v_mul_f32 v239, v254, v239
    v_mul_f32 v240, v254, v240
    v_mul_f32 v241, v254, v241
    v_mul_f32 v242, v254, v242
    v_mul_f32 v243, v254, v243
    v_cvt_pk_bf16_f32 v236, v236, v237
    v_cvt_pk_bf16_f32 v237, v238, v239
    v_cvt_pk_bf16_f32 v238, v240, v241
    v_cvt_pk_bf16_f32 v239, v242, v243
    buffer_store_dwordx4 v[236:239], v1, s[28:31], s52 offen offset:3072
    s_sub_u32 s91, s89, s88
    s_cmp_eq_u32 s92, 155648
    s_cselect_b32 s94, 4294955008, s93
    s_waitcnt lgkmcnt(0)
    s_waitcnt vmcnt(23)
    s_barrier
    v_add_u32 v9, s91, v9
    v_add_u32 v4, s94, v4
    ds_read_b128 a[36:39], v4 offset:0
    ds_read_b64_tr_b16 a[0:1], v9 offset:0
    ds_read_b64_tr_b16 a[2:3], v9 offset:18432
    v_mfma_f32_16x16x32_bf16 a[60:63], a[224:227], a[228:231], 0
    ds_read_b128 a[40:43], v4 offset:1024
    ds_read_b128 a[44:47], v4 offset:2048
    v_mfma_f32_16x16x32_bf16 a[64:67], a[224:227], a[232:235], 0
    ds_read_b128 a[48:51], v4 offset:3072
    ds_read_b128 a[52:55], v4 offset:4096
    v_mfma_f32_16x16x32_bf16 a[68:71], a[224:227], a[236:239], 0
    ds_read_b128 a[56:59], v4 offset:5120
    v_add_u32 v10, s91, v10
    v_mfma_f32_16x16x32_bf16 a[72:75], a[224:227], a[240:243], 0
    ds_read_b64_tr_b16 a[4:5], v10 offset:0
    ds_read_b64_tr_b16 a[6:7], v10 offset:18432
    v_mfma_f32_16x16x32_bf16 a[76:79], a[224:227], a[244:247], 0
    v_add_u32 v11, s91, v11
    ds_read_b64_tr_b16 a[8:9], v11 offset:0
    v_mfma_f32_16x16x32_bf16 a[80:83], a[224:227], a[248:251], 0
    ds_read_b64_tr_b16 a[10:11], v11 offset:18432
    v_add_u32 v12, s91, v12
    s_waitcnt lgkmcnt(9)
    v_mfma_f32_16x16x32_bf16 v[36:39], a[0:3], a[36:39], v[36:39]
    ds_read_b64_tr_b16 a[12:13], v12 offset:0
    ds_read_b64_tr_b16 a[14:15], v12 offset:18432
    s_waitcnt lgkmcnt(10)
    v_mfma_f32_16x16x32_bf16 v[40:43], a[0:3], a[40:43], v[40:43]
    ds_read_b64_tr_b16 a[16:17], v9 offset:128
    ds_read_b64_tr_b16 a[18:19], v9 offset:18560
    s_waitcnt lgkmcnt(11)
    v_mfma_f32_16x16x32_bf16 v[44:47], a[0:3], a[44:47], v[44:47]
    ds_read_b64_tr_b16 a[20:21], v10 offset:128
    ds_read_b64_tr_b16 a[22:23], v10 offset:18560
    s_waitcnt lgkmcnt(12)
    v_mfma_f32_16x16x32_bf16 v[48:51], a[0:3], a[48:51], v[48:51]
    ds_read_b64_tr_b16 a[24:25], v11 offset:128
    ds_read_b64_tr_b16 a[26:27], v11 offset:18560
    s_waitcnt lgkmcnt(13)
    v_mfma_f32_16x16x32_bf16 v[52:55], a[0:3], a[52:55], v[52:55]
    ds_read_b64_tr_b16 a[28:29], v12 offset:128
    ds_read_b64_tr_b16 a[30:31], v12 offset:18560
    s_waitcnt lgkmcnt(14)
    v_mfma_f32_16x16x32_bf16 v[56:59], a[0:3], a[56:59], v[56:59]
    ds_read_b64_tr_b16 a[32:33], v9 offset:256
    ds_read_b64_tr_b16 a[34:35], v9 offset:18688
    s_waitcnt lgkmcnt(14)
    v_mfma_f32_16x16x32_bf16 v[60:63], a[4:7], a[36:39], v[60:63]
    s_add_u32 s57, s41, s88
    s_mov_b32 m0, s57
    v_mfma_f32_16x16x32_bf16 v[64:67], a[4:7], a[40:43], v[64:67]
    buffer_load_dwordx4 v17, s[20:23], s45 offen offset:0 lds
    v_mfma_f32_16x16x32_bf16 v[68:71], a[4:7], a[44:47], v[68:71]
    buffer_load_dwordx4 v18, s[20:23], s45 offen offset:1024 lds
    v_mfma_f32_16x16x32_bf16 v[72:75], a[4:7], a[48:51], v[72:75]
    buffer_load_dwordx4 v19, s[20:23], s45 offen offset:2048 lds
    v_mfma_f32_16x16x32_bf16 v[76:79], a[4:7], a[52:55], v[76:79]
    buffer_load_dwordx4 v20, s[20:23], s45 offen offset:3072 lds
    v_mfma_f32_16x16x32_bf16 v[80:83], a[4:7], a[56:59], v[80:83]
    s_add_u32 m0, s57, 4096
    s_mov_b32 s53, s88
    s_waitcnt lgkmcnt(12)
    v_mfma_f32_16x16x32_bf16 v[84:87], a[8:11], a[36:39], v[84:87]
    buffer_load_dwordx4 v21, s[20:23], s45 offen offset:0 lds
    v_mfma_f32_16x16x32_bf16 v[88:91], a[8:11], a[40:43], v[88:91]
    buffer_load_dwordx4 v22, s[20:23], s45 offen offset:1024 lds
    v_mfma_f32_16x16x32_bf16 v[92:95], a[8:11], a[44:47], v[92:95]
    buffer_load_dwordx4 v23, s[20:23], s45 offen offset:2048 lds
    v_mfma_f32_16x16x32_bf16 v[96:99], a[8:11], a[48:51], v[96:99]
    buffer_load_dwordx4 v24, s[20:23], s45 offen offset:3072 lds
    v_mfma_f32_16x16x32_bf16 v[100:103], a[8:11], a[52:55], v[100:103]
    s_add_u32 m0, s57, 8192
    s_mov_b32 s88, s89
    v_mfma_f32_16x16x32_bf16 v[104:107], a[8:11], a[56:59], v[104:107]
    buffer_load_dwordx4 v25, s[20:23], s45 offen offset:0 lds
    s_waitcnt lgkmcnt(10)
    v_mfma_f32_16x16x32_bf16 v[108:111], a[12:15], a[36:39], v[108:111]
    s_add_u32 m0, s42, s92
    s_add_u32 s58, s1, s0
    v_mfma_f32_16x16x32_bf16 v[112:115], a[12:15], a[40:43], v[112:115]
    buffer_load_dwordx4 v26, s[28:31], s47 offen lds
    v_mfma_f32_16x16x32_bf16 v[116:119], a[12:15], a[44:47], v[116:119]
    s_mov_b32 exec_hi, 0
    buffer_load_dwordx4 v26, s[28:31], s47 offen offset:1024 lds
    s_mov_b32 exec_hi, -1
    v_mfma_f32_16x16x32_bf16 v[120:123], a[12:15], a[48:51], v[120:123]
    s_and_b32 s58, s58, 15
    s_andn2_b32 s59, s1, 15
    v_mfma_f32_16x16x32_bf16 v[124:127], a[12:15], a[52:55], v[124:127]
    s_add_u32 s58, s58, s59
    s_mul_i32 s47, s58, 6144
    v_mfma_f32_16x16x32_bf16 v[128:131], a[12:15], a[56:59], v[128:131]
    s_add_u32 s47, s47, s42
    s_add_u32 s1, s1, 1
    s_waitcnt lgkmcnt(8)
    v_mfma_f32_16x16x32_bf16 v[132:135], a[16:19], a[36:39], v[132:135]
    s_add_u32 s92, s92, s94
    s_mov_b32 s89, s90
    v_mfma_f32_16x16x32_bf16 v[136:139], a[16:19], a[40:43], v[136:139]
    v_accvgpr_read_b32 v228, a96
    v_accvgpr_read_b32 v229, a97
    v_mfma_f32_16x16x32_bf16 v[140:143], a[16:19], a[44:47], v[140:143]
    v_accvgpr_read_b32 v230, a98
    v_accvgpr_read_b32 v231, a99
    v_mfma_f32_16x16x32_bf16 v[144:147], a[16:19], a[48:51], v[144:147]
    v_accvgpr_read_b32 v232, a120
    v_accvgpr_read_b32 v233, a121
    v_mfma_f32_16x16x32_bf16 v[148:151], a[16:19], a[52:55], v[148:151]
    v_accvgpr_read_b32 v234, a122
    v_accvgpr_read_b32 v235, a123
    v_mfma_f32_16x16x32_bf16 v[152:155], a[16:19], a[56:59], v[152:155]
    v_mul_f32 v228, v244, v228
    v_mul_f32 v229, v244, v229
    s_waitcnt lgkmcnt(6)
    v_mfma_f32_16x16x32_bf16 v[156:159], a[20:23], a[36:39], v[156:159]
    v_mul_f32 v230, v244, v230
    v_mul_f32 v231, v244, v231
    v_mfma_f32_16x16x32_bf16 v[160:163], a[20:23], a[40:43], v[160:163]
    v_mul_f32 v232, v244, v232
    v_mul_f32 v233, v244, v233
    v_mfma_f32_16x16x32_bf16 v[164:167], a[20:23], a[44:47], v[164:167]
    v_mul_f32 v234, v244, v234
    v_mul_f32 v235, v244, v235
    v_mfma_f32_16x16x32_bf16 v[168:171], a[20:23], a[48:51], v[168:171]
    v_cvt_pk_bf16_f32 v228, v228, v229
    v_cvt_pk_bf16_f32 v229, v230, v231
    v_mfma_f32_16x16x32_bf16 v[172:175], a[20:23], a[52:55], v[172:175]
    v_cvt_pk_bf16_f32 v230, v232, v233
    v_cvt_pk_bf16_f32 v231, v234, v235
    v_mfma_f32_16x16x32_bf16 v[176:179], a[20:23], a[56:59], v[176:179]
    s_add_u32 s52, s52, 4096
    v_accvgpr_read_b32 v236, a100
    s_waitcnt lgkmcnt(4)
    v_mfma_f32_16x16x32_bf16 v[180:183], a[24:27], a[36:39], v[180:183]
    buffer_store_dwordx4 v[228:231], v1, s[28:31], s52 offen offset:0
    v_mfma_f32_16x16x32_bf16 v[184:187], a[24:27], a[40:43], v[184:187]
    v_accvgpr_read_b32 v237, a101
    v_accvgpr_read_b32 v238, a102
    v_mfma_f32_16x16x32_bf16 v[188:191], a[24:27], a[44:47], v[188:191]
    v_accvgpr_read_b32 v239, a103
    v_accvgpr_read_b32 v240, a124
    v_mfma_f32_16x16x32_bf16 v[192:195], a[24:27], a[48:51], v[192:195]
    v_accvgpr_read_b32 v241, a125
    v_accvgpr_read_b32 v242, a126
    v_mfma_f32_16x16x32_bf16 v[196:199], a[24:27], a[52:55], v[196:199]
    v_accvgpr_read_b32 v243, a127
    v_mul_f32 v236, v246, v236
    v_mfma_f32_16x16x32_bf16 v[200:203], a[24:27], a[56:59], v[200:203]
    v_mul_f32 v237, v246, v237
    v_mul_f32 v238, v246, v238
    s_waitcnt lgkmcnt(2)
    v_mfma_f32_16x16x32_bf16 v[204:207], a[28:31], a[36:39], v[204:207]
    v_mul_f32 v239, v246, v239
    v_mul_f32 v240, v246, v240
    v_mfma_f32_16x16x32_bf16 v[208:211], a[28:31], a[40:43], v[208:211]
    v_mul_f32 v241, v246, v241
    v_mul_f32 v242, v246, v242
    v_mfma_f32_16x16x32_bf16 v[212:215], a[28:31], a[44:47], v[212:215]
    v_mul_f32 v243, v246, v243
    v_cvt_pk_bf16_f32 v236, v236, v237
    v_mfma_f32_16x16x32_bf16 v[216:219], a[28:31], a[48:51], v[216:219]
    v_cvt_pk_bf16_f32 v237, v238, v239
    v_cvt_pk_bf16_f32 v238, v240, v241
    v_mfma_f32_16x16x32_bf16 v[220:223], a[28:31], a[52:55], v[220:223]
    v_cvt_pk_bf16_f32 v239, v242, v243
    v_accvgpr_read_b32 v228, a104
    v_mfma_f32_16x16x32_bf16 v[224:227], a[28:31], a[56:59], v[224:227]
    buffer_store_dwordx4 v[236:239], v1, s[28:31], s52 offen offset:1024
    v_accvgpr_read_b32 v229, a105
    v_accvgpr_read_b32 v230, a106
    v_accvgpr_read_b32 v231, a107
    v_accvgpr_read_b32 v232, a128
    v_accvgpr_read_b32 v233, a129
    v_accvgpr_read_b32 v234, a130
    v_accvgpr_read_b32 v235, a131
    v_mul_f32 v228, v248, v228
    v_mul_f32 v229, v248, v229
    v_mul_f32 v230, v248, v230
    v_mul_f32 v231, v248, v231
    v_mul_f32 v232, v248, v232
    v_mul_f32 v233, v248, v233
    v_mul_f32 v234, v248, v234
    v_mul_f32 v235, v248, v235
    v_cvt_pk_bf16_f32 v228, v228, v229
    v_cvt_pk_bf16_f32 v229, v230, v231
    v_cvt_pk_bf16_f32 v230, v232, v233
    v_cvt_pk_bf16_f32 v231, v234, v235
    buffer_store_dwordx4 v[228:231], v1, s[28:31], s52 offen offset:2048
    v_accvgpr_read_b32 v236, a108
    v_accvgpr_read_b32 v237, a109
    v_accvgpr_read_b32 v238, a110
    v_accvgpr_read_b32 v239, a111
    v_accvgpr_read_b32 v240, a132
    v_accvgpr_read_b32 v241, a133
    v_accvgpr_read_b32 v242, a134
    v_accvgpr_read_b32 v243, a135
    v_mul_f32 v236, v250, v236
    v_mul_f32 v237, v250, v237
    v_mul_f32 v238, v250, v238
    v_mul_f32 v239, v250, v239
    v_mul_f32 v240, v250, v240
    v_mul_f32 v241, v250, v241
    v_mul_f32 v242, v250, v242
    v_mul_f32 v243, v250, v243
    v_cvt_pk_bf16_f32 v236, v236, v237
    v_cvt_pk_bf16_f32 v237, v238, v239
    v_cvt_pk_bf16_f32 v238, v240, v241
    v_cvt_pk_bf16_f32 v239, v242, v243
    buffer_store_dwordx4 v[236:239], v1, s[28:31], s52 offen offset:3072
    v_accvgpr_read_b32 v228, a112
    v_accvgpr_read_b32 v229, a113
    v_accvgpr_read_b32 v230, a114
    v_accvgpr_read_b32 v231, a115
    v_accvgpr_read_b32 v232, a136
    v_accvgpr_read_b32 v233, a137
    v_accvgpr_read_b32 v234, a138
    v_accvgpr_read_b32 v235, a139
    v_mul_f32 v228, v252, v228
    v_mul_f32 v229, v252, v229
    v_mul_f32 v230, v252, v230
    v_mul_f32 v231, v252, v231
    v_mul_f32 v232, v252, v232
    v_mul_f32 v233, v252, v233
    v_mul_f32 v234, v252, v234
    v_mul_f32 v235, v252, v235
    v_cvt_pk_bf16_f32 v228, v228, v229
    v_cvt_pk_bf16_f32 v229, v230, v231
    v_cvt_pk_bf16_f32 v230, v232, v233
    v_cvt_pk_bf16_f32 v231, v234, v235
    s_add_u32 s52, s52, 4096
    buffer_store_dwordx4 v[228:231], v1, s[28:31], s52 offen offset:0
    v_accvgpr_read_b32 v236, a116
    v_accvgpr_read_b32 v237, a117
    v_accvgpr_read_b32 v238, a118
    v_accvgpr_read_b32 v239, a119
    v_accvgpr_read_b32 v240, a140
    v_accvgpr_read_b32 v241, a141
    v_accvgpr_read_b32 v242, a142
    v_accvgpr_read_b32 v243, a143
    v_mul_f32 v236, v254, v236
    v_mul_f32 v237, v254, v237
    v_mul_f32 v238, v254, v238
    v_mul_f32 v239, v254, v239
    v_mul_f32 v240, v254, v240
    v_mul_f32 v241, v254, v241
    v_mul_f32 v242, v254, v242
    v_mul_f32 v243, v254, v243
    v_cvt_pk_bf16_f32 v236, v236, v237
    v_cvt_pk_bf16_f32 v237, v238, v239
    v_cvt_pk_bf16_f32 v238, v240, v241
    v_cvt_pk_bf16_f32 v239, v242, v243
    buffer_store_dwordx4 v[236:239], v1, s[28:31], s52 offen offset:1024
    s_sub_u32 s91, s89, s88
    s_cmp_eq_u32 s92, 155648
    s_cselect_b32 s94, 4294955008, s93
    s_waitcnt lgkmcnt(0)
    s_waitcnt vmcnt(29)
    s_barrier
    v_add_u32 v9, s91, v9
    v_add_u32 v4, s94, v4
    ds_read_b128 a[228:231], v4 offset:0
    ds_read_b64_tr_b16 a[192:193], v9 offset:0
    ds_read_b64_tr_b16 a[194:195], v9 offset:18432
    v_mfma_f32_16x16x32_bf16 a[60:63], a[32:35], a[36:39], a[60:63]
    ds_read_b128 a[232:235], v4 offset:1024
    ds_read_b128 a[236:239], v4 offset:2048
    v_mfma_f32_16x16x32_bf16 a[64:67], a[32:35], a[40:43], a[64:67]
    ds_read_b128 a[240:243], v4 offset:3072
    ds_read_b128 a[244:247], v4 offset:4096
    v_mfma_f32_16x16x32_bf16 a[68:71], a[32:35], a[44:47], a[68:71]
    ds_read_b128 a[248:251], v4 offset:5120
    v_add_u32 v10, s91, v10
    v_mfma_f32_16x16x32_bf16 a[72:75], a[32:35], a[48:51], a[72:75]
    ds_read_b64_tr_b16 a[196:197], v10 offset:0
    ds_read_b64_tr_b16 a[198:199], v10 offset:18432
    v_mfma_f32_16x16x32_bf16 a[76:79], a[32:35], a[52:55], a[76:79]
    v_add_u32 v11, s91, v11
    ds_read_b64_tr_b16 a[200:201], v11 offset:0
    v_mfma_f32_16x16x32_bf16 a[80:83], a[32:35], a[56:59], a[80:83]
    ds_read_b64_tr_b16 a[202:203], v11 offset:18432
    v_add_u32 v12, s91, v12
    s_waitcnt lgkmcnt(9)
    v_mfma_f32_16x16x32_bf16 v[36:39], a[192:195], a[228:231], v[36:39]
    ds_read_b64_tr_b16 a[204:205], v12 offset:0
    ds_read_b64_tr_b16 a[206:207], v12 offset:18432
    s_waitcnt lgkmcnt(10)
    v_mfma_f32_16x16x32_bf16 v[40:43], a[192:195], a[232:235], v[40:43]
    ds_read_b64_tr_b16 a[208:209], v9 offset:128
    ds_read_b64_tr_b16 a[210:211], v9 offset:18560
    s_waitcnt lgkmcnt(11)
    v_mfma_f32_16x16x32_bf16 v[44:47], a[192:195], a[236:239], v[44:47]
    ds_read_b64_tr_b16 a[212:213], v10 offset:128
    ds_read_b64_tr_b16 a[214:215], v10 offset:18560
    s_waitcnt lgkmcnt(12)
    v_mfma_f32_16x16x32_bf16 v[48:51], a[192:195], a[240:243], v[48:51]
    ds_read_b64_tr_b16 a[216:217], v11 offset:128
    ds_read_b64_tr_b16 a[218:219], v11 offset:18560
    s_waitcnt lgkmcnt(13)
    v_mfma_f32_16x16x32_bf16 v[52:55], a[192:195], a[244:247], v[52:55]
    ds_read_b64_tr_b16 a[220:221], v12 offset:128
    ds_read_b64_tr_b16 a[222:223], v12 offset:18560
    s_waitcnt lgkmcnt(14)
    v_mfma_f32_16x16x32_bf16 v[56:59], a[192:195], a[248:251], v[56:59]
    ds_read_b64_tr_b16 a[224:225], v9 offset:256
    ds_read_b64_tr_b16 a[226:227], v9 offset:18688
    s_waitcnt lgkmcnt(14)
    v_mfma_f32_16x16x32_bf16 v[60:63], a[196:199], a[228:231], v[60:63]
    v_mov_b32 v245, v244
    v_mov_b32 v247, v246
    v_mfma_f32_16x16x32_bf16 v[64:67], a[196:199], a[232:235], v[64:67]
    v_mov_b32 v249, v248
    v_mov_b32 v251, v250
    v_mfma_f32_16x16x32_bf16 v[68:71], a[196:199], a[236:239], v[68:71]
    v_mov_b32 v253, v252
    v_mov_b32 v255, v254
    v_mfma_f32_16x16x32_bf16 v[72:75], a[196:199], a[240:243], v[72:75]
    s_mul_i32 s45, s58, 36864
    s_mov_b32 s90, s53
    v_mfma_f32_16x16x32_bf16 v[76:79], a[196:199], a[244:247], v[76:79]
    s_add_u32 s57, s41, s88
    s_mov_b32 m0, s57
    v_mfma_f32_16x16x32_bf16 v[80:83], a[196:199], a[248:251], v[80:83]
    buffer_load_dwordx4 v17, s[20:23], s45 offen offset:0 lds
    s_waitcnt lgkmcnt(12)
    v_mfma_f32_16x16x32_bf16 v[84:87], a[200:203], a[228:231], v[84:87]
    buffer_load_dwordx4 v18, s[20:23], s45 offen offset:1024 lds
    v_mfma_f32_16x16x32_bf16 v[88:91], a[200:203], a[232:235], v[88:91]
    buffer_load_dwordx4 v19, s[20:23], s45 offen offset:2048 lds
    v_mfma_f32_16x16x32_bf16 v[92:95], a[200:203], a[236:239], v[92:95]
    buffer_load_dwordx4 v20, s[20:23], s45 offen offset:3072 lds
    v_mfma_f32_16x16x32_bf16 v[96:99], a[200:203], a[240:243], v[96:99]
    s_add_u32 m0, s57, 4096
    s_mov_b32 s53, s88
    v_mfma_f32_16x16x32_bf16 v[100:103], a[200:203], a[244:247], v[100:103]
    buffer_load_dwordx4 v21, s[20:23], s45 offen offset:0 lds
    v_mfma_f32_16x16x32_bf16 v[104:107], a[200:203], a[248:251], v[104:107]
    buffer_load_dwordx4 v22, s[20:23], s45 offen offset:1024 lds
    s_waitcnt lgkmcnt(10)
    v_mfma_f32_16x16x32_bf16 v[108:111], a[204:207], a[228:231], v[108:111]
    buffer_load_dwordx4 v23, s[20:23], s45 offen offset:2048 lds
    v_mfma_f32_16x16x32_bf16 v[112:115], a[204:207], a[232:235], v[112:115]
    buffer_load_dwordx4 v24, s[20:23], s45 offen offset:3072 lds
    v_mfma_f32_16x16x32_bf16 v[116:119], a[204:207], a[236:239], v[116:119]
    s_add_u32 m0, s57, 8192
    s_mov_b32 s88, s89
    v_mfma_f32_16x16x32_bf16 v[120:123], a[204:207], a[240:243], v[120:123]
    buffer_load_dwordx4 v25, s[20:23], s45 offen offset:0 lds
    v_mfma_f32_16x16x32_bf16 v[124:127], a[204:207], a[244:247], v[124:127]
    s_add_u32 m0, s42, s92
    s_add_u32 s58, s1, s0
    v_mfma_f32_16x16x32_bf16 v[128:131], a[204:207], a[248:251], v[128:131]
    buffer_load_dwordx4 v26, s[28:31], s47 offen lds
    s_waitcnt lgkmcnt(8)
    v_mfma_f32_16x16x32_bf16 v[132:135], a[208:211], a[228:231], v[132:135]
    s_mov_b32 exec_hi, 0
    buffer_load_dwordx4 v26, s[28:31], s47 offen offset:1024 lds
    s_mov_b32 exec_hi, -1
    v_mfma_f32_16x16x32_bf16 v[136:139], a[208:211], a[232:235], v[136:139]
    s_and_b32 s58, s58, 15
    s_andn2_b32 s59, s1, 15
    v_mfma_f32_16x16x32_bf16 v[140:143], a[208:211], a[236:239], v[140:143]
    s_add_u32 s58, s58, s59
    s_mul_i32 s45, s58, 36864
    v_mfma_f32_16x16x32_bf16 v[144:147], a[208:211], a[240:243], v[144:147]
    s_mul_i32 s47, s58, 6144
    s_add_u32 s47, s47, s42
    v_mfma_f32_16x16x32_bf16 v[148:151], a[208:211], a[244:247], v[148:151]
    s_add_u32 s1, s1, 1
    s_add_u32 s92, s92, s94
    v_mfma_f32_16x16x32_bf16 v[152:155], a[208:211], a[248:251], v[152:155]
    s_mov_b32 s89, s90
    s_mov_b32 s90, s53
    s_waitcnt lgkmcnt(6)
    v_mfma_f32_16x16x32_bf16 v[156:159], a[212:215], a[228:231], v[156:159]
    v_accvgpr_read_b32 v228, a144
    v_accvgpr_read_b32 v229, a145
    v_mfma_f32_16x16x32_bf16 v[160:163], a[212:215], a[232:235], v[160:163]
    v_accvgpr_read_b32 v230, a146
    v_accvgpr_read_b32 v231, a147
    v_mfma_f32_16x16x32_bf16 v[164:167], a[212:215], a[236:239], v[164:167]
    v_accvgpr_read_b32 v232, a168
    v_accvgpr_read_b32 v233, a169
    v_mfma_f32_16x16x32_bf16 v[168:171], a[212:215], a[240:243], v[168:171]
    v_accvgpr_read_b32 v234, a170
    v_accvgpr_read_b32 v235, a171
    v_mfma_f32_16x16x32_bf16 v[172:175], a[212:215], a[244:247], v[172:175]
    v_mul_f32 v228, v244, v228
    v_mul_f32 v229, v244, v229
    v_mfma_f32_16x16x32_bf16 v[176:179], a[212:215], a[248:251], v[176:179]
    v_mul_f32 v230, v244, v230
    v_mul_f32 v231, v244, v231
    s_waitcnt lgkmcnt(4)
    v_mfma_f32_16x16x32_bf16 v[180:183], a[216:219], a[228:231], v[180:183]
    v_mul_f32 v232, v244, v232
    v_mul_f32 v233, v244, v233
    v_mfma_f32_16x16x32_bf16 v[184:187], a[216:219], a[232:235], v[184:187]
    v_mul_f32 v234, v244, v234
    v_mul_f32 v235, v244, v235
    v_mfma_f32_16x16x32_bf16 v[188:191], a[216:219], a[236:239], v[188:191]
    v_cvt_pk_bf16_f32 v228, v228, v229
    v_cvt_pk_bf16_f32 v229, v230, v231
    v_mfma_f32_16x16x32_bf16 v[192:195], a[216:219], a[240:243], v[192:195]
    v_cvt_pk_bf16_f32 v230, v232, v233
    v_cvt_pk_bf16_f32 v231, v234, v235
    v_mfma_f32_16x16x32_bf16 v[196:199], a[216:219], a[244:247], v[196:199]
    buffer_store_dwordx4 v[228:231], v1, s[28:31], s52 offen offset:2048
    v_mfma_f32_16x16x32_bf16 v[200:203], a[216:219], a[248:251], v[200:203]
    v_accvgpr_read_b32 v236, a148
    v_accvgpr_read_b32 v237, a149
    s_waitcnt lgkmcnt(2)
    v_mfma_f32_16x16x32_bf16 v[204:207], a[220:223], a[228:231], v[204:207]
    v_accvgpr_read_b32 v238, a150
    v_accvgpr_read_b32 v239, a151
    v_mfma_f32_16x16x32_bf16 v[208:211], a[220:223], a[232:235], v[208:211]
    v_accvgpr_read_b32 v240, a172
    v_accvgpr_read_b32 v241, a173
    v_mfma_f32_16x16x32_bf16 v[212:215], a[220:223], a[236:239], v[212:215]
    v_accvgpr_read_b32 v242, a174
    v_accvgpr_read_b32 v243, a175
    v_mfma_f32_16x16x32_bf16 v[216:219], a[220:223], a[240:243], v[216:219]
    v_mul_f32 v236, v246, v236
    v_mul_f32 v237, v246, v237
    v_mfma_f32_16x16x32_bf16 v[220:223], a[220:223], a[244:247], v[220:223]
    v_mul_f32 v238, v246, v238
    v_mul_f32 v239, v246, v239
    v_mfma_f32_16x16x32_bf16 v[224:227], a[220:223], a[248:251], v[224:227]
    v_mul_f32 v240, v246, v240
    v_mul_f32 v241, v246, v241
    s_waitcnt lgkmcnt(0)
    v_mfma_f32_16x16x32_bf16 a[60:63], a[224:227], a[228:231], a[60:63]
    v_mul_f32 v242, v246, v242
    v_mul_f32 v243, v246, v243
    v_mfma_f32_16x16x32_bf16 a[64:67], a[224:227], a[232:235], a[64:67]
    v_cvt_pk_bf16_f32 v236, v236, v237
    v_cvt_pk_bf16_f32 v237, v238, v239
    v_mfma_f32_16x16x32_bf16 a[68:71], a[224:227], a[236:239], a[68:71]
    v_cvt_pk_bf16_f32 v238, v240, v241
    v_cvt_pk_bf16_f32 v239, v242, v243
    v_mfma_f32_16x16x32_bf16 a[72:75], a[224:227], a[240:243], a[72:75]
    buffer_store_dwordx4 v[236:239], v1, s[28:31], s52 offen offset:3072
    v_mfma_f32_16x16x32_bf16 a[76:79], a[224:227], a[244:247], a[76:79]
    v_accvgpr_read_b32 v228, a152
    v_accvgpr_read_b32 v229, a153
    v_mfma_f32_16x16x32_bf16 a[80:83], a[224:227], a[248:251], a[80:83]
    v_accvgpr_read_b32 v230, a154
    v_accvgpr_read_b32 v231, a155
    v_accvgpr_read_b32 v232, a176
    v_accvgpr_read_b32 v233, a177
    v_accvgpr_read_b32 v234, a178
    v_accvgpr_read_b32 v235, a179
    v_mul_f32 v228, v248, v228
    v_mul_f32 v229, v248, v229
    v_mul_f32 v230, v248, v230
    v_mul_f32 v231, v248, v231
    v_mul_f32 v232, v248, v232
    v_mul_f32 v233, v248, v233
    v_mul_f32 v234, v248, v234
    v_mul_f32 v235, v248, v235
    v_cvt_pk_bf16_f32 v228, v228, v229
    v_cvt_pk_bf16_f32 v229, v230, v231
    v_cvt_pk_bf16_f32 v230, v232, v233
    v_cvt_pk_bf16_f32 v231, v234, v235
    s_add_u32 s52, s52, 4096
    buffer_store_dwordx4 v[228:231], v1, s[28:31], s52 offen offset:0
    v_accvgpr_read_b32 v236, a156
    v_accvgpr_read_b32 v237, a157
    v_accvgpr_read_b32 v238, a158
    v_accvgpr_read_b32 v239, a159
    v_accvgpr_read_b32 v240, a180
    v_accvgpr_read_b32 v241, a181
    v_accvgpr_read_b32 v242, a182
    v_accvgpr_read_b32 v243, a183
    v_mul_f32 v236, v250, v236
    v_mul_f32 v237, v250, v237
    v_mul_f32 v238, v250, v238
    v_mul_f32 v239, v250, v239
    v_mul_f32 v240, v250, v240
    v_mul_f32 v241, v250, v241
    v_mul_f32 v242, v250, v242
    v_mul_f32 v243, v250, v243
    v_cvt_pk_bf16_f32 v236, v236, v237
    v_cvt_pk_bf16_f32 v237, v238, v239
    v_cvt_pk_bf16_f32 v238, v240, v241
    v_cvt_pk_bf16_f32 v239, v242, v243
    buffer_store_dwordx4 v[236:239], v1, s[28:31], s52 offen offset:1024
    v_accvgpr_read_b32 v228, a160
    v_accvgpr_read_b32 v229, a161
    v_accvgpr_read_b32 v230, a162
    v_accvgpr_read_b32 v231, a163
    v_accvgpr_read_b32 v232, a184
    v_accvgpr_read_b32 v233, a185
    v_accvgpr_read_b32 v234, a186
    v_accvgpr_read_b32 v235, a187
    v_mul_f32 v228, v252, v228
    v_mul_f32 v229, v252, v229
    v_mul_f32 v230, v252, v230
    v_mul_f32 v231, v252, v231
    v_mul_f32 v232, v252, v232
    v_mul_f32 v233, v252, v233
    v_mul_f32 v234, v252, v234
    v_mul_f32 v235, v252, v235
    v_cvt_pk_bf16_f32 v228, v228, v229
    v_cvt_pk_bf16_f32 v229, v230, v231
    v_cvt_pk_bf16_f32 v230, v232, v233
    v_cvt_pk_bf16_f32 v231, v234, v235
    buffer_store_dwordx4 v[228:231], v1, s[28:31], s52 offen offset:2048
    v_accvgpr_read_b32 v236, a164
    v_accvgpr_read_b32 v237, a165
    v_accvgpr_read_b32 v238, a166
    v_accvgpr_read_b32 v239, a167
    v_accvgpr_read_b32 v240, a188
    v_accvgpr_read_b32 v241, a189
    v_accvgpr_read_b32 v242, a190
    v_accvgpr_read_b32 v243, a191
    v_mul_f32 v236, v254, v236
    v_mul_f32 v237, v254, v237
    v_mul_f32 v238, v254, v238
    v_mul_f32 v239, v254, v239
    v_mul_f32 v240, v254, v240
    v_mul_f32 v241, v254, v241
    v_mul_f32 v242, v254, v242
    v_mul_f32 v243, v254, v243
    v_cvt_pk_bf16_f32 v236, v236, v237
    v_cvt_pk_bf16_f32 v237, v238, v239
    v_cvt_pk_bf16_f32 v238, v240, v241
    v_cvt_pk_bf16_f32 v239, v242, v243
    buffer_store_dwordx4 v[236:239], v1, s[28:31], s52 offen offset:3072
    s_sub_u32 s91, s89, s88
    s_cmp_eq_u32 s92, 155648
    s_cselect_b32 s94, 4294955008, s93
    s_waitcnt vmcnt(23)
    s_barrier
    s_add_u32 s57, s41, s88
    s_mov_b32 m0, s57
    s_nop 0
    buffer_load_dwordx4 v17, s[20:23], s45 offen offset:0 lds
    buffer_load_dwordx4 v18, s[20:23], s45 offen offset:1024 lds
    buffer_load_dwordx4 v19, s[20:23], s45 offen offset:2048 lds
    buffer_load_dwordx4 v20, s[20:23], s45 offen offset:3072 lds
    s_add_u32 m0, s57, 4096
    s_nop 0
    buffer_load_dwordx4 v21, s[20:23], s45 offen offset:0 lds
    buffer_load_dwordx4 v22, s[20:23], s45 offen offset:1024 lds
    buffer_load_dwordx4 v23, s[20:23], s45 offen offset:2048 lds
    buffer_load_dwordx4 v24, s[20:23], s45 offen offset:3072 lds
    s_add_u32 m0, s57, 8192
    s_nop 0
    buffer_load_dwordx4 v25, s[20:23], s45 offen offset:0 lds
    s_add_u32 m0, s42, s92
    s_nop 0
    buffer_load_dwordx4 v26, s[28:31], s47 offen lds
    s_mov_b32 exec_hi, 0
    buffer_load_dwordx4 v26, s[28:31], s47 offen offset:1024 lds
    s_mov_b32 exec_hi, -1
    s_add_u32 s58, s1, s0
    s_and_b32 s58, s58, 15
    s_andn2_b32 s59, s1, 15
    s_add_u32 s58, s58, s59
    s_mul_i32 s45, s58, 36864
    s_mul_i32 s47, s58, 6144
    s_add_u32 s47, s47, s42
    s_add_u32 s1, s1, 1
    s_add_u32 s92, s92, s94
    s_mov_b32 s53, s88
    s_mov_b32 s88, s89
    s_mov_b32 s89, s90
    s_mov_b32 s90, s53
    v_add_u32 v9, s91, v9
    v_add_u32 v10, s91, v10
    v_add_u32 v11, s91, v11
    v_add_u32 v12, s91, v12
    v_add_u32 v4, s94, v4
    ds_read_b128 a[36:39], v4 offset:0
    ds_read_b128 a[40:43], v4 offset:1024
    ds_read_b128 a[44:47], v4 offset:2048
    ds_read_b128 a[48:51], v4 offset:3072
    ds_read_b128 a[52:55], v4 offset:4096
    ds_read_b128 a[56:59], v4 offset:5120
    ds_read_b64_tr_b16 a[0:1], v9 offset:0
    ds_read_b64_tr_b16 a[2:3], v9 offset:18432
    ds_read_b64_tr_b16 a[4:5], v10 offset:0
    ds_read_b64_tr_b16 a[6:7], v10 offset:18432
    ds_read_b64_tr_b16 a[8:9], v11 offset:0
    ds_read_b64_tr_b16 a[10:11], v11 offset:18432
    ds_read_b64_tr_b16 a[12:13], v12 offset:0
    ds_read_b64_tr_b16 a[14:15], v12 offset:18432
    ds_read_b64_tr_b16 a[16:17], v9 offset:128
    ds_read_b64_tr_b16 a[18:19], v9 offset:18560
    ds_read_b64_tr_b16 a[20:21], v10 offset:128
    ds_read_b64_tr_b16 a[22:23], v10 offset:18560
    ds_read_b64_tr_b16 a[24:25], v11 offset:128
    ds_read_b64_tr_b16 a[26:27], v11 offset:18560
    ds_read_b64_tr_b16 a[28:29], v12 offset:128
    ds_read_b64_tr_b16 a[30:31], v12 offset:18560
    ds_read_b64_tr_b16 a[32:33], v9 offset:256
    ds_read_b64_tr_b16 a[34:35], v9 offset:18688
    s_mov_b32 s40, 14
L_op:
    s_sub_u32 s91, s89, s88
    s_cmp_eq_u32 s92, 155648
    s_waitcnt lgkmcnt(15)
    v_mfma_f32_16x16x32_bf16 v[36:39], a[0:3], a[36:39], v[36:39]
    s_cselect_b32 s94, 4294955008, s93
    s_waitcnt lgkmcnt(0)
    s_waitcnt vmcnt(11)
    v_mfma_f32_16x16x32_bf16 v[40:43], a[0:3], a[40:43], v[40:43]
    s_barrier
    s_add_u32 s57, s41, s88
    v_mfma_f32_16x16x32_bf16 v[44:47], a[0:3], a[44:47], v[44:47]
    s_mov_b32 m0, s57
    s_mov_b32 s53, s88
    v_mfma_f32_16x16x32_bf16 v[48:51], a[0:3], a[48:51], v[48:51]
    buffer_load_dwordx4 v17, s[20:23], s45 offen offset:0 lds
    v_mfma_f32_16x16x32_bf16 v[52:55], a[0:3], a[52:55], v[52:55]
    buffer_load_dwordx4 v18, s[20:23], s45 offen offset:1024 lds
    v_mfma_f32_16x16x32_bf16 v[56:59], a[0:3], a[56:59], v[56:59]
    s_mov_b32 s88, s89
    s_mov_b32 s89, s90
    v_mfma_f32_16x16x32_bf16 v[60:63], a[4:7], a[36:39], v[60:63]
    s_mov_b32 s90, s53
    v_add_u32 v9, s91, v9
    v_mfma_f32_16x16x32_bf16 v[64:67], a[4:7], a[40:43], v[64:67]
    v_add_u32 v10, s91, v10
    v_add_u32 v11, s91, v11
    v_mfma_f32_16x16x32_bf16 v[68:71], a[4:7], a[44:47], v[68:71]
    buffer_load_dwordx4 v19, s[20:23], s45 offen offset:2048 lds
    v_mfma_f32_16x16x32_bf16 v[72:75], a[4:7], a[48:51], v[72:75]
    v_add_u32 v12, s91, v12
    v_add_u32 v4, s94, v4
    v_mfma_f32_16x16x32_bf16 v[76:79], a[4:7], a[52:55], v[76:79]
    ds_read_b128 a[228:231], v4 offset:0
    ds_read_b128 a[232:235], v4 offset:1024
    v_mfma_f32_16x16x32_bf16 v[80:83], a[4:7], a[56:59], v[80:83]
    ds_read_b128 a[236:239], v4 offset:2048
    ds_read_b128 a[240:243], v4 offset:3072
    v_mfma_f32_16x16x32_bf16 v[84:87], a[8:11], a[36:39], v[84:87]
    ds_read_b128 a[244:247], v4 offset:4096
    ds_read_b128 a[248:251], v4 offset:5120
    v_mfma_f32_16x16x32_bf16 v[88:91], a[8:11], a[40:43], v[88:91]
    buffer_load_dwordx4 v20, s[20:23], s45 offen offset:3072 lds
    v_mfma_f32_16x16x32_bf16 v[92:95], a[8:11], a[44:47], v[92:95]
    ds_read_b64_tr_b16 a[192:193], v9 offset:0
    ds_read_b64_tr_b16 a[194:195], v9 offset:18432
    v_mfma_f32_16x16x32_bf16 v[96:99], a[8:11], a[48:51], v[96:99]
    ds_read_b64_tr_b16 a[196:197], v10 offset:0
    ds_read_b64_tr_b16 a[198:199], v10 offset:18432
    v_mfma_f32_16x16x32_bf16 v[100:103], a[8:11], a[52:55], v[100:103]
    s_add_u32 m0, s57, 4096
    ds_read_b64_tr_b16 a[200:201], v11 offset:0
    v_mfma_f32_16x16x32_bf16 v[104:107], a[8:11], a[56:59], v[104:107]
    buffer_load_dwordx4 v21, s[20:23], s45 offen offset:0 lds
    v_mfma_f32_16x16x32_bf16 v[108:111], a[12:15], a[36:39], v[108:111]
    ds_read_b64_tr_b16 a[202:203], v11 offset:18432
    ds_read_b64_tr_b16 a[204:205], v12 offset:0
    v_mfma_f32_16x16x32_bf16 v[112:115], a[12:15], a[40:43], v[112:115]
    ds_read_b64_tr_b16 a[206:207], v12 offset:18432
    ds_read_b64_tr_b16 a[208:209], v9 offset:128
    v_mfma_f32_16x16x32_bf16 v[116:119], a[12:15], a[44:47], v[116:119]
    ds_read_b64_tr_b16 a[210:211], v9 offset:18560
    ds_read_b64_tr_b16 a[212:213], v10 offset:128
    v_mfma_f32_16x16x32_bf16 v[120:123], a[12:15], a[48:51], v[120:123]
    ds_read_b64_tr_b16 a[214:215], v10 offset:18560
    ds_read_b64_tr_b16 a[216:217], v11 offset:128
    v_mfma_f32_16x16x32_bf16 v[124:127], a[12:15], a[52:55], v[124:127]
    buffer_load_dwordx4 v22, s[20:23], s45 offen offset:1024 lds
    v_mfma_f32_16x16x32_bf16 v[128:131], a[12:15], a[56:59], v[128:131]
    ds_read_b64_tr_b16 a[218:219], v11 offset:18560
    ds_read_b64_tr_b16 a[220:221], v12 offset:128
    v_mfma_f32_16x16x32_bf16 v[132:135], a[16:19], a[36:39], v[132:135]
    ds_read_b64_tr_b16 a[222:223], v12 offset:18560
    ds_read_b64_tr_b16 a[224:225], v9 offset:256
    v_mfma_f32_16x16x32_bf16 v[136:139], a[16:19], a[40:43], v[136:139]
    ds_read_b64_tr_b16 a[226:227], v9 offset:18688
    v_mfma_f32_16x16x32_bf16 v[140:143], a[16:19], a[44:47], v[140:143]
    buffer_load_dwordx4 v23, s[20:23], s45 offen offset:2048 lds
    v_mfma_f32_16x16x32_bf16 v[144:147], a[16:19], a[48:51], v[144:147]
    v_mfma_f32_16x16x32_bf16 v[148:151], a[16:19], a[52:55], v[148:151]
    v_mfma_f32_16x16x32_bf16 v[152:155], a[16:19], a[56:59], v[152:155]
    v_mfma_f32_16x16x32_bf16 v[156:159], a[20:23], a[36:39], v[156:159]
    v_mfma_f32_16x16x32_bf16 v[160:163], a[20:23], a[40:43], v[160:163]
    buffer_load_dwordx4 v24, s[20:23], s45 offen offset:3072 lds
    v_mfma_f32_16x16x32_bf16 v[164:167], a[20:23], a[44:47], v[164:167]
    v_mfma_f32_16x16x32_bf16 v[168:171], a[20:23], a[48:51], v[168:171]
    v_mfma_f32_16x16x32_bf16 v[172:175], a[20:23], a[52:55], v[172:175]
    s_add_u32 m0, s57, 8192
    v_mfma_f32_16x16x32_bf16 v[176:179], a[20:23], a[56:59], v[176:179]
    buffer_load_dwordx4 v25, s[20:23], s45 offen offset:0 lds
    v_mfma_f32_16x16x32_bf16 v[180:183], a[24:27], a[36:39], v[180:183]
    v_mfma_f32_16x16x32_bf16 v[184:187], a[24:27], a[40:43], v[184:187]
    v_mfma_f32_16x16x32_bf16 v[188:191], a[24:27], a[44:47], v[188:191]
    v_mfma_f32_16x16x32_bf16 v[192:195], a[24:27], a[48:51], v[192:195]
    s_add_u32 m0, s42, s92
    s_add_u32 s58, s1, s0
    v_mfma_f32_16x16x32_bf16 v[196:199], a[24:27], a[52:55], v[196:199]
    buffer_load_dwordx4 v26, s[28:31], s47 offen lds
    v_mfma_f32_16x16x32_bf16 v[200:203], a[24:27], a[56:59], v[200:203]
    s_and_b32 s58, s58, 15
    s_andn2_b32 s59, s1, 15
    v_mfma_f32_16x16x32_bf16 v[204:207], a[28:31], a[36:39], v[204:207]
    s_add_u32 s58, s58, s59
    s_mul_i32 s45, s58, 36864
    v_mfma_f32_16x16x32_bf16 v[208:211], a[28:31], a[40:43], v[208:211]
    v_mfma_f32_16x16x32_bf16 v[212:215], a[28:31], a[44:47], v[212:215]
    s_mov_b32 exec_hi, 0
    buffer_load_dwordx4 v26, s[28:31], s47 offen offset:1024 lds
    s_mov_b32 exec_hi, -1
    v_mfma_f32_16x16x32_bf16 v[216:219], a[28:31], a[48:51], v[216:219]
    s_mul_i32 s47, s58, 6144
    s_add_u32 s47, s47, s42
    v_mfma_f32_16x16x32_bf16 v[220:223], a[28:31], a[52:55], v[220:223]
    s_add_u32 s1, s1, 1
    s_add_u32 s92, s92, s94
    v_mfma_f32_16x16x32_bf16 v[224:227], a[28:31], a[56:59], v[224:227]
    v_mfma_f32_16x16x32_bf16 a[60:63], a[32:35], a[36:39], a[60:63]
    v_mfma_f32_16x16x32_bf16 a[64:67], a[32:35], a[40:43], a[64:67]
    v_mfma_f32_16x16x32_bf16 a[68:71], a[32:35], a[44:47], a[68:71]
    v_mfma_f32_16x16x32_bf16 a[72:75], a[32:35], a[48:51], a[72:75]
    v_mfma_f32_16x16x32_bf16 a[76:79], a[32:35], a[52:55], a[76:79]
    v_mfma_f32_16x16x32_bf16 a[80:83], a[32:35], a[56:59], a[80:83]
    s_sub_u32 s91, s89, s88
    s_cmp_eq_u32 s92, 155648
    s_waitcnt lgkmcnt(15)
    v_mfma_f32_16x16x32_bf16 v[36:39], a[192:195], a[228:231], v[36:39]
    s_cselect_b32 s94, 4294955008, s93
    s_waitcnt lgkmcnt(0)
    s_waitcnt vmcnt(11)
    v_mfma_f32_16x16x32_bf16 v[40:43], a[192:195], a[232:235], v[40:43]
    s_barrier
    s_add_u32 s57, s41, s88
    v_mfma_f32_16x16x32_bf16 v[44:47], a[192:195], a[236:239], v[44:47]
    s_mov_b32 m0, s57
    s_mov_b32 s53, s88
    v_mfma_f32_16x16x32_bf16 v[48:51], a[192:195], a[240:243], v[48:51]
    buffer_load_dwordx4 v17, s[20:23], s45 offen offset:0 lds
    v_mfma_f32_16x16x32_bf16 v[52:55], a[192:195], a[244:247], v[52:55]
    buffer_load_dwordx4 v18, s[20:23], s45 offen offset:1024 lds
    v_mfma_f32_16x16x32_bf16 v[56:59], a[192:195], a[248:251], v[56:59]
    s_mov_b32 s88, s89
    s_mov_b32 s89, s90
    v_mfma_f32_16x16x32_bf16 v[60:63], a[196:199], a[228:231], v[60:63]
    s_mov_b32 s90, s53
    v_add_u32 v9, s91, v9
    v_mfma_f32_16x16x32_bf16 v[64:67], a[196:199], a[232:235], v[64:67]
    v_add_u32 v10, s91, v10
    v_add_u32 v11, s91, v11
    v_mfma_f32_16x16x32_bf16 v[68:71], a[196:199], a[236:239], v[68:71]
    buffer_load_dwordx4 v19, s[20:23], s45 offen offset:2048 lds
    v_mfma_f32_16x16x32_bf16 v[72:75], a[196:199], a[240:243], v[72:75]
    v_add_u32 v12, s91, v12
    v_add_u32 v4, s94, v4
    v_mfma_f32_16x16x32_bf16 v[76:79], a[196:199], a[244:247], v[76:79]
    ds_read_b128 a[36:39], v4 offset:0
    ds_read_b128 a[40:43], v4 offset:1024
    v_mfma_f32_16x16x32_bf16 v[80:83], a[196:199], a[248:251], v[80:83]
    ds_read_b128 a[44:47], v4 offset:2048
    ds_read_b128 a[48:51], v4 offset:3072
    v_mfma_f32_16x16x32_bf16 v[84:87], a[200:203], a[228:231], v[84:87]
    ds_read_b128 a[52:55], v4 offset:4096
    ds_read_b128 a[56:59], v4 offset:5120
    v_mfma_f32_16x16x32_bf16 v[88:91], a[200:203], a[232:235], v[88:91]
    buffer_load_dwordx4 v20, s[20:23], s45 offen offset:3072 lds
    v_mfma_f32_16x16x32_bf16 v[92:95], a[200:203], a[236:239], v[92:95]
    ds_read_b64_tr_b16 a[0:1], v9 offset:0
    ds_read_b64_tr_b16 a[2:3], v9 offset:18432
    v_mfma_f32_16x16x32_bf16 v[96:99], a[200:203], a[240:243], v[96:99]
    ds_read_b64_tr_b16 a[4:5], v10 offset:0
    ds_read_b64_tr_b16 a[6:7], v10 offset:18432
    v_mfma_f32_16x16x32_bf16 v[100:103], a[200:203], a[244:247], v[100:103]
    s_add_u32 m0, s57, 4096
    ds_read_b64_tr_b16 a[8:9], v11 offset:0
    v_mfma_f32_16x16x32_bf16 v[104:107], a[200:203], a[248:251], v[104:107]
    buffer_load_dwordx4 v21, s[20:23], s45 offen offset:0 lds
    v_mfma_f32_16x16x32_bf16 v[108:111], a[204:207], a[228:231], v[108:111]
    ds_read_b64_tr_b16 a[10:11], v11 offset:18432
    ds_read_b64_tr_b16 a[12:13], v12 offset:0
    v_mfma_f32_16x16x32_bf16 v[112:115], a[204:207], a[232:235], v[112:115]
    ds_read_b64_tr_b16 a[14:15], v12 offset:18432
    ds_read_b64_tr_b16 a[16:17], v9 offset:128
    v_mfma_f32_16x16x32_bf16 v[116:119], a[204:207], a[236:239], v[116:119]
    ds_read_b64_tr_b16 a[18:19], v9 offset:18560
    ds_read_b64_tr_b16 a[20:21], v10 offset:128
    v_mfma_f32_16x16x32_bf16 v[120:123], a[204:207], a[240:243], v[120:123]
    ds_read_b64_tr_b16 a[22:23], v10 offset:18560
    ds_read_b64_tr_b16 a[24:25], v11 offset:128
    v_mfma_f32_16x16x32_bf16 v[124:127], a[204:207], a[244:247], v[124:127]
    buffer_load_dwordx4 v22, s[20:23], s45 offen offset:1024 lds
    v_mfma_f32_16x16x32_bf16 v[128:131], a[204:207], a[248:251], v[128:131]
    ds_read_b64_tr_b16 a[26:27], v11 offset:18560
    ds_read_b64_tr_b16 a[28:29], v12 offset:128
    v_mfma_f32_16x16x32_bf16 v[132:135], a[208:211], a[228:231], v[132:135]
    ds_read_b64_tr_b16 a[30:31], v12 offset:18560
    ds_read_b64_tr_b16 a[32:33], v9 offset:256
    v_mfma_f32_16x16x32_bf16 v[136:139], a[208:211], a[232:235], v[136:139]
    ds_read_b64_tr_b16 a[34:35], v9 offset:18688
    v_mfma_f32_16x16x32_bf16 v[140:143], a[208:211], a[236:239], v[140:143]
    buffer_load_dwordx4 v23, s[20:23], s45 offen offset:2048 lds
    v_mfma_f32_16x16x32_bf16 v[144:147], a[208:211], a[240:243], v[144:147]
    v_mfma_f32_16x16x32_bf16 v[148:151], a[208:211], a[244:247], v[148:151]
    v_mfma_f32_16x16x32_bf16 v[152:155], a[208:211], a[248:251], v[152:155]
    v_mfma_f32_16x16x32_bf16 v[156:159], a[212:215], a[228:231], v[156:159]
    v_mfma_f32_16x16x32_bf16 v[160:163], a[212:215], a[232:235], v[160:163]
    buffer_load_dwordx4 v24, s[20:23], s45 offen offset:3072 lds
    v_mfma_f32_16x16x32_bf16 v[164:167], a[212:215], a[236:239], v[164:167]
    v_mfma_f32_16x16x32_bf16 v[168:171], a[212:215], a[240:243], v[168:171]
    v_mfma_f32_16x16x32_bf16 v[172:175], a[212:215], a[244:247], v[172:175]
    s_add_u32 m0, s57, 8192
    v_mfma_f32_16x16x32_bf16 v[176:179], a[212:215], a[248:251], v[176:179]
    buffer_load_dwordx4 v25, s[20:23], s45 offen offset:0 lds
    v_mfma_f32_16x16x32_bf16 v[180:183], a[216:219], a[228:231], v[180:183]
    v_mfma_f32_16x16x32_bf16 v[184:187], a[216:219], a[232:235], v[184:187]
    v_mfma_f32_16x16x32_bf16 v[188:191], a[216:219], a[236:239], v[188:191]
    v_mfma_f32_16x16x32_bf16 v[192:195], a[216:219], a[240:243], v[192:195]
    s_add_u32 m0, s42, s92
    s_add_u32 s58, s1, s0
    v_mfma_f32_16x16x32_bf16 v[196:199], a[216:219], a[244:247], v[196:199]
    buffer_load_dwordx4 v26, s[28:31], s47 offen lds
    v_mfma_f32_16x16x32_bf16 v[200:203], a[216:219], a[248:251], v[200:203]
    s_and_b32 s58, s58, 15
    s_andn2_b32 s59, s1, 15
    v_mfma_f32_16x16x32_bf16 v[204:207], a[220:223], a[228:231], v[204:207]
    s_add_u32 s58, s58, s59
    s_mul_i32 s45, s58, 36864
    v_mfma_f32_16x16x32_bf16 v[208:211], a[220:223], a[232:235], v[208:211]
    v_mfma_f32_16x16x32_bf16 v[212:215], a[220:223], a[236:239], v[212:215]
    s_mov_b32 exec_hi, 0
    buffer_load_dwordx4 v26, s[28:31], s47 offen offset:1024 lds
    s_mov_b32 exec_hi, -1
    v_mfma_f32_16x16x32_bf16 v[216:219], a[220:223], a[240:243], v[216:219]
    s_mul_i32 s47, s58, 6144
    s_add_u32 s47, s47, s42
    v_mfma_f32_16x16x32_bf16 v[220:223], a[220:223], a[244:247], v[220:223]
    s_add_u32 s1, s1, 1
    s_add_u32 s92, s92, s94
    v_mfma_f32_16x16x32_bf16 v[224:227], a[220:223], a[248:251], v[224:227]
    v_mfma_f32_16x16x32_bf16 a[60:63], a[224:227], a[228:231], a[60:63]
    v_mfma_f32_16x16x32_bf16 a[64:67], a[224:227], a[232:235], a[64:67]
    v_mfma_f32_16x16x32_bf16 a[68:71], a[224:227], a[236:239], a[68:71]
    v_mfma_f32_16x16x32_bf16 a[72:75], a[224:227], a[240:243], a[72:75]
    v_mfma_f32_16x16x32_bf16 a[76:79], a[224:227], a[244:247], a[76:79]
    v_mfma_f32_16x16x32_bf16 a[80:83], a[224:227], a[248:251], a[80:83]
    s_sub_u32 s40, s40, 1
    s_cmp_lg_u32 s40, 0
    s_cbranch_scc1 L_op
    s_cmp_eq_u32 s38, 1
    s_cbranch_scc1 L_var1
    s_cmp_eq_u32 s38, 2
    s_cbranch_scc1 L_var2
    s_cmp_eq_u32 s38, 3
    s_cbranch_scc1 L_var3
L_var0:
    s_mul_i32 s55, s36, 7168
    s_add_u32 s78, s55, 114688
    s_waitcnt lgkmcnt(15)
    v_mfma_f32_16x16x32_bf16 v[36:39], a[0:3], a[36:39], v[36:39]
    s_add_u32 s79, s55, 118784
    s_add_u32 s80, s55, 229376
    v_mfma_f32_16x16x32_bf16 v[40:43], a[0:3], a[40:43], v[40:43]
    s_add_u32 s81, s55, 233472
    s_add_u32 s82, s55, 344064
    v_mfma_f32_16x16x32_bf16 v[44:47], a[0:3], a[44:47], v[44:47]
    s_add_u32 s83, s55, 348160
    v_mfma_f32_16x16x32_bf16 v[48:51], a[0:3], a[48:51], v[48:51]
    v_mfma_f32_16x16x32_bf16 v[52:55], a[0:3], a[52:55], v[52:55]
    s_nop 4
    v_cvt_pk_bf16_f32 v228, v44, v45
    v_cvt_pk_bf16_f32 v229, v46, v47
    v_mfma_f32_16x16x32_bf16 v[56:59], a[0:3], a[56:59], v[56:59]
    v_cvt_pk_bf16_f32 v232, v48, v49
    v_cvt_pk_bf16_f32 v233, v50, v51
    s_waitcnt lgkmcnt(14)
    v_mfma_f32_16x16x32_bf16 v[60:63], a[4:7], a[36:39], v[60:63]
    v_mfma_f32_16x16x32_bf16 v[64:67], a[4:7], a[40:43], v[64:67]
    s_nop 2
    v_cvt_pk_bf16_f32 v236, v56, v57
    v_cvt_pk_bf16_f32 v237, v58, v59
    v_mfma_f32_16x16x32_bf16 v[68:71], a[4:7], a[44:47], v[68:71]
    v_mfma_f32_16x16x32_bf16 v[72:75], a[4:7], a[48:51], v[72:75]
    v_mfma_f32_16x16x32_bf16 v[76:79], a[4:7], a[52:55], v[76:79]
    s_nop 5
    v_cvt_pk_bf16_f32 v230, v68, v69
    v_cvt_pk_bf16_f32 v231, v70, v71
    v_mfma_f32_16x16x32_bf16 v[80:83], a[4:7], a[56:59], v[80:83]
    buffer_store_dwordx4 v[228:231], v26, s[32:35], s78 offen offset:2048 sc1
    s_waitcnt lgkmcnt(12)
    v_mfma_f32_16x16x32_bf16 v[84:87], a[8:11], a[36:39], v[84:87]
    v_cvt_pk_bf16_f32 v234, v72, v73
    v_cvt_pk_bf16_f32 v235, v74, v75
    v_mfma_f32_16x16x32_bf16 v[88:91], a[8:11], a[40:43], v[88:91]
    buffer_store_dwordx4 v[232:235], v26, s[32:35], s80 offen offset:0 sc1
    v_mfma_f32_16x16x32_bf16 v[92:95], a[8:11], a[44:47], v[92:95]
    v_cvt_pk_bf16_f32 v238, v80, v81
    v_cvt_pk_bf16_f32 v239, v82, v83
    v_mfma_f32_16x16x32_bf16 v[96:99], a[8:11], a[48:51], v[96:99]
    buffer_store_dwordx4 v[236:239], v26, s[32:35], s82 offen offset:2048 sc1
    v_mfma_f32_16x16x32_bf16 v[100:103], a[8:11], a[52:55], v[100:103]
    v_cvt_pk_bf16_f32 v240, v76, v77
    v_cvt_pk_bf16_f32 v241, v78, v79
    v_mfma_f32_16x16x32_bf16 v[104:107], a[8:11], a[56:59], v[104:107]
    v_cvt_pk_bf16_f32 v228, v92, v93
    v_cvt_pk_bf16_f32 v229, v94, v95
    s_waitcnt lgkmcnt(10)
    v_mfma_f32_16x16x32_bf16 v[108:111], a[12:15], a[36:39], v[108:111]
    s_nop 0
    v_cvt_pk_bf16_f32 v242, v100, v101
    v_cvt_pk_bf16_f32 v243, v102, v103
    v_mfma_f32_16x16x32_bf16 v[112:115], a[12:15], a[40:43], v[112:115]
    buffer_store_dwordx4 v[240:243], v26, s[32:35], s81 offen offset:1024 sc1
    v_mfma_f32_16x16x32_bf16 v[116:119], a[12:15], a[44:47], v[116:119]
    v_cvt_pk_bf16_f32 v232, v96, v97
    v_cvt_pk_bf16_f32 v233, v98, v99
    v_mfma_f32_16x16x32_bf16 v[120:123], a[12:15], a[48:51], v[120:123]
    v_cvt_pk_bf16_f32 v236, v104, v105
    v_cvt_pk_bf16_f32 v237, v106, v107
    v_mfma_f32_16x16x32_bf16 v[124:127], a[12:15], a[52:55], v[124:127]
    s_nop 1
    v_cvt_pk_bf16_f32 v230, v116, v117
    v_cvt_pk_bf16_f32 v231, v118, v119
    v_mfma_f32_16x16x32_bf16 v[128:131], a[12:15], a[56:59], v[128:131]
    buffer_store_dwordx4 v[228:231], v26, s[32:35], s78 offen offset:3072 sc1
    s_waitcnt lgkmcnt(8)
    v_mfma_f32_16x16x32_bf16 v[132:135], a[16:19], a[36:39], v[132:135]
    v_cvt_pk_bf16_f32 v234, v120, v121
    v_cvt_pk_bf16_f32 v235, v122, v123
    v_mfma_f32_16x16x32_bf16 v[136:139], a[16:19], a[40:43], v[136:139]
    buffer_store_dwordx4 v[232:235], v26, s[32:35], s80 offen offset:1024 sc1
    v_mfma_f32_16x16x32_bf16 v[140:143], a[16:19], a[44:47], v[140:143]
    v_cvt_pk_bf16_f32 v238, v128, v129
    v_cvt_pk_bf16_f32 v239, v130, v131
    v_mfma_f32_16x16x32_bf16 v[144:147], a[16:19], a[48:51], v[144:147]
    buffer_store_dwordx4 v[236:239], v26, s[32:35], s82 offen offset:3072 sc1
    v_mfma_f32_16x16x32_bf16 v[148:151], a[16:19], a[52:55], v[148:151]
    v_cvt_pk_bf16_f32 v240, v124, v125
    v_cvt_pk_bf16_f32 v241, v126, v127
    v_mfma_f32_16x16x32_bf16 v[152:155], a[16:19], a[56:59], v[152:155]
    v_cvt_pk_bf16_f32 v228, v140, v141
    v_cvt_pk_bf16_f32 v229, v142, v143
    s_waitcnt lgkmcnt(6)
    v_mfma_f32_16x16x32_bf16 v[156:159], a[20:23], a[36:39], v[156:159]
    s_nop 0
    v_cvt_pk_bf16_f32 v242, v148, v149
    v_cvt_pk_bf16_f32 v243, v150, v151
    v_mfma_f32_16x16x32_bf16 v[160:163], a[20:23], a[40:43], v[160:163]
    buffer_store_dwordx4 v[240:243], v26, s[32:35], s81 offen offset:2048 sc1
    v_mfma_f32_16x16x32_bf16 v[164:167], a[20:23], a[44:47], v[164:167]
    v_cvt_pk_bf16_f32 v232, v144, v145
    v_cvt_pk_bf16_f32 v233, v146, v147
    v_mfma_f32_16x16x32_bf16 v[168:171], a[20:23], a[48:51], v[168:171]
    v_cvt_pk_bf16_f32 v236, v152, v153
    v_cvt_pk_bf16_f32 v237, v154, v155
    v_mfma_f32_16x16x32_bf16 v[172:175], a[20:23], a[52:55], v[172:175]
    s_nop 1
    v_cvt_pk_bf16_f32 v230, v164, v165
    v_cvt_pk_bf16_f32 v231, v166, v167
    v_mfma_f32_16x16x32_bf16 v[176:179], a[20:23], a[56:59], v[176:179]
    buffer_store_dwordx4 v[228:231], v26, s[32:35], s79 offen offset:0 sc1
    s_waitcnt lgkmcnt(4)
    v_mfma_f32_16x16x32_bf16 v[180:183], a[24:27], a[36:39], v[180:183]
    v_cvt_pk_bf16_f32 v234, v168, v169
    v_cvt_pk_bf16_f32 v235, v170, v171
    v_mfma_f32_16x16x32_bf16 v[184:187], a[24:27], a[40:43], v[184:187]
    buffer_store_dwordx4 v[232:235], v26, s[32:35], s80 offen offset:2048 sc1
    v_mfma_f32_16x16x32_bf16 v[188:191], a[24:27], a[44:47], v[188:191]
    v_cvt_pk_bf16_f32 v238, v176, v177
    v_cvt_pk_bf16_f32 v239, v178, v179
    v_mfma_f32_16x16x32_bf16 v[192:195], a[24:27], a[48:51], v[192:195]
    buffer_store_dwordx4 v[236:239], v26, s[32:35], s83 offen offset:0 sc1
    v_mfma_f32_16x16x32_bf16 v[196:199], a[24:27], a[52:55], v[196:199]
    v_cvt_pk_bf16_f32 v240, v160, v161
    v_cvt_pk_bf16_f32 v241, v162, v163
    v_mfma_f32_16x16x32_bf16 v[200:203], a[24:27], a[56:59], v[200:203]
    v_cvt_pk_bf16_f32 v242, v184, v185
    v_cvt_pk_bf16_f32 v243, v186, v187
    s_waitcnt lgkmcnt(2)
    v_mfma_f32_16x16x32_bf16 v[204:207], a[28:31], a[36:39], v[204:207]
    buffer_store_dwordx4 v[240:243], v26, s[32:35], s78 offen offset:0 sc1
    v_mfma_f32_16x16x32_bf16 v[208:211], a[28:31], a[40:43], v[208:211]
    v_cvt_pk_bf16_f32 v228, v172, v173
    v_cvt_pk_bf16_f32 v229, v174, v175
    v_mfma_f32_16x16x32_bf16 v[212:215], a[28:31], a[44:47], v[212:215]
    v_cvt_pk_bf16_f32 v230, v196, v197
    v_cvt_pk_bf16_f32 v231, v198, v199
    v_mfma_f32_16x16x32_bf16 v[216:219], a[28:31], a[48:51], v[216:219]
    buffer_store_dwordx4 v[228:231], v26, s[32:35], s82 offen offset:0 sc1
    v_mfma_f32_16x16x32_bf16 v[220:223], a[28:31], a[52:55], v[220:223]
    v_cvt_pk_bf16_f32 v232, v188, v189
    v_cvt_pk_bf16_f32 v233, v190, v191
    v_mfma_f32_16x16x32_bf16 v[224:227], a[28:31], a[56:59], v[224:227]
    v_cvt_pk_bf16_f32 v234, v212, v213
    v_cvt_pk_bf16_f32 v235, v214, v215
    s_waitcnt lgkmcnt(0)
    v_mfma_f32_16x16x32_bf16 a[60:63], a[32:35], a[36:39], a[60:63]
    buffer_store_dwordx4 v[232:235], v26, s[32:35], s79 offen offset:1024 sc1
    v_mfma_f32_16x16x32_bf16 a[64:67], a[32:35], a[40:43], a[64:67]
    v_cvt_pk_bf16_f32 v236, v192, v193
    v_cvt_pk_bf16_f32 v237, v194, v195
    v_mfma_f32_16x16x32_bf16 a[68:71], a[32:35], a[44:47], a[68:71]
    v_cvt_pk_bf16_f32 v238, v216, v217
    v_cvt_pk_bf16_f32 v239, v218, v219
    v_mfma_f32_16x16x32_bf16 a[72:75], a[32:35], a[48:51], a[72:75]
    buffer_store_dwordx4 v[236:239], v26, s[32:35], s80 offen offset:3072 sc1
    v_mfma_f32_16x16x32_bf16 a[76:79], a[32:35], a[52:55], a[76:79]
    v_cvt_pk_bf16_f32 v240, v200, v201
    v_cvt_pk_bf16_f32 v241, v202, v203
    v_mfma_f32_16x16x32_bf16 a[80:83], a[32:35], a[56:59], a[80:83]
    v_cvt_pk_bf16_f32 v242, v224, v225
    v_cvt_pk_bf16_f32 v243, v226, v227
    buffer_store_dwordx4 v[240:243], v26, s[32:35], s83 offen offset:1024 sc1
    v_cvt_pk_bf16_f32 v228, v208, v209
    v_cvt_pk_bf16_f32 v229, v210, v211
    v_accvgpr_read_b32 v244, a64
    v_accvgpr_read_b32 v245, a65
    v_accvgpr_read_b32 v246, a66
    v_accvgpr_read_b32 v247, a67
    v_cvt_pk_bf16_f32 v230, v244, v245
    v_cvt_pk_bf16_f32 v231, v246, v247
    buffer_store_dwordx4 v[228:231], v26, s[32:35], s78 offen offset:1024 sc1
    v_accvgpr_read_b32 v248, a68
    v_accvgpr_read_b32 v249, a69
    v_accvgpr_read_b32 v250, a70
    v_accvgpr_read_b32 v251, a71
    v_cvt_pk_bf16_f32 v232, v248, v249
    v_cvt_pk_bf16_f32 v233, v250, v251
    buffer_store_dwordx4 v[232:235], v26, s[32:35], s79 offen offset:2048 sc1
    v_accvgpr_read_b32 v252, a72
    v_accvgpr_read_b32 v253, a73
    v_accvgpr_read_b32 v254, a74
    v_accvgpr_read_b32 v255, a75
    v_cvt_pk_bf16_f32 v236, v252, v253
    v_cvt_pk_bf16_f32 v237, v254, v255
    v_cvt_pk_bf16_f32 v238, v52, v53
    v_cvt_pk_bf16_f32 v239, v54, v55
    buffer_store_dwordx4 v[236:239], v26, s[32:35], s81 offen offset:0 sc1
    v_cvt_pk_bf16_f32 v240, v220, v221
    v_cvt_pk_bf16_f32 v241, v222, v223
    v_accvgpr_read_b32 v244, a76
    v_accvgpr_read_b32 v245, a77
    v_accvgpr_read_b32 v246, a78
    v_accvgpr_read_b32 v247, a79
    v_cvt_pk_bf16_f32 v242, v244, v245
    v_cvt_pk_bf16_f32 v243, v246, v247
    buffer_store_dwordx4 v[240:243], v26, s[32:35], s82 offen offset:1024 sc1
    v_accvgpr_read_b32 v248, a80
    v_accvgpr_read_b32 v249, a81
    v_accvgpr_read_b32 v250, a82
    v_accvgpr_read_b32 v251, a83
    v_cvt_pk_bf16_f32 v228, v248, v249
    v_cvt_pk_bf16_f32 v229, v250, v251
    buffer_store_dwordx4 v[228:231], v26, s[32:35], s83 offen offset:2048 sc1
    s_lshl_b32 s55, s36, 7
    s_add_u32 s55, s55, 458752
    v_lshlrev_b32 v1, 9, v0
    v_mov_b32 v2, 1
    v_mov_b32 v3, 0
    s_mov_b64 s[82:83], exec
    s_waitcnt vmcnt(0)
    s_mov_b64 exec, 14
    buffer_store_dword v2, v1, s[32:35], s55 offen sc1
    s_mov_b64 exec, 1
L_poll0:
    buffer_load_dwordx4 v[228:231], v3, s[32:35], s55 offen sc1
    s_waitcnt vmcnt(0)
    v_and_b32 v229, v229, v230
    v_and_b32 v229, v229, v231
    s_nop 0
    v_readfirstlane_b32 s56, v229
    s_nop 0
    s_cmp_eq_u32 s56, 1
    s_cbranch_scc1 L_poll_done0
    s_sleep 1
    s_branch L_poll0
L_poll_done0:
    s_mov_b64 exec, s[82:83]
    s_mul_i32 s55, s36, 7168
    s_add_u32 s56, s55, 28672
    buffer_load_dwordx4 v[44:47], v26, s[32:35], s56 offen offset:0 sc1
    s_add_u32 s57, s55, 57344
    buffer_load_dwordx4 v[80:83], v26, s[32:35], s57 offen offset:0 sc1
    s_add_u32 s58, s55, 86016
    buffer_load_dwordx4 v[124:127], v26, s[32:35], s58 offen offset:0 sc1
    buffer_load_dwordx4 v[48:51], v26, s[32:35], s56 offen offset:1024 sc1
    buffer_load_dwordx4 v[92:95], v26, s[32:35], s57 offen offset:1024 sc1
    buffer_load_dwordx4 v[128:131], v26, s[32:35], s58 offen offset:1024 sc1
    buffer_load_dwordx4 v[52:55], v26, s[32:35], s56 offen offset:2048 sc1
    buffer_load_dwordx4 v[96:99], v26, s[32:35], s57 offen offset:2048 sc1
    buffer_load_dwordx4 v[140:143], v26, s[32:35], s58 offen offset:2048 sc1
    buffer_load_dwordx4 v[56:59], v26, s[32:35], s56 offen offset:3072 sc1
    buffer_load_dwordx4 v[100:103], v26, s[32:35], s57 offen offset:3072 sc1
    buffer_load_dwordx4 v[144:147], v26, s[32:35], s58 offen offset:3072 sc1
    s_add_u32 s56, s55, 32768
    buffer_load_dwordx4 v[68:71], v26, s[32:35], s56 offen offset:0 sc1
    s_add_u32 s57, s55, 61440
    buffer_load_dwordx4 v[104:107], v26, s[32:35], s57 offen offset:0 sc1
    s_add_u32 s58, s55, 90112
    buffer_load_dwordx4 v[148:151], v26, s[32:35], s58 offen offset:0 sc1
    buffer_load_dwordx4 v[72:75], v26, s[32:35], s56 offen offset:1024 sc1
    buffer_load_dwordx4 v[116:119], v26, s[32:35], s57 offen offset:1024 sc1
    buffer_load_dwordx4 v[152:155], v26, s[32:35], s58 offen offset:1024 sc1
    buffer_load_dwordx4 v[76:79], v26, s[32:35], s56 offen offset:2048 sc1
    buffer_load_dwordx4 v[120:123], v26, s[32:35], s57 offen offset:2048 sc1
    buffer_load_dwordx4 v[160:163], v26, s[32:35], s58 offen offset:2048 sc1
    v_and_b32 v1, 15, v0
    v_mul_u32_u24 v1, 2304, v1
    v_lshrrev_b32 v2, 4, v0
    v_lshl_add_u32 v1, v2, 3, v1
    s_mul_i32 s55, s36, 288
    s_mov_b32 s59, 0xffff0000
    v_accvgpr_read_b32 v164, a60
    v_accvgpr_read_b32 v165, a61
    v_accvgpr_read_b32 v166, a62
    v_accvgpr_read_b32 v167, a63
    s_waitcnt vmcnt(18)
    v_lshlrev_b32 v228, 16, v44
    v_and_b32 v229, s59, v44
    v_lshlrev_b32 v230, 16, v45
    v_and_b32 v231, s59, v45
    v_pk_add_f32 v[36:37], v[36:37], v[228:229]
    v_pk_add_f32 v[38:39], v[38:39], v[230:231]
    v_lshlrev_b32 v232, 16, v80
    v_and_b32 v233, s59, v80
    v_lshlrev_b32 v234, 16, v81
    v_and_b32 v235, s59, v81
    v_pk_add_f32 v[36:37], v[36:37], v[232:233]
    v_pk_add_f32 v[38:39], v[38:39], v[234:235]
    v_lshlrev_b32 v236, 16, v124
    v_and_b32 v237, s59, v124
    v_lshlrev_b32 v238, 16, v125
    v_and_b32 v239, s59, v125
    v_pk_add_f32 v[36:37], v[36:37], v[236:237]
    v_pk_add_f32 v[38:39], v[38:39], v[238:239]
    v_cvt_pk_bf16_f32 v36, v36, v37
    v_cvt_pk_bf16_f32 v37, v38, v39
    s_add_u32 s56, s55, 0
    buffer_store_dwordx2 v[36:37], v1, s[24:27], s56 offen offset:0
    v_lshlrev_b32 v240, 16, v46
    v_and_b32 v241, s59, v46
    v_lshlrev_b32 v242, 16, v47
    v_and_b32 v243, s59, v47
    v_pk_add_f32 v[60:61], v[60:61], v[240:241]
    v_pk_add_f32 v[62:63], v[62:63], v[242:243]
    v_lshlrev_b32 v244, 16, v82
    v_and_b32 v245, s59, v82
    v_lshlrev_b32 v246, 16, v83
    v_and_b32 v247, s59, v83
    v_pk_add_f32 v[60:61], v[60:61], v[244:245]
    v_pk_add_f32 v[62:63], v[62:63], v[246:247]
    v_lshlrev_b32 v248, 16, v126
    v_and_b32 v249, s59, v126
    v_lshlrev_b32 v250, 16, v127
    v_and_b32 v251, s59, v127
    v_pk_add_f32 v[60:61], v[60:61], v[248:249]
    v_pk_add_f32 v[62:63], v[62:63], v[250:251]
    v_cvt_pk_bf16_f32 v60, v60, v61
    v_cvt_pk_bf16_f32 v61, v62, v63
    s_add_u32 s57, s55, 0
    buffer_store_dwordx2 v[60:61], v1, s[24:27], s57 offen offset:32
    s_waitcnt vmcnt(17)
    v_lshlrev_b32 v228, 16, v48
    v_and_b32 v229, s59, v48
    v_lshlrev_b32 v230, 16, v49
    v_and_b32 v231, s59, v49
    v_pk_add_f32 v[84:85], v[84:85], v[228:229]
    v_pk_add_f32 v[86:87], v[86:87], v[230:231]
    v_lshlrev_b32 v232, 16, v92
    v_and_b32 v233, s59, v92
    v_lshlrev_b32 v234, 16, v93
    v_and_b32 v235, s59, v93
    v_pk_add_f32 v[84:85], v[84:85], v[232:233]
    v_pk_add_f32 v[86:87], v[86:87], v[234:235]
    v_lshlrev_b32 v236, 16, v128
    v_and_b32 v237, s59, v128
    v_lshlrev_b32 v238, 16, v129
    v_and_b32 v239, s59, v129
    v_pk_add_f32 v[84:85], v[84:85], v[236:237]
    v_pk_add_f32 v[86:87], v[86:87], v[238:239]
    v_cvt_pk_bf16_f32 v84, v84, v85
    v_cvt_pk_bf16_f32 v85, v86, v87
    s_add_u32 s56, s55, 0
    buffer_store_dwordx2 v[84:85], v1, s[24:27], s56 offen offset:64
    v_lshlrev_b32 v240, 16, v50
    v_and_b32 v241, s59, v50
    v_lshlrev_b32 v242, 16, v51
    v_and_b32 v243, s59, v51
    v_pk_add_f32 v[108:109], v[108:109], v[240:241]
    v_pk_add_f32 v[110:111], v[110:111], v[242:243]
    v_lshlrev_b32 v244, 16, v94
    v_and_b32 v245, s59, v94
    v_lshlrev_b32 v246, 16, v95
    v_and_b32 v247, s59, v95
    v_pk_add_f32 v[108:109], v[108:109], v[244:245]
    v_pk_add_f32 v[110:111], v[110:111], v[246:247]
    v_lshlrev_b32 v248, 16, v130
    v_and_b32 v249, s59, v130
    v_lshlrev_b32 v250, 16, v131
    v_and_b32 v251, s59, v131
    v_pk_add_f32 v[108:109], v[108:109], v[248:249]
    v_pk_add_f32 v[110:111], v[110:111], v[250:251]
    v_cvt_pk_bf16_f32 v108, v108, v109
    v_cvt_pk_bf16_f32 v109, v110, v111
    s_add_u32 s57, s55, 0
    buffer_store_dwordx2 v[108:109], v1, s[24:27], s57 offen offset:96
    s_waitcnt vmcnt(16)
    v_lshlrev_b32 v228, 16, v52
    v_and_b32 v229, s59, v52
    v_lshlrev_b32 v230, 16, v53
    v_and_b32 v231, s59, v53
    v_pk_add_f32 v[132:133], v[132:133], v[228:229]
    v_pk_add_f32 v[134:135], v[134:135], v[230:231]
    v_lshlrev_b32 v232, 16, v96
    v_and_b32 v233, s59, v96
    v_lshlrev_b32 v234, 16, v97
    v_and_b32 v235, s59, v97
    v_pk_add_f32 v[132:133], v[132:133], v[232:233]
    v_pk_add_f32 v[134:135], v[134:135], v[234:235]
    v_lshlrev_b32 v236, 16, v140
    v_and_b32 v237, s59, v140
    v_lshlrev_b32 v238, 16, v141
    v_and_b32 v239, s59, v141
    v_pk_add_f32 v[132:133], v[132:133], v[236:237]
    v_pk_add_f32 v[134:135], v[134:135], v[238:239]
    v_cvt_pk_bf16_f32 v132, v132, v133
    v_cvt_pk_bf16_f32 v133, v134, v135
    s_add_u32 s56, s55, 0
    buffer_store_dwordx2 v[132:133], v1, s[24:27], s56 offen offset:128
    v_lshlrev_b32 v240, 16, v54
    v_and_b32 v241, s59, v54
    v_lshlrev_b32 v242, 16, v55
    v_and_b32 v243, s59, v55
    v_pk_add_f32 v[156:157], v[156:157], v[240:241]
    v_pk_add_f32 v[158:159], v[158:159], v[242:243]
    v_lshlrev_b32 v244, 16, v98
    v_and_b32 v245, s59, v98
    v_lshlrev_b32 v246, 16, v99
    v_and_b32 v247, s59, v99
    v_pk_add_f32 v[156:157], v[156:157], v[244:245]
    v_pk_add_f32 v[158:159], v[158:159], v[246:247]
    v_lshlrev_b32 v248, 16, v142
    v_and_b32 v249, s59, v142
    v_lshlrev_b32 v250, 16, v143
    v_and_b32 v251, s59, v143
    v_pk_add_f32 v[156:157], v[156:157], v[248:249]
    v_pk_add_f32 v[158:159], v[158:159], v[250:251]
    v_cvt_pk_bf16_f32 v156, v156, v157
    v_cvt_pk_bf16_f32 v157, v158, v159
    s_add_u32 s57, s55, 0
    buffer_store_dwordx2 v[156:157], v1, s[24:27], s57 offen offset:160
    s_waitcnt vmcnt(15)
    v_lshlrev_b32 v228, 16, v56
    v_and_b32 v229, s59, v56
    v_lshlrev_b32 v230, 16, v57
    v_and_b32 v231, s59, v57
    v_pk_add_f32 v[180:181], v[180:181], v[228:229]
    v_pk_add_f32 v[182:183], v[182:183], v[230:231]
    v_lshlrev_b32 v232, 16, v100
    v_and_b32 v233, s59, v100
    v_lshlrev_b32 v234, 16, v101
    v_and_b32 v235, s59, v101
    v_pk_add_f32 v[180:181], v[180:181], v[232:233]
    v_pk_add_f32 v[182:183], v[182:183], v[234:235]
    v_lshlrev_b32 v236, 16, v144
    v_and_b32 v237, s59, v144
    v_lshlrev_b32 v238, 16, v145
    v_and_b32 v239, s59, v145
    v_pk_add_f32 v[180:181], v[180:181], v[236:237]
    v_pk_add_f32 v[182:183], v[182:183], v[238:239]
    v_cvt_pk_bf16_f32 v180, v180, v181
    v_cvt_pk_bf16_f32 v181, v182, v183
    s_add_u32 s56, s55, 0
    buffer_store_dwordx2 v[180:181], v1, s[24:27], s56 offen offset:192
    v_lshlrev_b32 v240, 16, v58
    v_and_b32 v241, s59, v58
    v_lshlrev_b32 v242, 16, v59
    v_and_b32 v243, s59, v59
    v_pk_add_f32 v[204:205], v[204:205], v[240:241]
    v_pk_add_f32 v[206:207], v[206:207], v[242:243]
    v_lshlrev_b32 v244, 16, v102
    v_and_b32 v245, s59, v102
    v_lshlrev_b32 v246, 16, v103
    v_and_b32 v247, s59, v103
    v_pk_add_f32 v[204:205], v[204:205], v[244:245]
    v_pk_add_f32 v[206:207], v[206:207], v[246:247]
    v_lshlrev_b32 v248, 16, v146
    v_and_b32 v249, s59, v146
    v_lshlrev_b32 v250, 16, v147
    v_and_b32 v251, s59, v147
    v_pk_add_f32 v[204:205], v[204:205], v[248:249]
    v_pk_add_f32 v[206:207], v[206:207], v[250:251]
    v_cvt_pk_bf16_f32 v204, v204, v205
    v_cvt_pk_bf16_f32 v205, v206, v207
    s_add_u32 s57, s55, 0
    buffer_store_dwordx2 v[204:205], v1, s[24:27], s57 offen offset:224
    s_waitcnt vmcnt(14)
    v_lshlrev_b32 v228, 16, v68
    v_and_b32 v229, s59, v68
    v_lshlrev_b32 v230, 16, v69
    v_and_b32 v231, s59, v69
    v_pk_add_f32 v[164:165], v[164:165], v[228:229]
    v_pk_add_f32 v[166:167], v[166:167], v[230:231]
    v_lshlrev_b32 v232, 16, v104
    v_and_b32 v233, s59, v104
    v_lshlrev_b32 v234, 16, v105
    v_and_b32 v235, s59, v105
    v_pk_add_f32 v[164:165], v[164:165], v[232:233]
    v_pk_add_f32 v[166:167], v[166:167], v[234:235]
    v_lshlrev_b32 v236, 16, v148
    v_and_b32 v237, s59, v148
    v_lshlrev_b32 v238, 16, v149
    v_and_b32 v239, s59, v149
    v_pk_add_f32 v[164:165], v[164:165], v[236:237]
    v_pk_add_f32 v[166:167], v[166:167], v[238:239]
    v_cvt_pk_bf16_f32 v164, v164, v165
    v_cvt_pk_bf16_f32 v165, v166, v167
    s_add_u32 s56, s55, 0
    buffer_store_dwordx2 v[164:165], v1, s[24:27], s56 offen offset:256
    v_lshlrev_b32 v240, 16, v70
    v_and_b32 v241, s59, v70
    v_lshlrev_b32 v242, 16, v71
    v_and_b32 v243, s59, v71
    v_pk_add_f32 v[40:41], v[40:41], v[240:241]
    v_pk_add_f32 v[42:43], v[42:43], v[242:243]
    v_lshlrev_b32 v244, 16, v106
    v_and_b32 v245, s59, v106
    v_lshlrev_b32 v246, 16, v107
    v_and_b32 v247, s59, v107
    v_pk_add_f32 v[40:41], v[40:41], v[244:245]
    v_pk_add_f32 v[42:43], v[42:43], v[246:247]
    v_lshlrev_b32 v248, 16, v150
    v_and_b32 v249, s59, v150
    v_lshlrev_b32 v250, 16, v151
    v_and_b32 v251, s59, v151
    v_pk_add_f32 v[40:41], v[40:41], v[248:249]
    v_pk_add_f32 v[42:43], v[42:43], v[250:251]
    v_cvt_pk_bf16_f32 v40, v40, v41
    v_cvt_pk_bf16_f32 v41, v42, v43
    s_add_u32 s57, s55, 36864
    buffer_store_dwordx2 v[40:41], v1, s[24:27], s57 offen offset:0
    s_waitcnt vmcnt(13)
    v_lshlrev_b32 v228, 16, v72
    v_and_b32 v229, s59, v72
    v_lshlrev_b32 v230, 16, v73
    v_and_b32 v231, s59, v73
    v_pk_add_f32 v[64:65], v[64:65], v[228:229]
    v_pk_add_f32 v[66:67], v[66:67], v[230:231]
    v_lshlrev_b32 v232, 16, v116
    v_and_b32 v233, s59, v116
    v_lshlrev_b32 v234, 16, v117
    v_and_b32 v235, s59, v117
    v_pk_add_f32 v[64:65], v[64:65], v[232:233]
    v_pk_add_f32 v[66:67], v[66:67], v[234:235]
    v_lshlrev_b32 v236, 16, v152
    v_and_b32 v237, s59, v152
    v_lshlrev_b32 v238, 16, v153
    v_and_b32 v239, s59, v153
    v_pk_add_f32 v[64:65], v[64:65], v[236:237]
    v_pk_add_f32 v[66:67], v[66:67], v[238:239]
    v_cvt_pk_bf16_f32 v64, v64, v65
    v_cvt_pk_bf16_f32 v65, v66, v67
    s_add_u32 s56, s55, 36864
    buffer_store_dwordx2 v[64:65], v1, s[24:27], s56 offen offset:32
    v_lshlrev_b32 v240, 16, v74
    v_and_b32 v241, s59, v74
    v_lshlrev_b32 v242, 16, v75
    v_and_b32 v243, s59, v75
    v_pk_add_f32 v[88:89], v[88:89], v[240:241]
    v_pk_add_f32 v[90:91], v[90:91], v[242:243]
    v_lshlrev_b32 v244, 16, v118
    v_and_b32 v245, s59, v118
    v_lshlrev_b32 v246, 16, v119
    v_and_b32 v247, s59, v119
    v_pk_add_f32 v[88:89], v[88:89], v[244:245]
    v_pk_add_f32 v[90:91], v[90:91], v[246:247]
    v_lshlrev_b32 v248, 16, v154
    v_and_b32 v249, s59, v154
    v_lshlrev_b32 v250, 16, v155
    v_and_b32 v251, s59, v155
    v_pk_add_f32 v[88:89], v[88:89], v[248:249]
    v_pk_add_f32 v[90:91], v[90:91], v[250:251]
    v_cvt_pk_bf16_f32 v88, v88, v89
    v_cvt_pk_bf16_f32 v89, v90, v91
    s_add_u32 s57, s55, 36864
    buffer_store_dwordx2 v[88:89], v1, s[24:27], s57 offen offset:64
    s_waitcnt vmcnt(12)
    v_lshlrev_b32 v228, 16, v76
    v_and_b32 v229, s59, v76
    v_lshlrev_b32 v230, 16, v77
    v_and_b32 v231, s59, v77
    v_pk_add_f32 v[112:113], v[112:113], v[228:229]
    v_pk_add_f32 v[114:115], v[114:115], v[230:231]
    v_lshlrev_b32 v232, 16, v120
    v_and_b32 v233, s59, v120
    v_lshlrev_b32 v234, 16, v121
    v_and_b32 v235, s59, v121
    v_pk_add_f32 v[112:113], v[112:113], v[232:233]
    v_pk_add_f32 v[114:115], v[114:115], v[234:235]
    v_lshlrev_b32 v236, 16, v160
    v_and_b32 v237, s59, v160
    v_lshlrev_b32 v238, 16, v161
    v_and_b32 v239, s59, v161
    v_pk_add_f32 v[112:113], v[112:113], v[236:237]
    v_pk_add_f32 v[114:115], v[114:115], v[238:239]
    v_cvt_pk_bf16_f32 v112, v112, v113
    v_cvt_pk_bf16_f32 v113, v114, v115
    s_add_u32 s56, s55, 36864
    buffer_store_dwordx2 v[112:113], v1, s[24:27], s56 offen offset:96
    v_lshlrev_b32 v240, 16, v78
    v_and_b32 v241, s59, v78
    v_lshlrev_b32 v242, 16, v79
    v_and_b32 v243, s59, v79
    v_pk_add_f32 v[136:137], v[136:137], v[240:241]
    v_pk_add_f32 v[138:139], v[138:139], v[242:243]
    v_lshlrev_b32 v244, 16, v122
    v_and_b32 v245, s59, v122
    v_lshlrev_b32 v246, 16, v123
    v_and_b32 v247, s59, v123
    v_pk_add_f32 v[136:137], v[136:137], v[244:245]
    v_pk_add_f32 v[138:139], v[138:139], v[246:247]
    v_lshlrev_b32 v248, 16, v162
    v_and_b32 v249, s59, v162
    v_lshlrev_b32 v250, 16, v163
    v_and_b32 v251, s59, v163
    v_pk_add_f32 v[136:137], v[136:137], v[248:249]
    v_pk_add_f32 v[138:139], v[138:139], v[250:251]
    v_cvt_pk_bf16_f32 v136, v136, v137
    v_cvt_pk_bf16_f32 v137, v138, v139
    s_add_u32 s57, s55, 36864
    buffer_store_dwordx2 v[136:137], v1, s[24:27], s57 offen offset:128
    s_endpgm
L_var1:
    s_mul_i32 s55, s36, 7168
    s_add_u32 s78, s55, 28672
    s_waitcnt lgkmcnt(15)
    v_mfma_f32_16x16x32_bf16 v[36:39], a[0:3], a[36:39], v[36:39]
    s_add_u32 s79, s55, 32768
    s_add_u32 s80, s55, 258048
    v_mfma_f32_16x16x32_bf16 v[40:43], a[0:3], a[40:43], v[40:43]
    s_add_u32 s81, s55, 262144
    s_add_u32 s82, s55, 372736
    v_mfma_f32_16x16x32_bf16 v[44:47], a[0:3], a[44:47], v[44:47]
    s_add_u32 s83, s55, 376832
    s_nop 0
    v_cvt_pk_bf16_f32 v228, v36, v37
    v_mfma_f32_16x16x32_bf16 v[48:51], a[0:3], a[48:51], v[48:51]
    v_cvt_pk_bf16_f32 v229, v38, v39
    v_mfma_f32_16x16x32_bf16 v[52:55], a[0:3], a[52:55], v[52:55]
    v_mfma_f32_16x16x32_bf16 v[56:59], a[0:3], a[56:59], v[56:59]
    s_nop 4
    v_cvt_pk_bf16_f32 v232, v48, v49
    v_cvt_pk_bf16_f32 v233, v50, v51
    s_waitcnt lgkmcnt(14)
    v_mfma_f32_16x16x32_bf16 v[60:63], a[4:7], a[36:39], v[60:63]
    v_mfma_f32_16x16x32_bf16 v[64:67], a[4:7], a[40:43], v[64:67]
    v_cvt_pk_bf16_f32 v236, v56, v57
    v_cvt_pk_bf16_f32 v237, v58, v59
    v_mfma_f32_16x16x32_bf16 v[68:71], a[4:7], a[44:47], v[68:71]
    s_nop 3
    v_cvt_pk_bf16_f32 v230, v60, v61
    v_cvt_pk_bf16_f32 v231, v62, v63
    v_mfma_f32_16x16x32_bf16 v[72:75], a[4:7], a[48:51], v[72:75]
    buffer_store_dwordx4 v[228:231], v26, s[32:35], s78 offen offset:0 sc1
    v_mfma_f32_16x16x32_bf16 v[76:79], a[4:7], a[52:55], v[76:79]
    v_cvt_pk_bf16_f32 v240, v64, v65
    v_cvt_pk_bf16_f32 v241, v66, v67
    v_mfma_f32_16x16x32_bf16 v[80:83], a[4:7], a[56:59], v[80:83]
    s_nop 2
    v_cvt_pk_bf16_f32 v234, v72, v73
    v_cvt_pk_bf16_f32 v235, v74, v75
    s_waitcnt lgkmcnt(12)
    v_mfma_f32_16x16x32_bf16 v[84:87], a[8:11], a[36:39], v[84:87]
    buffer_store_dwordx4 v[232:235], v26, s[32:35], s80 offen offset:0 sc1
    v_mfma_f32_16x16x32_bf16 v[88:91], a[8:11], a[40:43], v[88:91]
    v_cvt_pk_bf16_f32 v238, v80, v81
    v_cvt_pk_bf16_f32 v239, v82, v83
    v_mfma_f32_16x16x32_bf16 v[92:95], a[8:11], a[44:47], v[92:95]
    buffer_store_dwordx4 v[236:239], v26, s[32:35], s82 offen offset:2048 sc1
    v_mfma_f32_16x16x32_bf16 v[96:99], a[8:11], a[48:51], v[96:99]
    s_nop 2
    v_cvt_pk_bf16_f32 v242, v88, v89
    v_cvt_pk_bf16_f32 v243, v90, v91
    v_mfma_f32_16x16x32_bf16 v[100:103], a[8:11], a[52:55], v[100:103]
    buffer_store_dwordx4 v[240:243], v26, s[32:35], s79 offen offset:1024 sc1
    v_mfma_f32_16x16x32_bf16 v[104:107], a[8:11], a[56:59], v[104:107]
    v_cvt_pk_bf16_f32 v228, v76, v77
    v_cvt_pk_bf16_f32 v229, v78, v79
    s_waitcnt lgkmcnt(10)
    v_mfma_f32_16x16x32_bf16 v[108:111], a[12:15], a[36:39], v[108:111]
    s_nop 1
    v_cvt_pk_bf16_f32 v230, v100, v101
    v_cvt_pk_bf16_f32 v231, v102, v103
    v_mfma_f32_16x16x32_bf16 v[112:115], a[12:15], a[40:43], v[112:115]
    buffer_store_dwordx4 v[228:231], v26, s[32:35], s81 offen offset:1024 sc1
    v_mfma_f32_16x16x32_bf16 v[116:119], a[12:15], a[44:47], v[116:119]
    v_cvt_pk_bf16_f32 v232, v84, v85
    v_cvt_pk_bf16_f32 v233, v86, v87
    v_mfma_f32_16x16x32_bf16 v[120:123], a[12:15], a[48:51], v[120:123]
    v_cvt_pk_bf16_f32 v234, v108, v109
    v_cvt_pk_bf16_f32 v235, v110, v111
    v_mfma_f32_16x16x32_bf16 v[124:127], a[12:15], a[52:55], v[124:127]
    buffer_store_dwordx4 v[232:235], v26, s[32:35], s78 offen offset:1024 sc1
    v_mfma_f32_16x16x32_bf16 v[128:131], a[12:15], a[56:59], v[128:131]
    v_cvt_pk_bf16_f32 v236, v96, v97
    v_cvt_pk_bf16_f32 v237, v98, v99
    s_waitcnt lgkmcnt(8)
    v_mfma_f32_16x16x32_bf16 v[132:135], a[16:19], a[36:39], v[132:135]
    v_cvt_pk_bf16_f32 v238, v120, v121
    v_cvt_pk_bf16_f32 v239, v122, v123
    v_mfma_f32_16x16x32_bf16 v[136:139], a[16:19], a[40:43], v[136:139]
    buffer_store_dwordx4 v[236:239], v26, s[32:35], s80 offen offset:1024 sc1
    v_mfma_f32_16x16x32_bf16 v[140:143], a[16:19], a[44:47], v[140:143]
    v_cvt_pk_bf16_f32 v240, v104, v105
    v_cvt_pk_bf16_f32 v241, v106, v107
    v_mfma_f32_16x16x32_bf16 v[144:147], a[16:19], a[48:51], v[144:147]
    v_cvt_pk_bf16_f32 v242, v128, v129
    v_cvt_pk_bf16_f32 v243, v130, v131
    v_mfma_f32_16x16x32_bf16 v[148:151], a[16:19], a[52:55], v[148:151]
    buffer_store_dwordx4 v[240:243], v26, s[32:35], s82 offen offset:3072 sc1
    v_mfma_f32_16x16x32_bf16 v[152:155], a[16:19], a[56:59], v[152:155]
    v_cvt_pk_bf16_f32 v228, v112, v113
    v_cvt_pk_bf16_f32 v229, v114, v115
    s_waitcnt lgkmcnt(6)
    v_mfma_f32_16x16x32_bf16 v[156:159], a[20:23], a[36:39], v[156:159]
    v_cvt_pk_bf16_f32 v230, v136, v137
    v_cvt_pk_bf16_f32 v231, v138, v139
    v_mfma_f32_16x16x32_bf16 v[160:163], a[20:23], a[40:43], v[160:163]
    buffer_store_dwordx4 v[228:231], v26, s[32:35], s79 offen offset:2048 sc1
    v_mfma_f32_16x16x32_bf16 v[164:167], a[20:23], a[44:47], v[164:167]
    v_cvt_pk_bf16_f32 v232, v124, v125
    v_cvt_pk_bf16_f32 v233, v126, v127
    v_mfma_f32_16x16x32_bf16 v[168:171], a[20:23], a[48:51], v[168:171]
    v_cvt_pk_bf16_f32 v234, v148, v149
    v_cvt_pk_bf16_f32 v235, v150, v151
    v_mfma_f32_16x16x32_bf16 v[172:175], a[20:23], a[52:55], v[172:175]
    buffer_store_dwordx4 v[232:235], v26, s[32:35], s81 offen offset:2048 sc1
    v_mfma_f32_16x16x32_bf16 v[176:179], a[20:23], a[56:59], v[176:179]
    v_cvt_pk_bf16_f32 v236, v132, v133
    v_cvt_pk_bf16_f32 v237, v134, v135
    s_waitcnt lgkmcnt(4)
    v_mfma_f32_16x16x32_bf16 v[180:183], a[24:27], a[36:39], v[180:183]
    v_cvt_pk_bf16_f32 v238, v156, v157
    v_cvt_pk_bf16_f32 v239, v158, v159
    v_mfma_f32_16x16x32_bf16 v[184:187], a[24:27], a[40:43], v[184:187]
    buffer_store_dwordx4 v[236:239], v26, s[32:35], s78 offen offset:2048 sc1
    v_mfma_f32_16x16x32_bf16 v[188:191], a[24:27], a[44:47], v[188:191]
    v_cvt_pk_bf16_f32 v240, v144, v145
    v_cvt_pk_bf16_f32 v241, v146, v147
    v_mfma_f32_16x16x32_bf16 v[192:195], a[24:27], a[48:51], v[192:195]
    v_cvt_pk_bf16_f32 v242, v168, v169
    v_cvt_pk_bf16_f32 v243, v170, v171
    v_mfma_f32_16x16x32_bf16 v[196:199], a[24:27], a[52:55], v[196:199]
    buffer_store_dwordx4 v[240:243], v26, s[32:35], s80 offen offset:2048 sc1
    v_mfma_f32_16x16x32_bf16 v[200:203], a[24:27], a[56:59], v[200:203]
    v_cvt_pk_bf16_f32 v228, v152, v153
    v_cvt_pk_bf16_f32 v229, v154, v155
    s_waitcnt lgkmcnt(2)
    v_mfma_f32_16x16x32_bf16 v[204:207], a[28:31], a[36:39], v[204:207]
    v_cvt_pk_bf16_f32 v230, v176, v177
    v_cvt_pk_bf16_f32 v231, v178, v179
    v_mfma_f32_16x16x32_bf16 v[208:211], a[28:31], a[40:43], v[208:211]
    buffer_store_dwordx4 v[228:231], v26, s[32:35], s83 offen offset:0 sc1
    v_mfma_f32_16x16x32_bf16 v[212:215], a[28:31], a[44:47], v[212:215]
    v_cvt_pk_bf16_f32 v232, v172, v173
    v_cvt_pk_bf16_f32 v233, v174, v175
    v_mfma_f32_16x16x32_bf16 v[216:219], a[28:31], a[48:51], v[216:219]
    v_cvt_pk_bf16_f32 v234, v196, v197
    v_cvt_pk_bf16_f32 v235, v198, v199
    v_mfma_f32_16x16x32_bf16 v[220:223], a[28:31], a[52:55], v[220:223]
    buffer_store_dwordx4 v[232:235], v26, s[32:35], s82 offen offset:0 sc1
    v_mfma_f32_16x16x32_bf16 v[224:227], a[28:31], a[56:59], v[224:227]
    v_cvt_pk_bf16_f32 v236, v180, v181
    v_cvt_pk_bf16_f32 v237, v182, v183
    s_waitcnt lgkmcnt(0)
    v_mfma_f32_16x16x32_bf16 a[60:63], a[32:35], a[36:39], a[60:63]
    v_cvt_pk_bf16_f32 v238, v204, v205
    v_cvt_pk_bf16_f32 v239, v206, v207
    v_mfma_f32_16x16x32_bf16 a[64:67], a[32:35], a[40:43], a[64:67]
    buffer_store_dwordx4 v[236:239], v26, s[32:35], s78 offen offset:3072 sc1
    v_mfma_f32_16x16x32_bf16 a[68:71], a[32:35], a[44:47], a[68:71]
    v_cvt_pk_bf16_f32 v240, v192, v193
    v_cvt_pk_bf16_f32 v241, v194, v195
    v_mfma_f32_16x16x32_bf16 a[72:75], a[32:35], a[48:51], a[72:75]
    v_cvt_pk_bf16_f32 v242, v216, v217
    v_cvt_pk_bf16_f32 v243, v218, v219
    v_mfma_f32_16x16x32_bf16 a[76:79], a[32:35], a[52:55], a[76:79]
    buffer_store_dwordx4 v[240:243], v26, s[32:35], s80 offen offset:3072 sc1
    v_mfma_f32_16x16x32_bf16 a[80:83], a[32:35], a[56:59], a[80:83]
    v_cvt_pk_bf16_f32 v228, v200, v201
    v_cvt_pk_bf16_f32 v229, v202, v203
    v_cvt_pk_bf16_f32 v230, v224, v225
    v_cvt_pk_bf16_f32 v231, v226, v227
    buffer_store_dwordx4 v[228:231], v26, s[32:35], s83 offen offset:1024 sc1
    v_accvgpr_read_b32 v244, a60
    v_accvgpr_read_b32 v245, a61
    v_accvgpr_read_b32 v246, a62
    v_accvgpr_read_b32 v247, a63
    v_cvt_pk_bf16_f32 v232, v244, v245
    v_cvt_pk_bf16_f32 v233, v246, v247
    v_cvt_pk_bf16_f32 v234, v40, v41
    v_cvt_pk_bf16_f32 v235, v42, v43
    buffer_store_dwordx4 v[232:235], v26, s[32:35], s79 offen offset:0 sc1
    v_accvgpr_read_b32 v248, a72
    v_accvgpr_read_b32 v249, a73
    v_accvgpr_read_b32 v250, a74
    v_accvgpr_read_b32 v251, a75
    v_cvt_pk_bf16_f32 v236, v248, v249
    v_cvt_pk_bf16_f32 v237, v250, v251
    v_cvt_pk_bf16_f32 v238, v52, v53
    v_cvt_pk_bf16_f32 v239, v54, v55
    buffer_store_dwordx4 v[236:239], v26, s[32:35], s81 offen offset:0 sc1
    v_cvt_pk_bf16_f32 v240, v220, v221
    v_cvt_pk_bf16_f32 v241, v222, v223
    v_accvgpr_read_b32 v252, a76
    v_accvgpr_read_b32 v253, a77
    v_accvgpr_read_b32 v254, a78
    v_accvgpr_read_b32 v255, a79
    v_cvt_pk_bf16_f32 v242, v252, v253
    v_cvt_pk_bf16_f32 v243, v254, v255
    buffer_store_dwordx4 v[240:243], v26, s[32:35], s82 offen offset:1024 sc1
    v_accvgpr_read_b32 v244, a80
    v_accvgpr_read_b32 v245, a81
    v_accvgpr_read_b32 v246, a82
    v_accvgpr_read_b32 v247, a83
    v_cvt_pk_bf16_f32 v228, v244, v245
    v_cvt_pk_bf16_f32 v229, v246, v247
    buffer_store_dwordx4 v[228:231], v26, s[32:35], s83 offen offset:2048 sc1
    s_lshl_b32 s55, s36, 7
    s_add_u32 s55, s55, 458756
    v_lshlrev_b32 v1, 9, v0
    v_mov_b32 v2, 1
    v_mov_b32 v3, 508
    s_mov_b64 s[82:83], exec
    s_waitcnt vmcnt(0)
    s_mov_b64 exec, 13
    buffer_store_dword v2, v1, s[32:35], s55 offen sc1
    s_mov_b64 exec, 1
L_poll1:
    buffer_load_dwordx4 v[228:231], v3, s[32:35], s55 offen sc1
    s_waitcnt vmcnt(0)
    v_and_b32 v228, v228, v230
    v_and_b32 v228, v228, v231
    s_nop 0
    v_readfirstlane_b32 s56, v228
    s_nop 0
    s_cmp_eq_u32 s56, 1
    s_cbranch_scc1 L_poll_done1
    s_sleep 1
    s_branch L_poll1
L_poll_done1:
    s_mov_b64 exec, s[82:83]
    s_mul_i32 s55, s36, 7168
    s_add_u32 s56, s55, 114688
    buffer_load_dwordx4 v[36:39], v26, s[32:35], s56 offen offset:0 sc1
    s_add_u32 s57, s55, 172032
    buffer_load_dwordx4 v[72:75], v26, s[32:35], s57 offen offset:0 sc1
    s_add_u32 s58, s55, 200704
    buffer_load_dwordx4 v[104:107], v26, s[32:35], s58 offen offset:0 sc1
    buffer_load_dwordx4 v[40:43], v26, s[32:35], s56 offen offset:1024 sc1
    buffer_load_dwordx4 v[76:79], v26, s[32:35], s57 offen offset:1024 sc1
    buffer_load_dwordx4 v[108:111], v26, s[32:35], s58 offen offset:1024 sc1
    buffer_load_dwordx4 v[48:51], v26, s[32:35], s56 offen offset:2048 sc1
    buffer_load_dwordx4 v[80:83], v26, s[32:35], s57 offen offset:2048 sc1
    buffer_load_dwordx4 v[112:115], v26, s[32:35], s58 offen offset:2048 sc1
    buffer_load_dwordx4 v[52:55], v26, s[32:35], s56 offen offset:3072 sc1
    buffer_load_dwordx4 v[84:87], v26, s[32:35], s57 offen offset:3072 sc1
    buffer_load_dwordx4 v[120:123], v26, s[32:35], s58 offen offset:3072 sc1
    s_add_u32 s56, s55, 118784
    buffer_load_dwordx4 v[56:59], v26, s[32:35], s56 offen offset:0 sc1
    s_add_u32 s57, s55, 176128
    buffer_load_dwordx4 v[88:91], v26, s[32:35], s57 offen offset:0 sc1
    s_add_u32 s58, s55, 204800
    buffer_load_dwordx4 v[124:127], v26, s[32:35], s58 offen offset:0 sc1
    buffer_load_dwordx4 v[60:63], v26, s[32:35], s56 offen offset:1024 sc1
    buffer_load_dwordx4 v[96:99], v26, s[32:35], s57 offen offset:1024 sc1
    buffer_load_dwordx4 v[128:131], v26, s[32:35], s58 offen offset:1024 sc1
    buffer_load_dwordx4 v[64:67], v26, s[32:35], s56 offen offset:2048 sc1
    buffer_load_dwordx4 v[100:103], v26, s[32:35], s57 offen offset:2048 sc1
    buffer_load_dwordx4 v[132:135], v26, s[32:35], s58 offen offset:2048 sc1
    v_and_b32 v1, 15, v0
    v_mul_u32_u24 v1, 2304, v1
    v_lshrrev_b32 v2, 4, v0
    v_lshl_add_u32 v1, v2, 3, v1
    s_mul_i32 s55, s36, 288
    s_mov_b32 s59, 0xffff0000
    v_accvgpr_read_b32 v136, a64
    v_accvgpr_read_b32 v137, a65
    v_accvgpr_read_b32 v138, a66
    v_accvgpr_read_b32 v139, a67
    v_accvgpr_read_b32 v144, a68
    v_accvgpr_read_b32 v145, a69
    v_accvgpr_read_b32 v146, a70
    v_accvgpr_read_b32 v147, a71
    s_waitcnt vmcnt(18)
    v_lshlrev_b32 v228, 16, v36
    v_and_b32 v229, s59, v36
    v_lshlrev_b32 v230, 16, v37
    v_and_b32 v231, s59, v37
    v_pk_add_f32 v[160:161], v[160:161], v[228:229]
    v_pk_add_f32 v[162:163], v[162:163], v[230:231]
    v_lshlrev_b32 v232, 16, v72
    v_and_b32 v233, s59, v72
    v_lshlrev_b32 v234, 16, v73
    v_and_b32 v235, s59, v73
    v_pk_add_f32 v[160:161], v[160:161], v[232:233]
    v_pk_add_f32 v[162:163], v[162:163], v[234:235]
    v_lshlrev_b32 v236, 16, v104
    v_and_b32 v237, s59, v104
    v_lshlrev_b32 v238, 16, v105
    v_and_b32 v239, s59, v105
    v_pk_add_f32 v[160:161], v[160:161], v[236:237]
    v_pk_add_f32 v[162:163], v[162:163], v[238:239]
    v_cvt_pk_bf16_f32 v160, v160, v161
    v_cvt_pk_bf16_f32 v161, v162, v163
    s_add_u32 s56, s55, 36864
    buffer_store_dwordx2 v[160:161], v1, s[24:27], s56 offen offset:160
    v_lshlrev_b32 v240, 16, v38
    v_and_b32 v241, s59, v38
    v_lshlrev_b32 v242, 16, v39
    v_and_b32 v243, s59, v39
    v_pk_add_f32 v[184:185], v[184:185], v[240:241]
    v_pk_add_f32 v[186:187], v[186:187], v[242:243]
    v_lshlrev_b32 v244, 16, v74
    v_and_b32 v245, s59, v74
    v_lshlrev_b32 v246, 16, v75
    v_and_b32 v247, s59, v75
    v_pk_add_f32 v[184:185], v[184:185], v[244:245]
    v_pk_add_f32 v[186:187], v[186:187], v[246:247]
    v_lshlrev_b32 v248, 16, v106
    v_and_b32 v249, s59, v106
    v_lshlrev_b32 v250, 16, v107
    v_and_b32 v251, s59, v107
    v_pk_add_f32 v[184:185], v[184:185], v[248:249]
    v_pk_add_f32 v[186:187], v[186:187], v[250:251]
    v_cvt_pk_bf16_f32 v184, v184, v185
    v_cvt_pk_bf16_f32 v185, v186, v187
    s_add_u32 s57, s55, 36864
    buffer_store_dwordx2 v[184:185], v1, s[24:27], s57 offen offset:192
    s_waitcnt vmcnt(17)
    v_lshlrev_b32 v228, 16, v40
    v_and_b32 v229, s59, v40
    v_lshlrev_b32 v230, 16, v41
    v_and_b32 v231, s59, v41
    v_pk_add_f32 v[208:209], v[208:209], v[228:229]
    v_pk_add_f32 v[210:211], v[210:211], v[230:231]
    v_lshlrev_b32 v232, 16, v76
    v_and_b32 v233, s59, v76
    v_lshlrev_b32 v234, 16, v77
    v_and_b32 v235, s59, v77
    v_pk_add_f32 v[208:209], v[208:209], v[232:233]
    v_pk_add_f32 v[210:211], v[210:211], v[234:235]
    v_lshlrev_b32 v236, 16, v108
    v_and_b32 v237, s59, v108
    v_lshlrev_b32 v238, 16, v109
    v_and_b32 v239, s59, v109
    v_pk_add_f32 v[208:209], v[208:209], v[236:237]
    v_pk_add_f32 v[210:211], v[210:211], v[238:239]
    v_cvt_pk_bf16_f32 v208, v208, v209
    v_cvt_pk_bf16_f32 v209, v210, v211
    s_add_u32 s56, s55, 36864
    buffer_store_dwordx2 v[208:209], v1, s[24:27], s56 offen offset:224
    v_lshlrev_b32 v240, 16, v42
    v_and_b32 v241, s59, v42
    v_lshlrev_b32 v242, 16, v43
    v_and_b32 v243, s59, v43
    v_pk_add_f32 v[136:137], v[136:137], v[240:241]
    v_pk_add_f32 v[138:139], v[138:139], v[242:243]
    v_lshlrev_b32 v244, 16, v78
    v_and_b32 v245, s59, v78
    v_lshlrev_b32 v246, 16, v79
    v_and_b32 v247, s59, v79
    v_pk_add_f32 v[136:137], v[136:137], v[244:245]
    v_pk_add_f32 v[138:139], v[138:139], v[246:247]
    v_lshlrev_b32 v248, 16, v110
    v_and_b32 v249, s59, v110
    v_lshlrev_b32 v250, 16, v111
    v_and_b32 v251, s59, v111
    v_pk_add_f32 v[136:137], v[136:137], v[248:249]
    v_pk_add_f32 v[138:139], v[138:139], v[250:251]
    v_cvt_pk_bf16_f32 v136, v136, v137
    v_cvt_pk_bf16_f32 v137, v138, v139
    s_add_u32 s57, s55, 36864
    buffer_store_dwordx2 v[136:137], v1, s[24:27], s57 offen offset:256
    s_waitcnt vmcnt(16)
    v_lshlrev_b32 v228, 16, v48
    v_and_b32 v229, s59, v48
    v_lshlrev_b32 v230, 16, v49
    v_and_b32 v231, s59, v49
    v_pk_add_f32 v[44:45], v[44:45], v[228:229]
    v_pk_add_f32 v[46:47], v[46:47], v[230:231]
    v_lshlrev_b32 v232, 16, v80
    v_and_b32 v233, s59, v80
    v_lshlrev_b32 v234, 16, v81
    v_and_b32 v235, s59, v81
    v_pk_add_f32 v[44:45], v[44:45], v[232:233]
    v_pk_add_f32 v[46:47], v[46:47], v[234:235]
    v_lshlrev_b32 v236, 16, v112
    v_and_b32 v237, s59, v112
    v_lshlrev_b32 v238, 16, v113
    v_and_b32 v239, s59, v113
    v_pk_add_f32 v[44:45], v[44:45], v[236:237]
    v_pk_add_f32 v[46:47], v[46:47], v[238:239]
    v_cvt_pk_bf16_f32 v44, v44, v45
    v_cvt_pk_bf16_f32 v45, v46, v47
    s_add_u32 s56, s55, 73728
    buffer_store_dwordx2 v[44:45], v1, s[24:27], s56 offen offset:0
    v_lshlrev_b32 v240, 16, v50
    v_and_b32 v241, s59, v50
    v_lshlrev_b32 v242, 16, v51
    v_and_b32 v243, s59, v51
    v_pk_add_f32 v[68:69], v[68:69], v[240:241]
    v_pk_add_f32 v[70:71], v[70:71], v[242:243]
    v_lshlrev_b32 v244, 16, v82
    v_and_b32 v245, s59, v82
    v_lshlrev_b32 v246, 16, v83
    v_and_b32 v247, s59, v83
    v_pk_add_f32 v[68:69], v[68:69], v[244:245]
    v_pk_add_f32 v[70:71], v[70:71], v[246:247]
    v_lshlrev_b32 v248, 16, v114
    v_and_b32 v249, s59, v114
    v_lshlrev_b32 v250, 16, v115
    v_and_b32 v251, s59, v115
    v_pk_add_f32 v[68:69], v[68:69], v[248:249]
    v_pk_add_f32 v[70:71], v[70:71], v[250:251]
    v_cvt_pk_bf16_f32 v68, v68, v69
    v_cvt_pk_bf16_f32 v69, v70, v71
    s_add_u32 s57, s55, 73728
    buffer_store_dwordx2 v[68:69], v1, s[24:27], s57 offen offset:32
    s_waitcnt vmcnt(15)
    v_lshlrev_b32 v228, 16, v52
    v_and_b32 v229, s59, v52
    v_lshlrev_b32 v230, 16, v53
    v_and_b32 v231, s59, v53
    v_pk_add_f32 v[92:93], v[92:93], v[228:229]
    v_pk_add_f32 v[94:95], v[94:95], v[230:231]
    v_lshlrev_b32 v232, 16, v84
    v_and_b32 v233, s59, v84
    v_lshlrev_b32 v234, 16, v85
    v_and_b32 v235, s59, v85
    v_pk_add_f32 v[92:93], v[92:93], v[232:233]
    v_pk_add_f32 v[94:95], v[94:95], v[234:235]
    v_lshlrev_b32 v236, 16, v120
    v_and_b32 v237, s59, v120
    v_lshlrev_b32 v238, 16, v121
    v_and_b32 v239, s59, v121
    v_pk_add_f32 v[92:93], v[92:93], v[236:237]
    v_pk_add_f32 v[94:95], v[94:95], v[238:239]
    v_cvt_pk_bf16_f32 v92, v92, v93
    v_cvt_pk_bf16_f32 v93, v94, v95
    s_add_u32 s56, s55, 73728
    buffer_store_dwordx2 v[92:93], v1, s[24:27], s56 offen offset:64
    v_lshlrev_b32 v240, 16, v54
    v_and_b32 v241, s59, v54
    v_lshlrev_b32 v242, 16, v55
    v_and_b32 v243, s59, v55
    v_pk_add_f32 v[116:117], v[116:117], v[240:241]
    v_pk_add_f32 v[118:119], v[118:119], v[242:243]
    v_lshlrev_b32 v244, 16, v86
    v_and_b32 v245, s59, v86
    v_lshlrev_b32 v246, 16, v87
    v_and_b32 v247, s59, v87
    v_pk_add_f32 v[116:117], v[116:117], v[244:245]
    v_pk_add_f32 v[118:119], v[118:119], v[246:247]
    v_lshlrev_b32 v248, 16, v122
    v_and_b32 v249, s59, v122
    v_lshlrev_b32 v250, 16, v123
    v_and_b32 v251, s59, v123
    v_pk_add_f32 v[116:117], v[116:117], v[248:249]
    v_pk_add_f32 v[118:119], v[118:119], v[250:251]
    v_cvt_pk_bf16_f32 v116, v116, v117
    v_cvt_pk_bf16_f32 v117, v118, v119
    s_add_u32 s57, s55, 73728
    buffer_store_dwordx2 v[116:117], v1, s[24:27], s57 offen offset:96
    s_waitcnt vmcnt(14)
    v_lshlrev_b32 v228, 16, v56
    v_and_b32 v229, s59, v56
    v_lshlrev_b32 v230, 16, v57
    v_and_b32 v231, s59, v57
    v_pk_add_f32 v[140:141], v[140:141], v[228:229]
    v_pk_add_f32 v[142:143], v[142:143], v[230:231]
    v_lshlrev_b32 v232, 16, v88
    v_and_b32 v233, s59, v88
    v_lshlrev_b32 v234, 16, v89
    v_and_b32 v235, s59, v89
    v_pk_add_f32 v[140:141], v[140:141], v[232:233]
    v_pk_add_f32 v[142:143], v[142:143], v[234:235]
    v_lshlrev_b32 v236, 16, v124
    v_and_b32 v237, s59, v124
    v_lshlrev_b32 v238, 16, v125
    v_and_b32 v239, s59, v125
    v_pk_add_f32 v[140:141], v[140:141], v[236:237]
    v_pk_add_f32 v[142:143], v[142:143], v[238:239]
    v_cvt_pk_bf16_f32 v140, v140, v141
    v_cvt_pk_bf16_f32 v141, v142, v143
    s_add_u32 s56, s55, 73728
    buffer_store_dwordx2 v[140:141], v1, s[24:27], s56 offen offset:128
    v_lshlrev_b32 v240, 16, v58
    v_and_b32 v241, s59, v58
    v_lshlrev_b32 v242, 16, v59
    v_and_b32 v243, s59, v59
    v_pk_add_f32 v[164:165], v[164:165], v[240:241]
    v_pk_add_f32 v[166:167], v[166:167], v[242:243]
    v_lshlrev_b32 v244, 16, v90
    v_and_b32 v245, s59, v90
    v_lshlrev_b32 v246, 16, v91
    v_and_b32 v247, s59, v91
    v_pk_add_f32 v[164:165], v[164:165], v[244:245]
    v_pk_add_f32 v[166:167], v[166:167], v[246:247]
    v_lshlrev_b32 v248, 16, v126
    v_and_b32 v249, s59, v126
    v_lshlrev_b32 v250, 16, v127
    v_and_b32 v251, s59, v127
    v_pk_add_f32 v[164:165], v[164:165], v[248:249]
    v_pk_add_f32 v[166:167], v[166:167], v[250:251]
    v_cvt_pk_bf16_f32 v164, v164, v165
    v_cvt_pk_bf16_f32 v165, v166, v167
    s_add_u32 s57, s55, 73728
    buffer_store_dwordx2 v[164:165], v1, s[24:27], s57 offen offset:160
    s_waitcnt vmcnt(13)
    v_lshlrev_b32 v228, 16, v60
    v_and_b32 v229, s59, v60
    v_lshlrev_b32 v230, 16, v61
    v_and_b32 v231, s59, v61
    v_pk_add_f32 v[188:189], v[188:189], v[228:229]
    v_pk_add_f32 v[190:191], v[190:191], v[230:231]
    v_lshlrev_b32 v232, 16, v96
    v_and_b32 v233, s59, v96
    v_lshlrev_b32 v234, 16, v97
    v_and_b32 v235, s59, v97
    v_pk_add_f32 v[188:189], v[188:189], v[232:233]
    v_pk_add_f32 v[190:191], v[190:191], v[234:235]
    v_lshlrev_b32 v236, 16, v128
    v_and_b32 v237, s59, v128
    v_lshlrev_b32 v238, 16, v129
    v_and_b32 v239, s59, v129
    v_pk_add_f32 v[188:189], v[188:189], v[236:237]
    v_pk_add_f32 v[190:191], v[190:191], v[238:239]
    v_cvt_pk_bf16_f32 v188, v188, v189
    v_cvt_pk_bf16_f32 v189, v190, v191
    s_add_u32 s56, s55, 73728
    buffer_store_dwordx2 v[188:189], v1, s[24:27], s56 offen offset:192
    v_lshlrev_b32 v240, 16, v62
    v_and_b32 v241, s59, v62
    v_lshlrev_b32 v242, 16, v63
    v_and_b32 v243, s59, v63
    v_pk_add_f32 v[212:213], v[212:213], v[240:241]
    v_pk_add_f32 v[214:215], v[214:215], v[242:243]
    v_lshlrev_b32 v244, 16, v98
    v_and_b32 v245, s59, v98
    v_lshlrev_b32 v246, 16, v99
    v_and_b32 v247, s59, v99
    v_pk_add_f32 v[212:213], v[212:213], v[244:245]
    v_pk_add_f32 v[214:215], v[214:215], v[246:247]
    v_lshlrev_b32 v248, 16, v130
    v_and_b32 v249, s59, v130
    v_lshlrev_b32 v250, 16, v131
    v_and_b32 v251, s59, v131
    v_pk_add_f32 v[212:213], v[212:213], v[248:249]
    v_pk_add_f32 v[214:215], v[214:215], v[250:251]
    v_cvt_pk_bf16_f32 v212, v212, v213
    v_cvt_pk_bf16_f32 v213, v214, v215
    s_add_u32 s57, s55, 73728
    buffer_store_dwordx2 v[212:213], v1, s[24:27], s57 offen offset:224
    s_waitcnt vmcnt(12)
    v_lshlrev_b32 v228, 16, v64
    v_and_b32 v229, s59, v64
    v_lshlrev_b32 v230, 16, v65
    v_and_b32 v231, s59, v65
    v_pk_add_f32 v[144:145], v[144:145], v[228:229]
    v_pk_add_f32 v[146:147], v[146:147], v[230:231]
    v_lshlrev_b32 v232, 16, v100
    v_and_b32 v233, s59, v100
    v_lshlrev_b32 v234, 16, v101
    v_and_b32 v235, s59, v101
    v_pk_add_f32 v[144:145], v[144:145], v[232:233]
    v_pk_add_f32 v[146:147], v[146:147], v[234:235]
    v_lshlrev_b32 v236, 16, v132
    v_and_b32 v237, s59, v132
    v_lshlrev_b32 v238, 16, v133
    v_and_b32 v239, s59, v133
    v_pk_add_f32 v[144:145], v[144:145], v[236:237]
    v_pk_add_f32 v[146:147], v[146:147], v[238:239]
    v_cvt_pk_bf16_f32 v144, v144, v145
    v_cvt_pk_bf16_f32 v145, v146, v147
    s_add_u32 s56, s55, 73728
    buffer_store_dwordx2 v[144:145], v1, s[24:27], s56 offen offset:256
    s_endpgm
L_var2:
    s_mul_i32 s55, s36, 7168
    s_add_u32 s78, s55, 57344
    s_waitcnt lgkmcnt(15)
    v_mfma_f32_16x16x32_bf16 v[36:39], a[0:3], a[36:39], v[36:39]
    s_add_u32 s79, s55, 61440
    s_add_u32 s80, s55, 172032
    v_mfma_f32_16x16x32_bf16 v[40:43], a[0:3], a[40:43], v[40:43]
    s_add_u32 s81, s55, 176128
    s_add_u32 s82, s55, 401408
    v_mfma_f32_16x16x32_bf16 v[44:47], a[0:3], a[44:47], v[44:47]
    s_add_u32 s83, s55, 405504
    s_nop 0
    v_cvt_pk_bf16_f32 v228, v36, v37
    v_mfma_f32_16x16x32_bf16 v[48:51], a[0:3], a[48:51], v[48:51]
    v_cvt_pk_bf16_f32 v229, v38, v39
    v_mfma_f32_16x16x32_bf16 v[52:55], a[0:3], a[52:55], v[52:55]
    s_nop 1
    v_cvt_pk_bf16_f32 v232, v44, v45
    v_cvt_pk_bf16_f32 v233, v46, v47
    v_mfma_f32_16x16x32_bf16 v[56:59], a[0:3], a[56:59], v[56:59]
    s_waitcnt lgkmcnt(14)
    v_mfma_f32_16x16x32_bf16 v[60:63], a[4:7], a[36:39], v[60:63]
    v_mfma_f32_16x16x32_bf16 v[64:67], a[4:7], a[40:43], v[64:67]
    s_nop 4
    v_cvt_pk_bf16_f32 v236, v56, v57
    v_cvt_pk_bf16_f32 v237, v58, v59
    v_mfma_f32_16x16x32_bf16 v[68:71], a[4:7], a[44:47], v[68:71]
    v_cvt_pk_bf16_f32 v230, v60, v61
    v_cvt_pk_bf16_f32 v231, v62, v63
    v_mfma_f32_16x16x32_bf16 v[72:75], a[4:7], a[48:51], v[72:75]
    buffer_store_dwordx4 v[228:231], v26, s[32:35], s78 offen offset:0 sc1
    v_mfma_f32_16x16x32_bf16 v[76:79], a[4:7], a[52:55], v[76:79]
    s_nop 2
    v_cvt_pk_bf16_f32 v234, v68, v69
    v_cvt_pk_bf16_f32 v235, v70, v71
    v_mfma_f32_16x16x32_bf16 v[80:83], a[4:7], a[56:59], v[80:83]
    buffer_store_dwordx4 v[232:235], v26, s[32:35], s80 offen offset:2048 sc1
    s_waitcnt lgkmcnt(12)
    v_mfma_f32_16x16x32_bf16 v[84:87], a[8:11], a[36:39], v[84:87]
    v_cvt_pk_bf16_f32 v240, v64, v65
    v_cvt_pk_bf16_f32 v241, v66, v67
    v_mfma_f32_16x16x32_bf16 v[88:91], a[8:11], a[40:43], v[88:91]
    s_nop 1
    v_cvt_pk_bf16_f32 v238, v80, v81
    v_cvt_pk_bf16_f32 v239, v82, v83
    v_mfma_f32_16x16x32_bf16 v[92:95], a[8:11], a[44:47], v[92:95]
    buffer_store_dwordx4 v[236:239], v26, s[32:35], s82 offen offset:2048 sc1
    v_mfma_f32_16x16x32_bf16 v[96:99], a[8:11], a[48:51], v[96:99]
    s_nop 0
    v_cvt_pk_bf16_f32 v242, v88, v89
    v_cvt_pk_bf16_f32 v243, v90, v91
    v_mfma_f32_16x16x32_bf16 v[100:103], a[8:11], a[52:55], v[100:103]
    buffer_store_dwordx4 v[240:243], v26, s[32:35], s79 offen offset:1024 sc1
    v_mfma_f32_16x16x32_bf16 v[104:107], a[8:11], a[56:59], v[104:107]
    v_cvt_pk_bf16_f32 v228, v84, v85
    v_cvt_pk_bf16_f32 v229, v86, v87
    s_waitcnt lgkmcnt(10)
    v_mfma_f32_16x16x32_bf16 v[108:111], a[12:15], a[36:39], v[108:111]
    v_cvt_pk_bf16_f32 v232, v92, v93
    v_cvt_pk_bf16_f32 v233, v94, v95
    v_mfma_f32_16x16x32_bf16 v[112:115], a[12:15], a[40:43], v[112:115]
    s_nop 0
    v_cvt_pk_bf16_f32 v236, v104, v105
    v_cvt_pk_bf16_f32 v237, v106, v107
    v_mfma_f32_16x16x32_bf16 v[116:119], a[12:15], a[44:47], v[116:119]
    s_nop 0
    v_cvt_pk_bf16_f32 v230, v108, v109
    v_cvt_pk_bf16_f32 v231, v110, v111
    v_mfma_f32_16x16x32_bf16 v[120:123], a[12:15], a[48:51], v[120:123]
    buffer_store_dwordx4 v[228:231], v26, s[32:35], s78 offen offset:1024 sc1
    v_mfma_f32_16x16x32_bf16 v[124:127], a[12:15], a[52:55], v[124:127]
    s_nop 1
    v_cvt_pk_bf16_f32 v234, v116, v117
    v_cvt_pk_bf16_f32 v235, v118, v119
    v_mfma_f32_16x16x32_bf16 v[128:131], a[12:15], a[56:59], v[128:131]
    buffer_store_dwordx4 v[232:235], v26, s[32:35], s80 offen offset:3072 sc1
    s_waitcnt lgkmcnt(8)
    v_mfma_f32_16x16x32_bf16 v[132:135], a[16:19], a[36:39], v[132:135]
    v_cvt_pk_bf16_f32 v240, v112, v113
    v_cvt_pk_bf16_f32 v241, v114, v115
    v_mfma_f32_16x16x32_bf16 v[136:139], a[16:19], a[40:43], v[136:139]
    s_nop 1
    v_cvt_pk_bf16_f32 v238, v128, v129
    v_cvt_pk_bf16_f32 v239, v130, v131
    v_mfma_f32_16x16x32_bf16 v[140:143], a[16:19], a[44:47], v[140:143]
    buffer_store_dwordx4 v[236:239], v26, s[32:35], s82 offen offset:3072 sc1
    v_mfma_f32_16x16x32_bf16 v[144:147], a[16:19], a[48:51], v[144:147]
    s_nop 0
    v_cvt_pk_bf16_f32 v242, v136, v137
    v_cvt_pk_bf16_f32 v243, v138, v139
    v_mfma_f32_16x16x32_bf16 v[148:151], a[16:19], a[52:55], v[148:151]
    buffer_store_dwordx4 v[240:243], v26, s[32:35], s79 offen offset:2048 sc1
    v_mfma_f32_16x16x32_bf16 v[152:155], a[16:19], a[56:59], v[152:155]
    v_cvt_pk_bf16_f32 v228, v132, v133
    v_cvt_pk_bf16_f32 v229, v134, v135
    s_waitcnt lgkmcnt(6)
    v_mfma_f32_16x16x32_bf16 v[156:159], a[20:23], a[36:39], v[156:159]
    v_cvt_pk_bf16_f32 v232, v140, v141
    v_cvt_pk_bf16_f32 v233, v142, v143
    v_mfma_f32_16x16x32_bf16 v[160:163], a[20:23], a[40:43], v[160:163]
    s_nop 0
    v_cvt_pk_bf16_f32 v236, v152, v153
    v_cvt_pk_bf16_f32 v237, v154, v155
    v_mfma_f32_16x16x32_bf16 v[164:167], a[20:23], a[44:47], v[164:167]
    s_nop 0
    v_cvt_pk_bf16_f32 v230, v156, v157
    v_cvt_pk_bf16_f32 v231, v158, v159
    v_mfma_f32_16x16x32_bf16 v[168:171], a[20:23], a[48:51], v[168:171]
    buffer_store_dwordx4 v[228:231], v26, s[32:35], s78 offen offset:2048 sc1
    v_mfma_f32_16x16x32_bf16 v[172:175], a[20:23], a[52:55], v[172:175]
    s_nop 1
    v_cvt_pk_bf16_f32 v234, v164, v165
    v_cvt_pk_bf16_f32 v235, v166, v167
    v_mfma_f32_16x16x32_bf16 v[176:179], a[20:23], a[56:59], v[176:179]
    buffer_store_dwordx4 v[232:235], v26, s[32:35], s81 offen offset:0 sc1
    s_waitcnt lgkmcnt(4)
    v_mfma_f32_16x16x32_bf16 v[180:183], a[24:27], a[36:39], v[180:183]
    v_cvt_pk_bf16_f32 v240, v160, v161
    v_cvt_pk_bf16_f32 v241, v162, v163
    v_mfma_f32_16x16x32_bf16 v[184:187], a[24:27], a[40:43], v[184:187]
    s_nop 1
    v_cvt_pk_bf16_f32 v238, v176, v177
    v_cvt_pk_bf16_f32 v239, v178, v179
    v_mfma_f32_16x16x32_bf16 v[188:191], a[24:27], a[44:47], v[188:191]
    buffer_store_dwordx4 v[236:239], v26, s[32:35], s83 offen offset:0 sc1
    v_mfma_f32_16x16x32_bf16 v[192:195], a[24:27], a[48:51], v[192:195]
    s_nop 0
    v_cvt_pk_bf16_f32 v242, v184, v185
    v_cvt_pk_bf16_f32 v243, v186, v187
    v_mfma_f32_16x16x32_bf16 v[196:199], a[24:27], a[52:55], v[196:199]
    buffer_store_dwordx4 v[240:243], v26, s[32:35], s80 offen offset:0 sc1
    v_mfma_f32_16x16x32_bf16 v[200:203], a[24:27], a[56:59], v[200:203]
    v_cvt_pk_bf16_f32 v228, v172, v173
    v_cvt_pk_bf16_f32 v229, v174, v175
    s_waitcnt lgkmcnt(2)
    v_mfma_f32_16x16x32_bf16 v[204:207], a[28:31], a[36:39], v[204:207]
    s_nop 1
    v_cvt_pk_bf16_f32 v230, v196, v197
    v_cvt_pk_bf16_f32 v231, v198, v199
    v_mfma_f32_16x16x32_bf16 v[208:211], a[28:31], a[40:43], v[208:211]
    buffer_store_dwordx4 v[228:231], v26, s[32:35], s82 offen offset:0 sc1
    v_mfma_f32_16x16x32_bf16 v[212:215], a[28:31], a[44:47], v[212:215]
    v_cvt_pk_bf16_f32 v232, v180, v181
    v_cvt_pk_bf16_f32 v233, v182, v183
    v_mfma_f32_16x16x32_bf16 v[216:219], a[28:31], a[48:51], v[216:219]
    v_cvt_pk_bf16_f32 v234, v204, v205
    v_cvt_pk_bf16_f32 v235, v206, v207
    v_mfma_f32_16x16x32_bf16 v[220:223], a[28:31], a[52:55], v[220:223]
    buffer_store_dwordx4 v[232:235], v26, s[32:35], s78 offen offset:3072 sc1
    v_mfma_f32_16x16x32_bf16 v[224:227], a[28:31], a[56:59], v[224:227]
    v_cvt_pk_bf16_f32 v236, v188, v189
    v_cvt_pk_bf16_f32 v237, v190, v191
    s_waitcnt lgkmcnt(0)
    v_mfma_f32_16x16x32_bf16 a[60:63], a[32:35], a[36:39], a[60:63]
    v_cvt_pk_bf16_f32 v238, v212, v213
    v_cvt_pk_bf16_f32 v239, v214, v215
    v_mfma_f32_16x16x32_bf16 a[64:67], a[32:35], a[40:43], a[64:67]
    buffer_store_dwordx4 v[236:239], v26, s[32:35], s81 offen offset:1024 sc1
    v_mfma_f32_16x16x32_bf16 a[68:71], a[32:35], a[44:47], a[68:71]
    v_cvt_pk_bf16_f32 v240, v200, v201
    v_cvt_pk_bf16_f32 v241, v202, v203
    v_mfma_f32_16x16x32_bf16 a[72:75], a[32:35], a[48:51], a[72:75]
    v_cvt_pk_bf16_f32 v242, v224, v225
    v_cvt_pk_bf16_f32 v243, v226, v227
    v_mfma_f32_16x16x32_bf16 a[76:79], a[32:35], a[52:55], a[76:79]
    buffer_store_dwordx4 v[240:243], v26, s[32:35], s83 offen offset:1024 sc1
    v_mfma_f32_16x16x32_bf16 a[80:83], a[32:35], a[56:59], a[80:83]
    v_accvgpr_read_b32 v244, a60
    v_accvgpr_read_b32 v245, a61
    v_accvgpr_read_b32 v246, a62
    v_accvgpr_read_b32 v247, a63
    v_cvt_pk_bf16_f32 v228, v244, v245
    v_cvt_pk_bf16_f32 v229, v246, v247
    v_cvt_pk_bf16_f32 v230, v40, v41
    v_cvt_pk_bf16_f32 v231, v42, v43
    buffer_store_dwordx4 v[228:231], v26, s[32:35], s79 offen offset:0 sc1
    v_cvt_pk_bf16_f32 v232, v208, v209
    v_cvt_pk_bf16_f32 v233, v210, v211
    v_accvgpr_read_b32 v248, a64
    v_accvgpr_read_b32 v249, a65
    v_accvgpr_read_b32 v250, a66
    v_accvgpr_read_b32 v251, a67
    v_cvt_pk_bf16_f32 v234, v248, v249
    v_cvt_pk_bf16_f32 v235, v250, v251
    buffer_store_dwordx4 v[232:235], v26, s[32:35], s80 offen offset:1024 sc1
    v_accvgpr_read_b32 v252, a68
    v_accvgpr_read_b32 v253, a69
    v_accvgpr_read_b32 v254, a70
    v_accvgpr_read_b32 v255, a71
    v_cvt_pk_bf16_f32 v236, v252, v253
    v_cvt_pk_bf16_f32 v237, v254, v255
    buffer_store_dwordx4 v[236:239], v26, s[32:35], s81 offen offset:2048 sc1
    v_cvt_pk_bf16_f32 v240, v220, v221
    v_cvt_pk_bf16_f32 v241, v222, v223
    v_accvgpr_read_b32 v244, a76
    v_accvgpr_read_b32 v245, a77
    v_accvgpr_read_b32 v246, a78
    v_accvgpr_read_b32 v247, a79
    v_cvt_pk_bf16_f32 v242, v244, v245
    v_cvt_pk_bf16_f32 v243, v246, v247
    buffer_store_dwordx4 v[240:243], v26, s[32:35], s82 offen offset:1024 sc1
    v_accvgpr_read_b32 v248, a80
    v_accvgpr_read_b32 v249, a81
    v_accvgpr_read_b32 v250, a82
    v_accvgpr_read_b32 v251, a83
    v_cvt_pk_bf16_f32 v228, v248, v249
    v_cvt_pk_bf16_f32 v229, v250, v251
    buffer_store_dwordx4 v[228:231], v26, s[32:35], s83 offen offset:2048 sc1
    s_lshl_b32 s55, s36, 7
    s_add_u32 s55, s55, 458760
    v_lshlrev_b32 v1, 9, v0
    v_mov_b32 v2, 1
    v_mov_b32 v3, 1016
    s_mov_b64 s[82:83], exec
    s_waitcnt vmcnt(0)
    s_mov_b64 exec, 11
    buffer_store_dword v2, v1, s[32:35], s55 offen sc1
    s_mov_b64 exec, 1
L_poll2:
    buffer_load_dwordx4 v[228:231], v3, s[32:35], s55 offen sc1
    s_waitcnt vmcnt(0)
    v_and_b32 v228, v228, v229
    v_and_b32 v228, v228, v231
    s_nop 0
    v_readfirstlane_b32 s56, v228
    s_nop 0
    s_cmp_eq_u32 s56, 1
    s_cbranch_scc1 L_poll_done2
    s_sleep 1
    s_branch L_poll2
L_poll_done2:
    s_mov_b64 exec, s[82:83]
    s_mul_i32 s55, s36, 7168
    s_add_u32 s56, s55, 229376
    buffer_load_dwordx4 v[36:39], v26, s[32:35], s56 offen offset:0 sc1
    s_add_u32 s57, s55, 258048
    buffer_load_dwordx4 v[80:83], v26, s[32:35], s57 offen offset:0 sc1
    s_add_u32 s58, s55, 315392
    buffer_load_dwordx4 v[116:119], v26, s[32:35], s58 offen offset:0 sc1
    buffer_load_dwordx4 v[40:43], v26, s[32:35], s56 offen offset:1024 sc1
    buffer_load_dwordx4 v[84:87], v26, s[32:35], s57 offen offset:1024 sc1
    buffer_load_dwordx4 v[128:131], v26, s[32:35], s58 offen offset:1024 sc1
    buffer_load_dwordx4 v[44:47], v26, s[32:35], s56 offen offset:2048 sc1
    buffer_load_dwordx4 v[88:91], v26, s[32:35], s57 offen offset:2048 sc1
    buffer_load_dwordx4 v[132:135], v26, s[32:35], s58 offen offset:2048 sc1
    buffer_load_dwordx4 v[56:59], v26, s[32:35], s56 offen offset:3072 sc1
    buffer_load_dwordx4 v[92:95], v26, s[32:35], s57 offen offset:3072 sc1
    buffer_load_dwordx4 v[136:139], v26, s[32:35], s58 offen offset:3072 sc1
    s_add_u32 s56, s55, 233472
    buffer_load_dwordx4 v[60:63], v26, s[32:35], s56 offen offset:0 sc1
    s_add_u32 s57, s55, 262144
    buffer_load_dwordx4 v[104:107], v26, s[32:35], s57 offen offset:0 sc1
    s_add_u32 s58, s55, 319488
    buffer_load_dwordx4 v[140:143], v26, s[32:35], s58 offen offset:0 sc1
    buffer_load_dwordx4 v[64:67], v26, s[32:35], s56 offen offset:1024 sc1
    buffer_load_dwordx4 v[108:111], v26, s[32:35], s57 offen offset:1024 sc1
    buffer_load_dwordx4 v[152:155], v26, s[32:35], s58 offen offset:1024 sc1
    buffer_load_dwordx4 v[68:71], v26, s[32:35], s56 offen offset:2048 sc1
    buffer_load_dwordx4 v[112:115], v26, s[32:35], s57 offen offset:2048 sc1
    buffer_load_dwordx4 v[156:159], v26, s[32:35], s58 offen offset:2048 sc1
    v_and_b32 v1, 15, v0
    v_mul_u32_u24 v1, 2304, v1
    v_lshrrev_b32 v2, 4, v0
    v_lshl_add_u32 v1, v2, 3, v1
    s_mul_i32 s55, s36, 288
    s_mov_b32 s59, 0xffff0000
    v_accvgpr_read_b32 v160, a72
    v_accvgpr_read_b32 v161, a73
    v_accvgpr_read_b32 v162, a74
    v_accvgpr_read_b32 v163, a75
    s_waitcnt vmcnt(18)
    v_lshlrev_b32 v228, 16, v36
    v_and_b32 v229, s59, v36
    v_lshlrev_b32 v230, 16, v37
    v_and_b32 v231, s59, v37
    v_pk_add_f32 v[48:49], v[48:49], v[228:229]
    v_pk_add_f32 v[50:51], v[50:51], v[230:231]
    v_lshlrev_b32 v232, 16, v80
    v_and_b32 v233, s59, v80
    v_lshlrev_b32 v234, 16, v81
    v_and_b32 v235, s59, v81
    v_pk_add_f32 v[48:49], v[48:49], v[232:233]
    v_pk_add_f32 v[50:51], v[50:51], v[234:235]
    v_lshlrev_b32 v236, 16, v116
    v_and_b32 v237, s59, v116
    v_lshlrev_b32 v238, 16, v117
    v_and_b32 v239, s59, v117
    v_pk_add_f32 v[48:49], v[48:49], v[236:237]
    v_pk_add_f32 v[50:51], v[50:51], v[238:239]
    v_cvt_pk_bf16_f32 v48, v48, v49
    v_cvt_pk_bf16_f32 v49, v50, v51
    s_add_u32 s56, s55, 110592
    buffer_store_dwordx2 v[48:49], v1, s[24:27], s56 offen offset:0
    v_lshlrev_b32 v240, 16, v38
    v_and_b32 v241, s59, v38
    v_lshlrev_b32 v242, 16, v39
    v_and_b32 v243, s59, v39
    v_pk_add_f32 v[72:73], v[72:73], v[240:241]
    v_pk_add_f32 v[74:75], v[74:75], v[242:243]
    v_lshlrev_b32 v244, 16, v82
    v_and_b32 v245, s59, v82
    v_lshlrev_b32 v246, 16, v83
    v_and_b32 v247, s59, v83
    v_pk_add_f32 v[72:73], v[72:73], v[244:245]
    v_pk_add_f32 v[74:75], v[74:75], v[246:247]
    v_lshlrev_b32 v248, 16, v118
    v_and_b32 v249, s59, v118
    v_lshlrev_b32 v250, 16, v119
    v_and_b32 v251, s59, v119
    v_pk_add_f32 v[72:73], v[72:73], v[248:249]
    v_pk_add_f32 v[74:75], v[74:75], v[250:251]
    v_cvt_pk_bf16_f32 v72, v72, v73
    v_cvt_pk_bf16_f32 v73, v74, v75
    s_add_u32 s57, s55, 110592
    buffer_store_dwordx2 v[72:73], v1, s[24:27], s57 offen offset:32
    s_waitcnt vmcnt(17)
    v_lshlrev_b32 v228, 16, v40
    v_and_b32 v229, s59, v40
    v_lshlrev_b32 v230, 16, v41
    v_and_b32 v231, s59, v41
    v_pk_add_f32 v[96:97], v[96:97], v[228:229]
    v_pk_add_f32 v[98:99], v[98:99], v[230:231]
    v_lshlrev_b32 v232, 16, v84
    v_and_b32 v233, s59, v84
    v_lshlrev_b32 v234, 16, v85
    v_and_b32 v235, s59, v85
    v_pk_add_f32 v[96:97], v[96:97], v[232:233]
    v_pk_add_f32 v[98:99], v[98:99], v[234:235]
    v_lshlrev_b32 v236, 16, v128
    v_and_b32 v237, s59, v128
    v_lshlrev_b32 v238, 16, v129
    v_and_b32 v239, s59, v129
    v_pk_add_f32 v[96:97], v[96:97], v[236:237]
    v_pk_add_f32 v[98:99], v[98:99], v[238:239]
    v_cvt_pk_bf16_f32 v96, v96, v97
    v_cvt_pk_bf16_f32 v97, v98, v99
    s_add_u32 s56, s55, 110592
    buffer_store_dwordx2 v[96:97], v1, s[24:27], s56 offen offset:64
    v_lshlrev_b32 v240, 16, v42
    v_and_b32 v241, s59, v42
    v_lshlrev_b32 v242, 16, v43
    v_and_b32 v243, s59, v43
    v_pk_add_f32 v[120:121], v[120:121], v[240:241]
    v_pk_add_f32 v[122:123], v[122:123], v[242:243]
    v_lshlrev_b32 v244, 16, v86
    v_and_b32 v245, s59, v86
    v_lshlrev_b32 v246, 16, v87
    v_and_b32 v247, s59, v87
    v_pk_add_f32 v[120:121], v[120:121], v[244:245]
    v_pk_add_f32 v[122:123], v[122:123], v[246:247]
    v_lshlrev_b32 v248, 16, v130
    v_and_b32 v249, s59, v130
    v_lshlrev_b32 v250, 16, v131
    v_and_b32 v251, s59, v131
    v_pk_add_f32 v[120:121], v[120:121], v[248:249]
    v_pk_add_f32 v[122:123], v[122:123], v[250:251]
    v_cvt_pk_bf16_f32 v120, v120, v121
    v_cvt_pk_bf16_f32 v121, v122, v123
    s_add_u32 s57, s55, 110592
    buffer_store_dwordx2 v[120:121], v1, s[24:27], s57 offen offset:96
    s_waitcnt vmcnt(16)
    v_lshlrev_b32 v228, 16, v44
    v_and_b32 v229, s59, v44
    v_lshlrev_b32 v230, 16, v45
    v_and_b32 v231, s59, v45
    v_pk_add_f32 v[144:145], v[144:145], v[228:229]
    v_pk_add_f32 v[146:147], v[146:147], v[230:231]
    v_lshlrev_b32 v232, 16, v88
    v_and_b32 v233, s59, v88
    v_lshlrev_b32 v234, 16, v89
    v_and_b32 v235, s59, v89
    v_pk_add_f32 v[144:145], v[144:145], v[232:233]
    v_pk_add_f32 v[146:147], v[146:147], v[234:235]
    v_lshlrev_b32 v236, 16, v132
    v_and_b32 v237, s59, v132
    v_lshlrev_b32 v238, 16, v133
    v_and_b32 v239, s59, v133
    v_pk_add_f32 v[144:145], v[144:145], v[236:237]
    v_pk_add_f32 v[146:147], v[146:147], v[238:239]
    v_cvt_pk_bf16_f32 v144, v144, v145
    v_cvt_pk_bf16_f32 v145, v146, v147
    s_add_u32 s56, s55, 110592
    buffer_store_dwordx2 v[144:145], v1, s[24:27], s56 offen offset:128
    v_lshlrev_b32 v240, 16, v46
    v_and_b32 v241, s59, v46
    v_lshlrev_b32 v242, 16, v47
    v_and_b32 v243, s59, v47
    v_pk_add_f32 v[168:169], v[168:169], v[240:241]
    v_pk_add_f32 v[170:171], v[170:171], v[242:243]
    v_lshlrev_b32 v244, 16, v90
    v_and_b32 v245, s59, v90
    v_lshlrev_b32 v246, 16, v91
    v_and_b32 v247, s59, v91
    v_pk_add_f32 v[168:169], v[168:169], v[244:245]
    v_pk_add_f32 v[170:171], v[170:171], v[246:247]
    v_lshlrev_b32 v248, 16, v134
    v_and_b32 v249, s59, v134
    v_lshlrev_b32 v250, 16, v135
    v_and_b32 v251, s59, v135
    v_pk_add_f32 v[168:169], v[168:169], v[248:249]
    v_pk_add_f32 v[170:171], v[170:171], v[250:251]
    v_cvt_pk_bf16_f32 v168, v168, v169
    v_cvt_pk_bf16_f32 v169, v170, v171
    s_add_u32 s57, s55, 110592
    buffer_store_dwordx2 v[168:169], v1, s[24:27], s57 offen offset:160
    s_waitcnt vmcnt(15)
    v_lshlrev_b32 v228, 16, v56
    v_and_b32 v229, s59, v56
    v_lshlrev_b32 v230, 16, v57
    v_and_b32 v231, s59, v57
    v_pk_add_f32 v[192:193], v[192:193], v[228:229]
    v_pk_add_f32 v[194:195], v[194:195], v[230:231]
    v_lshlrev_b32 v232, 16, v92
    v_and_b32 v233, s59, v92
    v_lshlrev_b32 v234, 16, v93
    v_and_b32 v235, s59, v93
    v_pk_add_f32 v[192:193], v[192:193], v[232:233]
    v_pk_add_f32 v[194:195], v[194:195], v[234:235]
    v_lshlrev_b32 v236, 16, v136
    v_and_b32 v237, s59, v136
    v_lshlrev_b32 v238, 16, v137
    v_and_b32 v239, s59, v137
    v_pk_add_f32 v[192:193], v[192:193], v[236:237]
    v_pk_add_f32 v[194:195], v[194:195], v[238:239]
    v_cvt_pk_bf16_f32 v192, v192, v193
    v_cvt_pk_bf16_f32 v193, v194, v195
    s_add_u32 s56, s55, 110592
    buffer_store_dwordx2 v[192:193], v1, s[24:27], s56 offen offset:192
    v_lshlrev_b32 v240, 16, v58
    v_and_b32 v241, s59, v58
    v_lshlrev_b32 v242, 16, v59
    v_and_b32 v243, s59, v59
    v_pk_add_f32 v[216:217], v[216:217], v[240:241]
    v_pk_add_f32 v[218:219], v[218:219], v[242:243]
    v_lshlrev_b32 v244, 16, v94
    v_and_b32 v245, s59, v94
    v_lshlrev_b32 v246, 16, v95
    v_and_b32 v247, s59, v95
    v_pk_add_f32 v[216:217], v[216:217], v[244:245]
    v_pk_add_f32 v[218:219], v[218:219], v[246:247]
    v_lshlrev_b32 v248, 16, v138
    v_and_b32 v249, s59, v138
    v_lshlrev_b32 v250, 16, v139
    v_and_b32 v251, s59, v139
    v_pk_add_f32 v[216:217], v[216:217], v[248:249]
    v_pk_add_f32 v[218:219], v[218:219], v[250:251]
    v_cvt_pk_bf16_f32 v216, v216, v217
    v_cvt_pk_bf16_f32 v217, v218, v219
    s_add_u32 s57, s55, 110592
    buffer_store_dwordx2 v[216:217], v1, s[24:27], s57 offen offset:224
    s_waitcnt vmcnt(14)
    v_lshlrev_b32 v228, 16, v60
    v_and_b32 v229, s59, v60
    v_lshlrev_b32 v230, 16, v61
    v_and_b32 v231, s59, v61
    v_pk_add_f32 v[160:161], v[160:161], v[228:229]
    v_pk_add_f32 v[162:163], v[162:163], v[230:231]
    v_lshlrev_b32 v232, 16, v104
    v_and_b32 v233, s59, v104
    v_lshlrev_b32 v234, 16, v105
    v_and_b32 v235, s59, v105
    v_pk_add_f32 v[160:161], v[160:161], v[232:233]
    v_pk_add_f32 v[162:163], v[162:163], v[234:235]
    v_lshlrev_b32 v236, 16, v140
    v_and_b32 v237, s59, v140
    v_lshlrev_b32 v238, 16, v141
    v_and_b32 v239, s59, v141
    v_pk_add_f32 v[160:161], v[160:161], v[236:237]
    v_pk_add_f32 v[162:163], v[162:163], v[238:239]
    v_cvt_pk_bf16_f32 v160, v160, v161
    v_cvt_pk_bf16_f32 v161, v162, v163
    s_add_u32 s56, s55, 110592
    buffer_store_dwordx2 v[160:161], v1, s[24:27], s56 offen offset:256
    v_lshlrev_b32 v240, 16, v62
    v_and_b32 v241, s59, v62
    v_lshlrev_b32 v242, 16, v63
    v_and_b32 v243, s59, v63
    v_pk_add_f32 v[52:53], v[52:53], v[240:241]
    v_pk_add_f32 v[54:55], v[54:55], v[242:243]
    v_lshlrev_b32 v244, 16, v106
    v_and_b32 v245, s59, v106
    v_lshlrev_b32 v246, 16, v107
    v_and_b32 v247, s59, v107
    v_pk_add_f32 v[52:53], v[52:53], v[244:245]
    v_pk_add_f32 v[54:55], v[54:55], v[246:247]
    v_lshlrev_b32 v248, 16, v142
    v_and_b32 v249, s59, v142
    v_lshlrev_b32 v250, 16, v143
    v_and_b32 v251, s59, v143
    v_pk_add_f32 v[52:53], v[52:53], v[248:249]
    v_pk_add_f32 v[54:55], v[54:55], v[250:251]
    v_cvt_pk_bf16_f32 v52, v52, v53
    v_cvt_pk_bf16_f32 v53, v54, v55
    s_add_u32 s57, s55, 147456
    buffer_store_dwordx2 v[52:53], v1, s[24:27], s57 offen offset:0
    s_waitcnt vmcnt(13)
    v_lshlrev_b32 v228, 16, v64
    v_and_b32 v229, s59, v64
    v_lshlrev_b32 v230, 16, v65
    v_and_b32 v231, s59, v65
    v_pk_add_f32 v[76:77], v[76:77], v[228:229]
    v_pk_add_f32 v[78:79], v[78:79], v[230:231]
    v_lshlrev_b32 v232, 16, v108
    v_and_b32 v233, s59, v108
    v_lshlrev_b32 v234, 16, v109
    v_and_b32 v235, s59, v109
    v_pk_add_f32 v[76:77], v[76:77], v[232:233]
    v_pk_add_f32 v[78:79], v[78:79], v[234:235]
    v_lshlrev_b32 v236, 16, v152
    v_and_b32 v237, s59, v152
    v_lshlrev_b32 v238, 16, v153
    v_and_b32 v239, s59, v153
    v_pk_add_f32 v[76:77], v[76:77], v[236:237]
    v_pk_add_f32 v[78:79], v[78:79], v[238:239]
    v_cvt_pk_bf16_f32 v76, v76, v77
    v_cvt_pk_bf16_f32 v77, v78, v79
    s_add_u32 s56, s55, 147456
    buffer_store_dwordx2 v[76:77], v1, s[24:27], s56 offen offset:32
    v_lshlrev_b32 v240, 16, v66
    v_and_b32 v241, s59, v66
    v_lshlrev_b32 v242, 16, v67
    v_and_b32 v243, s59, v67
    v_pk_add_f32 v[100:101], v[100:101], v[240:241]
    v_pk_add_f32 v[102:103], v[102:103], v[242:243]
    v_lshlrev_b32 v244, 16, v110
    v_and_b32 v245, s59, v110
    v_lshlrev_b32 v246, 16, v111
    v_and_b32 v247, s59, v111
    v_pk_add_f32 v[100:101], v[100:101], v[244:245]
    v_pk_add_f32 v[102:103], v[102:103], v[246:247]
    v_lshlrev_b32 v248, 16, v154
    v_and_b32 v249, s59, v154
    v_lshlrev_b32 v250, 16, v155
    v_and_b32 v251, s59, v155
    v_pk_add_f32 v[100:101], v[100:101], v[248:249]
    v_pk_add_f32 v[102:103], v[102:103], v[250:251]
    v_cvt_pk_bf16_f32 v100, v100, v101
    v_cvt_pk_bf16_f32 v101, v102, v103
    s_add_u32 s57, s55, 147456
    buffer_store_dwordx2 v[100:101], v1, s[24:27], s57 offen offset:64
    s_waitcnt vmcnt(12)
    v_lshlrev_b32 v228, 16, v68
    v_and_b32 v229, s59, v68
    v_lshlrev_b32 v230, 16, v69
    v_and_b32 v231, s59, v69
    v_pk_add_f32 v[124:125], v[124:125], v[228:229]
    v_pk_add_f32 v[126:127], v[126:127], v[230:231]
    v_lshlrev_b32 v232, 16, v112
    v_and_b32 v233, s59, v112
    v_lshlrev_b32 v234, 16, v113
    v_and_b32 v235, s59, v113
    v_pk_add_f32 v[124:125], v[124:125], v[232:233]
    v_pk_add_f32 v[126:127], v[126:127], v[234:235]
    v_lshlrev_b32 v236, 16, v156
    v_and_b32 v237, s59, v156
    v_lshlrev_b32 v238, 16, v157
    v_and_b32 v239, s59, v157
    v_pk_add_f32 v[124:125], v[124:125], v[236:237]
    v_pk_add_f32 v[126:127], v[126:127], v[238:239]
    v_cvt_pk_bf16_f32 v124, v124, v125
    v_cvt_pk_bf16_f32 v125, v126, v127
    s_add_u32 s56, s55, 147456
    buffer_store_dwordx2 v[124:125], v1, s[24:27], s56 offen offset:96
    v_lshlrev_b32 v240, 16, v70
    v_and_b32 v241, s59, v70
    v_lshlrev_b32 v242, 16, v71
    v_and_b32 v243, s59, v71
    v_pk_add_f32 v[148:149], v[148:149], v[240:241]
    v_pk_add_f32 v[150:151], v[150:151], v[242:243]
    v_lshlrev_b32 v244, 16, v114
    v_and_b32 v245, s59, v114
    v_lshlrev_b32 v246, 16, v115
    v_and_b32 v247, s59, v115
    v_pk_add_f32 v[148:149], v[148:149], v[244:245]
    v_pk_add_f32 v[150:151], v[150:151], v[246:247]
    v_lshlrev_b32 v248, 16, v158
    v_and_b32 v249, s59, v158
    v_lshlrev_b32 v250, 16, v159
    v_and_b32 v251, s59, v159
    v_pk_add_f32 v[148:149], v[148:149], v[248:249]
    v_pk_add_f32 v[150:151], v[150:151], v[250:251]
    v_cvt_pk_bf16_f32 v148, v148, v149
    v_cvt_pk_bf16_f32 v149, v150, v151
    s_add_u32 s57, s55, 147456
    buffer_store_dwordx2 v[148:149], v1, s[24:27], s57 offen offset:128
    s_endpgm
L_var3:
    s_mul_i32 s55, s36, 7168
    s_add_u32 s78, s55, 86016
    s_waitcnt lgkmcnt(15)
    v_mfma_f32_16x16x32_bf16 v[36:39], a[0:3], a[36:39], v[36:39]
    s_add_u32 s79, s55, 90112
    s_add_u32 s80, s55, 200704
    v_mfma_f32_16x16x32_bf16 v[40:43], a[0:3], a[40:43], v[40:43]
    s_add_u32 s81, s55, 204800
    s_add_u32 s82, s55, 315392
    v_mfma_f32_16x16x32_bf16 v[44:47], a[0:3], a[44:47], v[44:47]
    s_add_u32 s83, s55, 319488
    s_nop 0
    v_cvt_pk_bf16_f32 v228, v36, v37
    v_mfma_f32_16x16x32_bf16 v[48:51], a[0:3], a[48:51], v[48:51]
    v_cvt_pk_bf16_f32 v229, v38, v39
    v_mfma_f32_16x16x32_bf16 v[52:55], a[0:3], a[52:55], v[52:55]
    s_nop 1
    v_cvt_pk_bf16_f32 v232, v44, v45
    v_cvt_pk_bf16_f32 v233, v46, v47
    v_mfma_f32_16x16x32_bf16 v[56:59], a[0:3], a[56:59], v[56:59]
    s_nop 0
    v_cvt_pk_bf16_f32 v236, v48, v49
    v_cvt_pk_bf16_f32 v237, v50, v51
    s_waitcnt lgkmcnt(14)
    v_mfma_f32_16x16x32_bf16 v[60:63], a[4:7], a[36:39], v[60:63]
    v_mfma_f32_16x16x32_bf16 v[64:67], a[4:7], a[40:43], v[64:67]
    v_mfma_f32_16x16x32_bf16 v[68:71], a[4:7], a[44:47], v[68:71]
    s_nop 5
    v_cvt_pk_bf16_f32 v230, v60, v61
    v_cvt_pk_bf16_f32 v231, v62, v63
    v_mfma_f32_16x16x32_bf16 v[72:75], a[4:7], a[48:51], v[72:75]
    buffer_store_dwordx4 v[228:231], v26, s[32:35], s78 offen offset:0 sc1
    v_mfma_f32_16x16x32_bf16 v[76:79], a[4:7], a[52:55], v[76:79]
    v_cvt_pk_bf16_f32 v234, v68, v69
    v_cvt_pk_bf16_f32 v235, v70, v71
    v_mfma_f32_16x16x32_bf16 v[80:83], a[4:7], a[56:59], v[80:83]
    buffer_store_dwordx4 v[232:235], v26, s[32:35], s80 offen offset:2048 sc1
    s_waitcnt lgkmcnt(12)
    v_mfma_f32_16x16x32_bf16 v[84:87], a[8:11], a[36:39], v[84:87]
    v_cvt_pk_bf16_f32 v238, v72, v73
    v_cvt_pk_bf16_f32 v239, v74, v75
    v_mfma_f32_16x16x32_bf16 v[88:91], a[8:11], a[40:43], v[88:91]
    buffer_store_dwordx4 v[236:239], v26, s[32:35], s82 offen offset:0 sc1
    v_mfma_f32_16x16x32_bf16 v[92:95], a[8:11], a[44:47], v[92:95]
    v_cvt_pk_bf16_f32 v240, v64, v65
    v_cvt_pk_bf16_f32 v241, v66, v67
    v_mfma_f32_16x16x32_bf16 v[96:99], a[8:11], a[48:51], v[96:99]
    s_nop 2
    v_cvt_pk_bf16_f32 v242, v88, v89
    v_cvt_pk_bf16_f32 v243, v90, v91
    v_mfma_f32_16x16x32_bf16 v[100:103], a[8:11], a[52:55], v[100:103]
    buffer_store_dwordx4 v[240:243], v26, s[32:35], s79 offen offset:1024 sc1
    v_mfma_f32_16x16x32_bf16 v[104:107], a[8:11], a[56:59], v[104:107]
    v_cvt_pk_bf16_f32 v228, v76, v77
    v_cvt_pk_bf16_f32 v229, v78, v79
    s_waitcnt lgkmcnt(10)
    v_mfma_f32_16x16x32_bf16 v[108:111], a[12:15], a[36:39], v[108:111]
    s_nop 1
    v_cvt_pk_bf16_f32 v230, v100, v101
    v_cvt_pk_bf16_f32 v231, v102, v103
    v_mfma_f32_16x16x32_bf16 v[112:115], a[12:15], a[40:43], v[112:115]
    buffer_store_dwordx4 v[228:231], v26, s[32:35], s83 offen offset:1024 sc1
    v_mfma_f32_16x16x32_bf16 v[116:119], a[12:15], a[44:47], v[116:119]
    v_cvt_pk_bf16_f32 v232, v84, v85
    v_cvt_pk_bf16_f32 v233, v86, v87
    v_mfma_f32_16x16x32_bf16 v[120:123], a[12:15], a[48:51], v[120:123]
    v_cvt_pk_bf16_f32 v234, v108, v109
    v_cvt_pk_bf16_f32 v235, v110, v111
    v_mfma_f32_16x16x32_bf16 v[124:127], a[12:15], a[52:55], v[124:127]
    buffer_store_dwordx4 v[232:235], v26, s[32:35], s78 offen offset:1024 sc1
    v_mfma_f32_16x16x32_bf16 v[128:131], a[12:15], a[56:59], v[128:131]
    v_cvt_pk_bf16_f32 v236, v92, v93
    v_cvt_pk_bf16_f32 v237, v94, v95
    s_waitcnt lgkmcnt(8)
    v_mfma_f32_16x16x32_bf16 v[132:135], a[16:19], a[36:39], v[132:135]
    v_cvt_pk_bf16_f32 v238, v116, v117
    v_cvt_pk_bf16_f32 v239, v118, v119
    v_mfma_f32_16x16x32_bf16 v[136:139], a[16:19], a[40:43], v[136:139]
    buffer_store_dwordx4 v[236:239], v26, s[32:35], s80 offen offset:3072 sc1
    v_mfma_f32_16x16x32_bf16 v[140:143], a[16:19], a[44:47], v[140:143]
    v_cvt_pk_bf16_f32 v240, v96, v97
    v_cvt_pk_bf16_f32 v241, v98, v99
    v_mfma_f32_16x16x32_bf16 v[144:147], a[16:19], a[48:51], v[144:147]
    v_cvt_pk_bf16_f32 v242, v120, v121
    v_cvt_pk_bf16_f32 v243, v122, v123
    v_mfma_f32_16x16x32_bf16 v[148:151], a[16:19], a[52:55], v[148:151]
    buffer_store_dwordx4 v[240:243], v26, s[32:35], s82 offen offset:1024 sc1
    v_mfma_f32_16x16x32_bf16 v[152:155], a[16:19], a[56:59], v[152:155]
    v_cvt_pk_bf16_f32 v228, v112, v113
    v_cvt_pk_bf16_f32 v229, v114, v115
    s_waitcnt lgkmcnt(6)
    v_mfma_f32_16x16x32_bf16 v[156:159], a[20:23], a[36:39], v[156:159]
    v_cvt_pk_bf16_f32 v230, v136, v137
    v_cvt_pk_bf16_f32 v231, v138, v139
    v_mfma_f32_16x16x32_bf16 v[160:163], a[20:23], a[40:43], v[160:163]
    buffer_store_dwordx4 v[228:231], v26, s[32:35], s79 offen offset:2048 sc1
    v_mfma_f32_16x16x32_bf16 v[164:167], a[20:23], a[44:47], v[164:167]
    v_cvt_pk_bf16_f32 v232, v124, v125
    v_cvt_pk_bf16_f32 v233, v126, v127
    v_mfma_f32_16x16x32_bf16 v[168:171], a[20:23], a[48:51], v[168:171]
    v_cvt_pk_bf16_f32 v234, v148, v149
    v_cvt_pk_bf16_f32 v235, v150, v151
    v_mfma_f32_16x16x32_bf16 v[172:175], a[20:23], a[52:55], v[172:175]
    buffer_store_dwordx4 v[232:235], v26, s[32:35], s83 offen offset:2048 sc1
    v_mfma_f32_16x16x32_bf16 v[176:179], a[20:23], a[56:59], v[176:179]
    v_cvt_pk_bf16_f32 v236, v132, v133
    v_cvt_pk_bf16_f32 v237, v134, v135
    s_waitcnt lgkmcnt(4)
    v_mfma_f32_16x16x32_bf16 v[180:183], a[24:27], a[36:39], v[180:183]
    v_cvt_pk_bf16_f32 v238, v156, v157
    v_cvt_pk_bf16_f32 v239, v158, v159
    v_mfma_f32_16x16x32_bf16 v[184:187], a[24:27], a[40:43], v[184:187]
    buffer_store_dwordx4 v[236:239], v26, s[32:35], s78 offen offset:2048 sc1
    v_mfma_f32_16x16x32_bf16 v[188:191], a[24:27], a[44:47], v[188:191]
    v_cvt_pk_bf16_f32 v240, v140, v141
    v_cvt_pk_bf16_f32 v241, v142, v143
    v_mfma_f32_16x16x32_bf16 v[192:195], a[24:27], a[48:51], v[192:195]
    v_cvt_pk_bf16_f32 v242, v164, v165
    v_cvt_pk_bf16_f32 v243, v166, v167
    v_mfma_f32_16x16x32_bf16 v[196:199], a[24:27], a[52:55], v[196:199]
    buffer_store_dwordx4 v[240:243], v26, s[32:35], s81 offen offset:0 sc1
    v_mfma_f32_16x16x32_bf16 v[200:203], a[24:27], a[56:59], v[200:203]
    v_cvt_pk_bf16_f32 v228, v144, v145
    v_cvt_pk_bf16_f32 v229, v146, v147
    s_waitcnt lgkmcnt(2)
    v_mfma_f32_16x16x32_bf16 v[204:207], a[28:31], a[36:39], v[204:207]
    v_cvt_pk_bf16_f32 v230, v168, v169
    v_cvt_pk_bf16_f32 v231, v170, v171
    v_mfma_f32_16x16x32_bf16 v[208:211], a[28:31], a[40:43], v[208:211]
    buffer_store_dwordx4 v[228:231], v26, s[32:35], s82 offen offset:2048 sc1
    v_mfma_f32_16x16x32_bf16 v[212:215], a[28:31], a[44:47], v[212:215]
    v_cvt_pk_bf16_f32 v232, v160, v161
    v_cvt_pk_bf16_f32 v233, v162, v163
    v_mfma_f32_16x16x32_bf16 v[216:219], a[28:31], a[48:51], v[216:219]
    v_cvt_pk_bf16_f32 v234, v184, v185
    v_cvt_pk_bf16_f32 v235, v186, v187
    v_mfma_f32_16x16x32_bf16 v[220:223], a[28:31], a[52:55], v[220:223]
    buffer_store_dwordx4 v[232:235], v26, s[32:35], s80 offen offset:0 sc1
    v_mfma_f32_16x16x32_bf16 v[224:227], a[28:31], a[56:59], v[224:227]
    v_cvt_pk_bf16_f32 v236, v180, v181
    v_cvt_pk_bf16_f32 v237, v182, v183
    s_waitcnt lgkmcnt(0)
    v_mfma_f32_16x16x32_bf16 a[60:63], a[32:35], a[36:39], a[60:63]
    v_cvt_pk_bf16_f32 v238, v204, v205
    v_cvt_pk_bf16_f32 v239, v206, v207
    v_mfma_f32_16x16x32_bf16 a[64:67], a[32:35], a[40:43], a[64:67]
    buffer_store_dwordx4 v[236:239], v26, s[32:35], s78 offen offset:3072 sc1
    v_mfma_f32_16x16x32_bf16 a[68:71], a[32:35], a[44:47], a[68:71]
    v_cvt_pk_bf16_f32 v240, v188, v189
    v_cvt_pk_bf16_f32 v241, v190, v191
    v_mfma_f32_16x16x32_bf16 a[72:75], a[32:35], a[48:51], a[72:75]
    v_cvt_pk_bf16_f32 v242, v212, v213
    v_cvt_pk_bf16_f32 v243, v214, v215
    v_mfma_f32_16x16x32_bf16 a[76:79], a[32:35], a[52:55], a[76:79]
    buffer_store_dwordx4 v[240:243], v26, s[32:35], s81 offen offset:1024 sc1
    v_mfma_f32_16x16x32_bf16 a[80:83], a[32:35], a[56:59], a[80:83]
    v_cvt_pk_bf16_f32 v228, v192, v193
    v_cvt_pk_bf16_f32 v229, v194, v195
    v_cvt_pk_bf16_f32 v230, v216, v217
    v_cvt_pk_bf16_f32 v231, v218, v219
    buffer_store_dwordx4 v[228:231], v26, s[32:35], s82 offen offset:3072 sc1
    v_accvgpr_read_b32 v244, a60
    v_accvgpr_read_b32 v245, a61
    v_accvgpr_read_b32 v246, a62
    v_accvgpr_read_b32 v247, a63
    v_cvt_pk_bf16_f32 v232, v244, v245
    v_cvt_pk_bf16_f32 v233, v246, v247
    v_cvt_pk_bf16_f32 v234, v40, v41
    v_cvt_pk_bf16_f32 v235, v42, v43
    buffer_store_dwordx4 v[232:235], v26, s[32:35], s79 offen offset:0 sc1
    v_cvt_pk_bf16_f32 v236, v208, v209
    v_cvt_pk_bf16_f32 v237, v210, v211
    v_accvgpr_read_b32 v248, a64
    v_accvgpr_read_b32 v249, a65
    v_accvgpr_read_b32 v250, a66
    v_accvgpr_read_b32 v251, a67
    v_cvt_pk_bf16_f32 v238, v248, v249
    v_cvt_pk_bf16_f32 v239, v250, v251
    buffer_store_dwordx4 v[236:239], v26, s[32:35], s80 offen offset:1024 sc1
    v_accvgpr_read_b32 v252, a68
    v_accvgpr_read_b32 v253, a69
    v_accvgpr_read_b32 v254, a70
    v_accvgpr_read_b32 v255, a71
    v_cvt_pk_bf16_f32 v240, v252, v253
    v_cvt_pk_bf16_f32 v241, v254, v255
    buffer_store_dwordx4 v[240:243], v26, s[32:35], s81 offen offset:2048 sc1
    v_accvgpr_read_b32 v244, a72
    v_accvgpr_read_b32 v245, a73
    v_accvgpr_read_b32 v246, a74
    v_accvgpr_read_b32 v247, a75
    v_cvt_pk_bf16_f32 v228, v244, v245
    v_cvt_pk_bf16_f32 v229, v246, v247
    v_cvt_pk_bf16_f32 v230, v52, v53
    v_cvt_pk_bf16_f32 v231, v54, v55
    buffer_store_dwordx4 v[228:231], v26, s[32:35], s83 offen offset:0 sc1
    s_lshl_b32 s55, s36, 7
    s_add_u32 s55, s55, 458764
    v_lshlrev_b32 v1, 9, v0
    v_mov_b32 v2, 1
    v_mov_b32 v3, 1524
    s_mov_b64 s[82:83], exec
    s_waitcnt vmcnt(0)
    s_mov_b64 exec, 7
    buffer_store_dword v2, v1, s[32:35], s55 offen sc1
    s_mov_b64 exec, 1
L_poll3:
    buffer_load_dwordx4 v[228:231], v3, s[32:35], s55 offen sc1
    s_waitcnt vmcnt(0)
    v_and_b32 v228, v228, v229
    v_and_b32 v228, v228, v230
    s_nop 0
    v_readfirstlane_b32 s56, v228
    s_nop 0
    s_cmp_eq_u32 s56, 1
    s_cbranch_scc1 L_poll_done3
    s_sleep 1
    s_branch L_poll3
L_poll_done3:
    s_mov_b64 exec, s[82:83]
    s_mul_i32 s55, s36, 7168
    s_add_u32 s56, s55, 344064
    buffer_load_dwordx4 v[36:39], v26, s[32:35], s56 offen offset:0 sc1
    s_add_u32 s57, s55, 372736
    buffer_load_dwordx4 v[68:71], v26, s[32:35], s57 offen offset:0 sc1
    s_add_u32 s58, s55, 401408
    buffer_load_dwordx4 v[100:103], v26, s[32:35], s58 offen offset:0 sc1
    buffer_load_dwordx4 v[40:43], v26, s[32:35], s56 offen offset:1024 sc1
    buffer_load_dwordx4 v[72:75], v26, s[32:35], s57 offen offset:1024 sc1
    buffer_load_dwordx4 v[108:111], v26, s[32:35], s58 offen offset:1024 sc1
    buffer_load_dwordx4 v[44:47], v26, s[32:35], s56 offen offset:2048 sc1
    buffer_load_dwordx4 v[76:79], v26, s[32:35], s57 offen offset:2048 sc1
    buffer_load_dwordx4 v[112:115], v26, s[32:35], s58 offen offset:2048 sc1
    buffer_load_dwordx4 v[48:51], v26, s[32:35], s56 offen offset:3072 sc1
    buffer_load_dwordx4 v[84:87], v26, s[32:35], s57 offen offset:3072 sc1
    buffer_load_dwordx4 v[116:119], v26, s[32:35], s58 offen offset:3072 sc1
    s_add_u32 s56, s55, 348160
    buffer_load_dwordx4 v[52:55], v26, s[32:35], s56 offen offset:0 sc1
    s_add_u32 s57, s55, 376832
    buffer_load_dwordx4 v[88:91], v26, s[32:35], s57 offen offset:0 sc1
    s_add_u32 s58, s55, 405504
    buffer_load_dwordx4 v[120:123], v26, s[32:35], s58 offen offset:0 sc1
    buffer_load_dwordx4 v[60:63], v26, s[32:35], s56 offen offset:1024 sc1
    buffer_load_dwordx4 v[92:95], v26, s[32:35], s57 offen offset:1024 sc1
    buffer_load_dwordx4 v[124:127], v26, s[32:35], s58 offen offset:1024 sc1
    buffer_load_dwordx4 v[64:67], v26, s[32:35], s56 offen offset:2048 sc1
    buffer_load_dwordx4 v[96:99], v26, s[32:35], s57 offen offset:2048 sc1
    buffer_load_dwordx4 v[132:135], v26, s[32:35], s58 offen offset:2048 sc1
    v_and_b32 v1, 15, v0
    v_mul_u32_u24 v1, 2304, v1
    v_lshrrev_b32 v2, 4, v0
    v_lshl_add_u32 v1, v2, 3, v1
    s_mul_i32 s55, s36, 288
    s_mov_b32 s59, 0xffff0000
    v_accvgpr_read_b32 v136, a76
    v_accvgpr_read_b32 v137, a77
    v_accvgpr_read_b32 v138, a78
    v_accvgpr_read_b32 v139, a79
    v_accvgpr_read_b32 v140, a80
    v_accvgpr_read_b32 v141, a81
    v_accvgpr_read_b32 v142, a82
    v_accvgpr_read_b32 v143, a83
    s_waitcnt vmcnt(18)
    v_lshlrev_b32 v228, 16, v36
    v_and_b32 v229, s59, v36
    v_lshlrev_b32 v230, 16, v37
    v_and_b32 v231, s59, v37
    v_pk_add_f32 v[172:173], v[172:173], v[228:229]
    v_pk_add_f32 v[174:175], v[174:175], v[230:231]
    v_lshlrev_b32 v232, 16, v68
    v_and_b32 v233, s59, v68
    v_lshlrev_b32 v234, 16, v69
    v_and_b32 v235, s59, v69
    v_pk_add_f32 v[172:173], v[172:173], v[232:233]
    v_pk_add_f32 v[174:175], v[174:175], v[234:235]
    v_lshlrev_b32 v236, 16, v100
    v_and_b32 v237, s59, v100
    v_lshlrev_b32 v238, 16, v101
    v_and_b32 v239, s59, v101
    v_pk_add_f32 v[172:173], v[172:173], v[236:237]
    v_pk_add_f32 v[174:175], v[174:175], v[238:239]
    v_cvt_pk_bf16_f32 v172, v172, v173
    v_cvt_pk_bf16_f32 v173, v174, v175
    s_add_u32 s56, s55, 147456
    buffer_store_dwordx2 v[172:173], v1, s[24:27], s56 offen offset:160
    v_lshlrev_b32 v240, 16, v38
    v_and_b32 v241, s59, v38
    v_lshlrev_b32 v242, 16, v39
    v_and_b32 v243, s59, v39
    v_pk_add_f32 v[196:197], v[196:197], v[240:241]
    v_pk_add_f32 v[198:199], v[198:199], v[242:243]
    v_lshlrev_b32 v244, 16, v70
    v_and_b32 v245, s59, v70
    v_lshlrev_b32 v246, 16, v71
    v_and_b32 v247, s59, v71
    v_pk_add_f32 v[196:197], v[196:197], v[244:245]
    v_pk_add_f32 v[198:199], v[198:199], v[246:247]
    v_lshlrev_b32 v248, 16, v102
    v_and_b32 v249, s59, v102
    v_lshlrev_b32 v250, 16, v103
    v_and_b32 v251, s59, v103
    v_pk_add_f32 v[196:197], v[196:197], v[248:249]
    v_pk_add_f32 v[198:199], v[198:199], v[250:251]
    v_cvt_pk_bf16_f32 v196, v196, v197
    v_cvt_pk_bf16_f32 v197, v198, v199
    s_add_u32 s57, s55, 147456
    buffer_store_dwordx2 v[196:197], v1, s[24:27], s57 offen offset:192
    s_waitcnt vmcnt(17)
    v_lshlrev_b32 v228, 16, v40
    v_and_b32 v229, s59, v40
    v_lshlrev_b32 v230, 16, v41
    v_and_b32 v231, s59, v41
    v_pk_add_f32 v[220:221], v[220:221], v[228:229]
    v_pk_add_f32 v[222:223], v[222:223], v[230:231]
    v_lshlrev_b32 v232, 16, v72
    v_and_b32 v233, s59, v72
    v_lshlrev_b32 v234, 16, v73
    v_and_b32 v235, s59, v73
    v_pk_add_f32 v[220:221], v[220:221], v[232:233]
    v_pk_add_f32 v[222:223], v[222:223], v[234:235]
    v_lshlrev_b32 v236, 16, v108
    v_and_b32 v237, s59, v108
    v_lshlrev_b32 v238, 16, v109
    v_and_b32 v239, s59, v109
    v_pk_add_f32 v[220:221], v[220:221], v[236:237]
    v_pk_add_f32 v[222:223], v[222:223], v[238:239]
    v_cvt_pk_bf16_f32 v220, v220, v221
    v_cvt_pk_bf16_f32 v221, v222, v223
    s_add_u32 s56, s55, 147456
    buffer_store_dwordx2 v[220:221], v1, s[24:27], s56 offen offset:224
    v_lshlrev_b32 v240, 16, v42
    v_and_b32 v241, s59, v42
    v_lshlrev_b32 v242, 16, v43
    v_and_b32 v243, s59, v43
    v_pk_add_f32 v[136:137], v[136:137], v[240:241]
    v_pk_add_f32 v[138:139], v[138:139], v[242:243]
    v_lshlrev_b32 v244, 16, v74
    v_and_b32 v245, s59, v74
    v_lshlrev_b32 v246, 16, v75
    v_and_b32 v247, s59, v75
    v_pk_add_f32 v[136:137], v[136:137], v[244:245]
    v_pk_add_f32 v[138:139], v[138:139], v[246:247]
    v_lshlrev_b32 v248, 16, v110
    v_and_b32 v249, s59, v110
    v_lshlrev_b32 v250, 16, v111
    v_and_b32 v251, s59, v111
    v_pk_add_f32 v[136:137], v[136:137], v[248:249]
    v_pk_add_f32 v[138:139], v[138:139], v[250:251]
    v_cvt_pk_bf16_f32 v136, v136, v137
    v_cvt_pk_bf16_f32 v137, v138, v139
    s_add_u32 s57, s55, 147456
    buffer_store_dwordx2 v[136:137], v1, s[24:27], s57 offen offset:256
    s_waitcnt vmcnt(16)
    v_lshlrev_b32 v228, 16, v44
    v_and_b32 v229, s59, v44
    v_lshlrev_b32 v230, 16, v45
    v_and_b32 v231, s59, v45
    v_pk_add_f32 v[56:57], v[56:57], v[228:229]
    v_pk_add_f32 v[58:59], v[58:59], v[230:231]
    v_lshlrev_b32 v232, 16, v76
    v_and_b32 v233, s59, v76
    v_lshlrev_b32 v234, 16, v77
    v_and_b32 v235, s59, v77
    v_pk_add_f32 v[56:57], v[56:57], v[232:233]
    v_pk_add_f32 v[58:59], v[58:59], v[234:235]
    v_lshlrev_b32 v236, 16, v112
    v_and_b32 v237, s59, v112
    v_lshlrev_b32 v238, 16, v113
    v_and_b32 v239, s59, v113
    v_pk_add_f32 v[56:57], v[56:57], v[236:237]
    v_pk_add_f32 v[58:59], v[58:59], v[238:239]
    v_cvt_pk_bf16_f32 v56, v56, v57
    v_cvt_pk_bf16_f32 v57, v58, v59
    s_add_u32 s56, s55, 184320
    buffer_store_dwordx2 v[56:57], v1, s[24:27], s56 offen offset:0
    v_lshlrev_b32 v240, 16, v46
    v_and_b32 v241, s59, v46
    v_lshlrev_b32 v242, 16, v47
    v_and_b32 v243, s59, v47
    v_pk_add_f32 v[80:81], v[80:81], v[240:241]
    v_pk_add_f32 v[82:83], v[82:83], v[242:243]
    v_lshlrev_b32 v244, 16, v78
    v_and_b32 v245, s59, v78
    v_lshlrev_b32 v246, 16, v79
    v_and_b32 v247, s59, v79
    v_pk_add_f32 v[80:81], v[80:81], v[244:245]
    v_pk_add_f32 v[82:83], v[82:83], v[246:247]
    v_lshlrev_b32 v248, 16, v114
    v_and_b32 v249, s59, v114
    v_lshlrev_b32 v250, 16, v115
    v_and_b32 v251, s59, v115
    v_pk_add_f32 v[80:81], v[80:81], v[248:249]
    v_pk_add_f32 v[82:83], v[82:83], v[250:251]
    v_cvt_pk_bf16_f32 v80, v80, v81
    v_cvt_pk_bf16_f32 v81, v82, v83
    s_add_u32 s57, s55, 184320
    buffer_store_dwordx2 v[80:81], v1, s[24:27], s57 offen offset:32
    s_waitcnt vmcnt(15)
    v_lshlrev_b32 v228, 16, v48
    v_and_b32 v229, s59, v48
    v_lshlrev_b32 v230, 16, v49
    v_and_b32 v231, s59, v49
    v_pk_add_f32 v[104:105], v[104:105], v[228:229]
    v_pk_add_f32 v[106:107], v[106:107], v[230:231]
    v_lshlrev_b32 v232, 16, v84
    v_and_b32 v233, s59, v84
    v_lshlrev_b32 v234, 16, v85
    v_and_b32 v235, s59, v85
    v_pk_add_f32 v[104:105], v[104:105], v[232:233]
    v_pk_add_f32 v[106:107], v[106:107], v[234:235]
    v_lshlrev_b32 v236, 16, v116
    v_and_b32 v237, s59, v116
    v_lshlrev_b32 v238, 16, v117
    v_and_b32 v239, s59, v117
    v_pk_add_f32 v[104:105], v[104:105], v[236:237]
    v_pk_add_f32 v[106:107], v[106:107], v[238:239]
    v_cvt_pk_bf16_f32 v104, v104, v105
    v_cvt_pk_bf16_f32 v105, v106, v107
    s_add_u32 s56, s55, 184320
    buffer_store_dwordx2 v[104:105], v1, s[24:27], s56 offen offset:64
    v_lshlrev_b32 v240, 16, v50
    v_and_b32 v241, s59, v50
    v_lshlrev_b32 v242, 16, v51
    v_and_b32 v243, s59, v51
    v_pk_add_f32 v[128:129], v[128:129], v[240:241]
    v_pk_add_f32 v[130:131], v[130:131], v[242:243]
    v_lshlrev_b32 v244, 16, v86
    v_and_b32 v245, s59, v86
    v_lshlrev_b32 v246, 16, v87
    v_and_b32 v247, s59, v87
    v_pk_add_f32 v[128:129], v[128:129], v[244:245]
    v_pk_add_f32 v[130:131], v[130:131], v[246:247]
    v_lshlrev_b32 v248, 16, v118
    v_and_b32 v249, s59, v118
    v_lshlrev_b32 v250, 16, v119
    v_and_b32 v251, s59, v119
    v_pk_add_f32 v[128:129], v[128:129], v[248:249]
    v_pk_add_f32 v[130:131], v[130:131], v[250:251]
    v_cvt_pk_bf16_f32 v128, v128, v129
    v_cvt_pk_bf16_f32 v129, v130, v131
    s_add_u32 s57, s55, 184320
    buffer_store_dwordx2 v[128:129], v1, s[24:27], s57 offen offset:96
    s_waitcnt vmcnt(14)
    v_lshlrev_b32 v228, 16, v52
    v_and_b32 v229, s59, v52
    v_lshlrev_b32 v230, 16, v53
    v_and_b32 v231, s59, v53
    v_pk_add_f32 v[152:153], v[152:153], v[228:229]
    v_pk_add_f32 v[154:155], v[154:155], v[230:231]
    v_lshlrev_b32 v232, 16, v88
    v_and_b32 v233, s59, v88
    v_lshlrev_b32 v234, 16, v89
    v_and_b32 v235, s59, v89
    v_pk_add_f32 v[152:153], v[152:153], v[232:233]
    v_pk_add_f32 v[154:155], v[154:155], v[234:235]
    v_lshlrev_b32 v236, 16, v120
    v_and_b32 v237, s59, v120
    v_lshlrev_b32 v238, 16, v121
    v_and_b32 v239, s59, v121
    v_pk_add_f32 v[152:153], v[152:153], v[236:237]
    v_pk_add_f32 v[154:155], v[154:155], v[238:239]
    v_cvt_pk_bf16_f32 v152, v152, v153
    v_cvt_pk_bf16_f32 v153, v154, v155
    s_add_u32 s56, s55, 184320
    buffer_store_dwordx2 v[152:153], v1, s[24:27], s56 offen offset:128
    v_lshlrev_b32 v240, 16, v54
    v_and_b32 v241, s59, v54
    v_lshlrev_b32 v242, 16, v55
    v_and_b32 v243, s59, v55
    v_pk_add_f32 v[176:177], v[176:177], v[240:241]
    v_pk_add_f32 v[178:179], v[178:179], v[242:243]
    v_lshlrev_b32 v244, 16, v90
    v_and_b32 v245, s59, v90
    v_lshlrev_b32 v246, 16, v91
    v_and_b32 v247, s59, v91
    v_pk_add_f32 v[176:177], v[176:177], v[244:245]
    v_pk_add_f32 v[178:179], v[178:179], v[246:247]
    v_lshlrev_b32 v248, 16, v122
    v_and_b32 v249, s59, v122
    v_lshlrev_b32 v250, 16, v123
    v_and_b32 v251, s59, v123
    v_pk_add_f32 v[176:177], v[176:177], v[248:249]
    v_pk_add_f32 v[178:179], v[178:179], v[250:251]
    v_cvt_pk_bf16_f32 v176, v176, v177
    v_cvt_pk_bf16_f32 v177, v178, v179
    s_add_u32 s57, s55, 184320
    buffer_store_dwordx2 v[176:177], v1, s[24:27], s57 offen offset:160
    s_waitcnt vmcnt(13)
    v_lshlrev_b32 v228, 16, v60
    v_and_b32 v229, s59, v60
    v_lshlrev_b32 v230, 16, v61
    v_and_b32 v231, s59, v61
    v_pk_add_f32 v[200:201], v[200:201], v[228:229]
    v_pk_add_f32 v[202:203], v[202:203], v[230:231]
    v_lshlrev_b32 v232, 16, v92
    v_and_b32 v233, s59, v92
    v_lshlrev_b32 v234, 16, v93
    v_and_b32 v235, s59, v93
    v_pk_add_f32 v[200:201], v[200:201], v[232:233]
    v_pk_add_f32 v[202:203], v[202:203], v[234:235]
    v_lshlrev_b32 v236, 16, v124
    v_and_b32 v237, s59, v124
    v_lshlrev_b32 v238, 16, v125
    v_and_b32 v239, s59, v125
    v_pk_add_f32 v[200:201], v[200:201], v[236:237]
    v_pk_add_f32 v[202:203], v[202:203], v[238:239]
    v_cvt_pk_bf16_f32 v200, v200, v201
    v_cvt_pk_bf16_f32 v201, v202, v203
    s_add_u32 s56, s55, 184320
    buffer_store_dwordx2 v[200:201], v1, s[24:27], s56 offen offset:192
    v_lshlrev_b32 v240, 16, v62
    v_and_b32 v241, s59, v62
    v_lshlrev_b32 v242, 16, v63
    v_and_b32 v243, s59, v63
    v_pk_add_f32 v[224:225], v[224:225], v[240:241]
    v_pk_add_f32 v[226:227], v[226:227], v[242:243]
    v_lshlrev_b32 v244, 16, v94
    v_and_b32 v245, s59, v94
    v_lshlrev_b32 v246, 16, v95
    v_and_b32 v247, s59, v95
    v_pk_add_f32 v[224:225], v[224:225], v[244:245]
    v_pk_add_f32 v[226:227], v[226:227], v[246:247]
    v_lshlrev_b32 v248, 16, v126
    v_and_b32 v249, s59, v126
    v_lshlrev_b32 v250, 16, v127
    v_and_b32 v251, s59, v127
    v_pk_add_f32 v[224:225], v[224:225], v[248:249]
    v_pk_add_f32 v[226:227], v[226:227], v[250:251]
    v_cvt_pk_bf16_f32 v224, v224, v225
    v_cvt_pk_bf16_f32 v225, v226, v227
    s_add_u32 s57, s55, 184320
    buffer_store_dwordx2 v[224:225], v1, s[24:27], s57 offen offset:224
    s_waitcnt vmcnt(12)
    v_lshlrev_b32 v228, 16, v64
    v_and_b32 v229, s59, v64
    v_lshlrev_b32 v230, 16, v65
    v_and_b32 v231, s59, v65
    v_pk_add_f32 v[140:141], v[140:141], v[228:229]
    v_pk_add_f32 v[142:143], v[142:143], v[230:231]
    v_lshlrev_b32 v232, 16, v96
    v_and_b32 v233, s59, v96
    v_lshlrev_b32 v234, 16, v97
    v_and_b32 v235, s59, v97
    v_pk_add_f32 v[140:141], v[140:141], v[232:233]
    v_pk_add_f32 v[142:143], v[142:143], v[234:235]
    v_lshlrev_b32 v236, 16, v132
    v_and_b32 v237, s59, v132
    v_lshlrev_b32 v238, 16, v133
    v_and_b32 v239, s59, v133
    v_pk_add_f32 v[140:141], v[140:141], v[236:237]
    v_pk_add_f32 v[142:143], v[142:143], v[238:239]
    v_cvt_pk_bf16_f32 v140, v140, v141
    v_cvt_pk_bf16_f32 v141, v142, v143
    s_add_u32 s56, s55, 184320
    buffer_store_dwordx2 v[140:141], v1, s[24:27], s56 offen offset:256
    s_endpgm
L_slow0:
    v_subrev_u32 v4, 69632, v4
    v_subrev_u32 v5, 69632, v5
    v_subrev_u32 v6, 69632, v6
    v_subrev_u32 v7, 69632, v7
    v_subrev_u32 v8, 69632, v8
    s_branch L_slowc
L_slow1:
    v_subrev_u32 v4, 34816, v4
    v_subrev_u32 v5, 34816, v5
    v_subrev_u32 v6, 34816, v6
    v_subrev_u32 v7, 34816, v7
    v_subrev_u32 v8, 34816, v8
L_slowc:
    s_waitcnt vmcnt(0) lgkmcnt(0)
    s_barrier
    s_add_u32 s8, s64, s60
    s_addc_u32 s9, s65, 0
    s_sub_u32 s8, s8, 256
    s_subb_u32 s9, s9, 0
    s_and_b32 s9, s9, 0xffff
    s_mov_b32 s10, 131328
    s_mov_b32 s11, 0x20000
    s_add_u32 s12, s66, s60
    s_addc_u32 s13, s67, 0
    s_sub_u32 s12, s12, 1280
    s_subb_u32 s13, s13, 0
    s_and_b32 s13, s13, 0xffff
    s_mov_b32 s14, 132352
    s_mov_b32 s15, 0x20000
    s_mov_b32 s96, 8192
    s_lshr_b32 s53, s36, 1
    s_mul_i32 s53, s53, 17408
    s_and_b32 s43, s36, 1
    s_mul_i32 s43, s43, 4352
    s_add_u32 s43, s43, s53
    s_add_u32 s44, s43, 8704
    v_lshrrev_b32 v1, 4, v0
    v_and_b32 v2, 15, v0
    v_xor_b32 v3, v1, v2
    v_lshlrev_b32 v3, 4, v3
    v_lshl_add_u32 v12, v1, 8, v3
    v_add_u32 v9, 256, v12
    v_add_u32 v10, 192, v12
    v_add_u32 v11, 128, v12
    v_add_u32 v12, 64, v12
    v_lshlrev_b32 v3, 1, v1
    v_xor_b32 v3, v3, v2
    v_lshlrev_b32 v3, 4, v3
    v_lshl_add_u32 v16, v1, 8, v3
    v_add_u32 v13, 1280, v16
    v_add_u32 v14, 2240, v16
    v_add_u32 v15, 128, v16
    v_add_u32 v16, 1088, v16
    s_and_b32 s48, s36, 1
    s_lshl_b32 s48, s48, 12
    s_mov_b32 s49, s48
    s_mov_b32 s97, 16
    v_mov_b32 v228, 0xff800000
    v_mov_b32 v232, 0xff800000
    v_mov_b32 v236, 0xff800000
    v_mov_b32 v240, 0xff800000
    v_mov_b32 v244, 0xff800000
    v_mov_b32 v248, 0xff800000
L_slowk:
    s_add_u32 m0, s43, 0
    s_nop 0
    buffer_load_dwordx4 v9, s[8:11], s48 offen offset:0 nt lds
    buffer_load_dwordx4 v10, s[8:11], s48 offen offset:1088 nt lds
    buffer_load_dwordx4 v11, s[8:11], s48 offen offset:2176 nt lds
    buffer_load_dwordx4 v12, s[8:11], s48 offen offset:3264 nt lds
    s_add_u32 s48, s48, s96
    s_waitcnt vmcnt(0)
    s_barrier
    ds_read_b128 a[192:195], v4 offset:0
    s_waitcnt lgkmcnt(0)
    v_mfma_f32_16x16x32_bf16 v[40:43], a[192:195], v[36:39], 0
    v_mfma_f32_16x16x32_bf16 v[48:51], a[192:195], v[44:47], 0
    v_mfma_f32_16x16x32_bf16 v[56:59], a[192:195], v[52:55], 0
    v_mfma_f32_16x16x32_bf16 v[64:67], a[192:195], v[60:63], 0
    v_mfma_f32_16x16x32_bf16 v[72:75], a[192:195], v[68:71], 0
    v_mfma_f32_16x16x32_bf16 v[80:83], a[192:195], v[76:79], 0
    ds_read_b128 a[196:199], v4 offset:64
    s_waitcnt lgkmcnt(0)
    v_mfma_f32_16x16x32_bf16 v[40:43], a[196:199], v[84:87], v[40:43]
    v_mfma_f32_16x16x32_bf16 v[48:51], a[196:199], v[92:95], v[48:51]
    v_mfma_f32_16x16x32_bf16 v[56:59], a[196:199], v[100:103], v[56:59]
    v_mfma_f32_16x16x32_bf16 v[64:67], a[196:199], v[108:111], v[64:67]
    v_mfma_f32_16x16x32_bf16 v[72:75], a[196:199], v[116:119], v[72:75]
    v_mfma_f32_16x16x32_bf16 v[80:83], a[196:199], v[124:127], v[80:83]
    ds_read_b128 a[200:203], v4 offset:128
    s_waitcnt lgkmcnt(0)
    v_mfma_f32_16x16x32_bf16 v[40:43], a[200:203], v[132:135], v[40:43]
    v_mfma_f32_16x16x32_bf16 v[48:51], a[200:203], v[140:143], v[48:51]
    v_mfma_f32_16x16x32_bf16 v[56:59], a[200:203], v[148:151], v[56:59]
    v_mfma_f32_16x16x32_bf16 v[64:67], a[200:203], v[156:159], v[64:67]
    v_mfma_f32_16x16x32_bf16 v[72:75], a[200:203], v[164:167], v[72:75]
    v_mfma_f32_16x16x32_bf16 v[80:83], a[200:203], v[172:175], v[80:83]
    ds_read_b128 a[204:207], v4 offset:192
    s_waitcnt lgkmcnt(0)
    v_mfma_f32_16x16x32_bf16 v[40:43], a[204:207], v[180:183], v[40:43]
    v_mfma_f32_16x16x32_bf16 v[48:51], a[204:207], v[188:191], v[48:51]
    v_mfma_f32_16x16x32_bf16 v[56:59], a[204:207], v[196:199], v[56:59]
    v_mfma_f32_16x16x32_bf16 v[64:67], a[204:207], v[204:207], v[64:67]
    v_mfma_f32_16x16x32_bf16 v[72:75], a[204:207], v[212:215], v[72:75]
    v_mfma_f32_16x16x32_bf16 v[80:83], a[204:207], v[220:223], v[80:83]
    ds_read_b128 a[192:195], v4 offset:4352
    s_waitcnt lgkmcnt(0)
    v_mfma_f32_16x16x32_bf16 v[88:91], a[192:195], v[36:39], 0
    v_mfma_f32_16x16x32_bf16 v[96:99], a[192:195], v[44:47], 0
    v_mfma_f32_16x16x32_bf16 v[104:107], a[192:195], v[52:55], 0
    v_mfma_f32_16x16x32_bf16 v[112:115], a[192:195], v[60:63], 0
    v_mfma_f32_16x16x32_bf16 v[120:123], a[192:195], v[68:71], 0
    v_mfma_f32_16x16x32_bf16 v[128:131], a[192:195], v[76:79], 0
    ds_read_b128 a[196:199], v4 offset:4416
    s_waitcnt lgkmcnt(0)
    v_mfma_f32_16x16x32_bf16 v[88:91], a[196:199], v[84:87], v[88:91]
    v_mfma_f32_16x16x32_bf16 v[96:99], a[196:199], v[92:95], v[96:99]
    v_mfma_f32_16x16x32_bf16 v[104:107], a[196:199], v[100:103], v[104:107]
    v_mfma_f32_16x16x32_bf16 v[112:115], a[196:199], v[108:111], v[112:115]
    v_mfma_f32_16x16x32_bf16 v[120:123], a[196:199], v[116:119], v[120:123]
    v_mfma_f32_16x16x32_bf16 v[128:131], a[196:199], v[124:127], v[128:131]
    ds_read_b128 a[200:203], v4 offset:4480
    s_waitcnt lgkmcnt(0)
    v_mfma_f32_16x16x32_bf16 v[88:91], a[200:203], v[132:135], v[88:91]
    v_mfma_f32_16x16x32_bf16 v[96:99], a[200:203], v[140:143], v[96:99]
    v_mfma_f32_16x16x32_bf16 v[104:107], a[200:203], v[148:151], v[104:107]
    v_mfma_f32_16x16x32_bf16 v[112:115], a[200:203], v[156:159], v[112:115]
    v_mfma_f32_16x16x32_bf16 v[120:123], a[200:203], v[164:167], v[120:123]
    v_mfma_f32_16x16x32_bf16 v[128:131], a[200:203], v[172:175], v[128:131]
    ds_read_b128 a[204:207], v4 offset:4544
    s_waitcnt lgkmcnt(0)
    v_mfma_f32_16x16x32_bf16 v[88:91], a[204:207], v[180:183], v[88:91]
    v_mfma_f32_16x16x32_bf16 v[96:99], a[204:207], v[188:191], v[96:99]
    v_mfma_f32_16x16x32_bf16 v[104:107], a[204:207], v[196:199], v[104:107]
    v_mfma_f32_16x16x32_bf16 v[112:115], a[204:207], v[204:207], v[112:115]
    v_mfma_f32_16x16x32_bf16 v[120:123], a[204:207], v[212:215], v[120:123]
    v_mfma_f32_16x16x32_bf16 v[128:131], a[204:207], v[220:223], v[128:131]
    v_max3_f32 v228, v228, v40, v41
    v_max3_f32 v228, v228, v42, v43
    s_nop 0
    v_max3_f32 v228, v228, v88, v89
    v_max3_f32 v228, v228, v90, v91
    v_max3_f32 v232, v232, v48, v49
    v_max3_f32 v232, v232, v50, v51
    v_max3_f32 v232, v232, v96, v97
    v_max3_f32 v232, v232, v98, v99
    v_max3_f32 v236, v236, v56, v57
    v_max3_f32 v236, v236, v58, v59
    v_max3_f32 v236, v236, v104, v105
    v_max3_f32 v236, v236, v106, v107
    v_max3_f32 v240, v240, v64, v65
    v_max3_f32 v240, v240, v66, v67
    v_max3_f32 v240, v240, v112, v113
    v_max3_f32 v240, v240, v114, v115
    v_max3_f32 v244, v244, v72, v73
    v_max3_f32 v244, v244, v74, v75
    v_max3_f32 v244, v244, v120, v121
    v_max3_f32 v244, v244, v122, v123
    v_max3_f32 v248, v248, v80, v81
    v_max3_f32 v248, v248, v82, v83
    v_max3_f32 v248, v248, v128, v129
    v_max3_f32 v248, v248, v130, v131
    s_waitcnt lgkmcnt(0)
    s_barrier
    s_sub_u32 s97, s97, 1
    s_cmp_lg_u32 s97, 0
    s_cbranch_scc1 L_slowk
    v_mov_b32 v229, v228
    s_nop 1
    v_permlane32_swap_b32 v229, v228
    v_max_f32 v228, v228, v229
    v_mov_b32 v229, v228
    s_nop 1
    v_permlane16_swap_b32 v229, v228
    v_max_f32 v228, v228, v229
    v_sub_f32 v228, 0, v228
    v_mov_b32 v229, v228
    v_mov_b32 v230, v228
    v_mov_b32 v231, v228
    v_mov_b32 v233, v232
    s_nop 1
    v_permlane32_swap_b32 v233, v232
    v_max_f32 v232, v232, v233
    v_mov_b32 v233, v232
    s_nop 1
    v_permlane16_swap_b32 v233, v232
    v_max_f32 v232, v232, v233
    v_sub_f32 v232, 0, v232
    v_mov_b32 v233, v232
    v_mov_b32 v234, v232
    v_mov_b32 v235, v232
    v_mov_b32 v237, v236
    s_nop 1
    v_permlane32_swap_b32 v237, v236
    v_max_f32 v236, v236, v237
    v_mov_b32 v237, v236
    s_nop 1
    v_permlane16_swap_b32 v237, v236
    v_max_f32 v236, v236, v237
    v_sub_f32 v236, 0, v236
    v_mov_b32 v237, v236
    v_mov_b32 v238, v236
    v_mov_b32 v239, v236
    v_mov_b32 v241, v240
    s_nop 1
    v_permlane32_swap_b32 v241, v240
    v_max_f32 v240, v240, v241
    v_mov_b32 v241, v240
    s_nop 1
    v_permlane16_swap_b32 v241, v240
    v_max_f32 v240, v240, v241
    v_sub_f32 v240, 0, v240
    v_mov_b32 v241, v240
    v_mov_b32 v242, v240
    v_mov_b32 v243, v240
    v_mov_b32 v245, v244
    s_nop 1
    v_permlane32_swap_b32 v245, v244
    v_max_f32 v244, v244, v245
    v_mov_b32 v245, v244
    s_nop 1
    v_permlane16_swap_b32 v245, v244
    v_max_f32 v244, v244, v245
    v_sub_f32 v244, 0, v244
    v_mov_b32 v245, v244
    v_mov_b32 v246, v244
    v_mov_b32 v247, v244
    v_mov_b32 v249, v248
    s_nop 1
    v_permlane32_swap_b32 v249, v248
    v_max_f32 v248, v248, v249
    v_mov_b32 v249, v248
    s_nop 1
    v_permlane16_swap_b32 v249, v248
    v_max_f32 v248, v248, v249
    v_sub_f32 v248, 0, v248
    v_mov_b32 v249, v248
    v_mov_b32 v250, v248
    v_mov_b32 v251, v248
    s_and_b32 s48, s36, 1
    s_lshl_b32 s48, s48, 12
    s_mov_b32 s49, s48
    s_mov_b32 s98, s3
    s_mov_b32 s99, s98
    s_add_u32 s98, s98, 34816
    s_cmp_eq_u32 s98, 139264
    s_cselect_b32 s98, 0, s98
    s_sub_u32 s100, s98, s99
    s_add_u32 m0, s43, s99
    s_nop 0
    buffer_load_dwordx4 v9, s[8:11], s48 offen offset:0 nt lds
    buffer_load_dwordx4 v10, s[8:11], s48 offen offset:1088 nt lds
    buffer_load_dwordx4 v11, s[8:11], s48 offen offset:2176 nt lds
    buffer_load_dwordx4 v12, s[8:11], s48 offen offset:3264 nt lds
    s_add_u32 s48, s48, s96
    s_mov_b32 s99, s98
    s_add_u32 s98, s98, 34816
    s_cmp_eq_u32 s98, 139264
    s_cselect_b32 s98, 0, s98
    s_sub_u32 s100, s98, s99
    s_add_u32 m0, s43, s99
    s_nop 0
    buffer_load_dwordx4 v9, s[8:11], s48 offen offset:0 nt lds
    buffer_load_dwordx4 v10, s[8:11], s48 offen offset:1088 nt lds
    buffer_load_dwordx4 v11, s[8:11], s48 offen offset:2176 nt lds
    buffer_load_dwordx4 v12, s[8:11], s48 offen offset:3264 nt lds
    s_add_u32 s48, s48, s96
    s_add_u32 m0, s44, s99
    s_nop 0
    buffer_load_dwordx4 v13, s[12:15], s49 offen offset:0 nt lds
    buffer_load_dwordx4 v14, s[12:15], s49 offen offset:1088 nt lds
    buffer_load_dwordx4 v15, s[12:15], s49 offen offset:2176 nt lds
    buffer_load_dwordx4 v16, s[12:15], s49 offen offset:3264 nt lds
    s_add_u32 s49, s49, s96
    s_mov_b32 s99, s98
    s_add_u32 s98, s98, 34816
    s_cmp_eq_u32 s98, 139264
    s_cselect_b32 s98, 0, s98
    s_sub_u32 s100, s98, s99
    s_add_u32 m0, s43, s99
    s_nop 0
    buffer_load_dwordx4 v9, s[8:11], s48 offen offset:0 nt lds
    buffer_load_dwordx4 v10, s[8:11], s48 offen offset:1088 nt lds
    buffer_load_dwordx4 v11, s[8:11], s48 offen offset:2176 nt lds
    buffer_load_dwordx4 v12, s[8:11], s48 offen offset:3264 nt lds
    s_add_u32 s48, s48, s96
    s_add_u32 m0, s44, s99
    s_nop 0
    buffer_load_dwordx4 v13, s[12:15], s49 offen offset:0 nt lds
    buffer_load_dwordx4 v14, s[12:15], s49 offen offset:1088 nt lds
    buffer_load_dwordx4 v15, s[12:15], s49 offen offset:2176 nt lds
    buffer_load_dwordx4 v16, s[12:15], s49 offen offset:3264 nt lds
    s_add_u32 s49, s49, s96
    s_mov_b32 s99, s98
    s_add_u32 s98, s98, 34816
    s_cmp_eq_u32 s98, 139264
    s_cselect_b32 s98, 0, s98
    s_sub_u32 s100, s98, s99
    s_add_u32 m0, s43, s99
    s_nop 0
    buffer_load_dwordx4 v9, s[8:11], s48 offen offset:0 nt lds
    buffer_load_dwordx4 v10, s[8:11], s48 offen offset:1088 nt lds
    buffer_load_dwordx4 v11, s[8:11], s48 offen offset:2176 nt lds
    buffer_load_dwordx4 v12, s[8:11], s48 offen offset:3264 nt lds
    s_add_u32 s48, s48, s96
    s_add_u32 m0, s44, s99
    s_nop 0
    buffer_load_dwordx4 v13, s[12:15], s49 offen offset:0 nt lds
    buffer_load_dwordx4 v14, s[12:15], s49 offen offset:1088 nt lds
    buffer_load_dwordx4 v15, s[12:15], s49 offen offset:2176 nt lds
    buffer_load_dwordx4 v16, s[12:15], s49 offen offset:3264 nt lds
    s_add_u32 s49, s49, s96
    s_mov_b32 s95, 1
    s_waitcnt vmcnt(0)
    s_barrier
    v_add_u32 v4, s98, v4
    ds_read_b128 a[192:195], v4 offset:0
    ds_read_b128 a[196:199], v4 offset:64
    s_waitcnt lgkmcnt(1)
    v_mfma_f32_16x16x32_bf16 v[40:43], a[192:195], v[36:39], v[228:231]
    v_mfma_f32_16x16x32_bf16 v[48:51], a[192:195], v[44:47], v[232:235]
    v_mfma_f32_16x16x32_bf16 v[56:59], a[192:195], v[52:55], v[236:239]
    v_mfma_f32_16x16x32_bf16 v[64:67], a[192:195], v[60:63], v[240:243]
    v_mfma_f32_16x16x32_bf16 v[72:75], a[192:195], v[68:71], v[244:247]
    v_mfma_f32_16x16x32_bf16 v[80:83], a[192:195], v[76:79], v[248:251]
    s_waitcnt lgkmcnt(0)
    v_mfma_f32_16x16x32_bf16 v[40:43], a[196:199], v[84:87], v[40:43]
    v_mfma_f32_16x16x32_bf16 v[48:51], a[196:199], v[92:95], v[48:51]
    v_mfma_f32_16x16x32_bf16 v[56:59], a[196:199], v[100:103], v[56:59]
    v_mfma_f32_16x16x32_bf16 v[64:67], a[196:199], v[108:111], v[64:67]
    v_mfma_f32_16x16x32_bf16 v[72:75], a[196:199], v[116:119], v[72:75]
    v_mfma_f32_16x16x32_bf16 v[80:83], a[196:199], v[124:127], v[80:83]
    ds_read_b128 a[200:203], v4 offset:128
    s_waitcnt lgkmcnt(0)
    v_mfma_f32_16x16x32_bf16 v[40:43], a[200:203], v[132:135], v[40:43]
    v_mfma_f32_16x16x32_bf16 v[48:51], a[200:203], v[140:143], v[48:51]
    v_mfma_f32_16x16x32_bf16 v[56:59], a[200:203], v[148:151], v[56:59]
    v_mfma_f32_16x16x32_bf16 v[64:67], a[200:203], v[156:159], v[64:67]
    v_mfma_f32_16x16x32_bf16 v[72:75], a[200:203], v[164:167], v[72:75]
    v_mfma_f32_16x16x32_bf16 v[80:83], a[200:203], v[172:175], v[80:83]
    ds_read_b128 a[204:207], v4 offset:192
    s_waitcnt lgkmcnt(0)
    v_mfma_f32_16x16x32_bf16 v[40:43], a[204:207], v[180:183], v[40:43]
    v_mfma_f32_16x16x32_bf16 v[48:51], a[204:207], v[188:191], v[48:51]
    v_mfma_f32_16x16x32_bf16 v[56:59], a[204:207], v[196:199], v[56:59]
    v_mfma_f32_16x16x32_bf16 v[64:67], a[204:207], v[204:207], v[64:67]
    v_mfma_f32_16x16x32_bf16 v[72:75], a[204:207], v[212:215], v[72:75]
    v_mfma_f32_16x16x32_bf16 v[80:83], a[204:207], v[220:223], v[80:83]
    ds_read_b128 a[192:195], v4 offset:4352
    s_waitcnt lgkmcnt(0)
    v_mfma_f32_16x16x32_bf16 v[88:91], a[192:195], v[36:39], v[228:231]
    v_mfma_f32_16x16x32_bf16 v[96:99], a[192:195], v[44:47], v[232:235]
    v_mfma_f32_16x16x32_bf16 v[104:107], a[192:195], v[52:55], v[236:239]
    v_mfma_f32_16x16x32_bf16 v[112:115], a[192:195], v[60:63], v[240:243]
    v_mfma_f32_16x16x32_bf16 v[120:123], a[192:195], v[68:71], v[244:247]
    v_mfma_f32_16x16x32_bf16 v[128:131], a[192:195], v[76:79], v[248:251]
    ds_read_b128 a[196:199], v4 offset:4416
    s_waitcnt lgkmcnt(0)
    v_mfma_f32_16x16x32_bf16 v[88:91], a[196:199], v[84:87], v[88:91]
    v_mfma_f32_16x16x32_bf16 v[96:99], a[196:199], v[92:95], v[96:99]
    v_mfma_f32_16x16x32_bf16 v[104:107], a[196:199], v[100:103], v[104:107]
    v_mfma_f32_16x16x32_bf16 v[112:115], a[196:199], v[108:111], v[112:115]
    v_mfma_f32_16x16x32_bf16 v[120:123], a[196:199], v[116:119], v[120:123]
    v_mfma_f32_16x16x32_bf16 v[128:131], a[196:199], v[124:127], v[128:131]
    ds_read_b128 a[200:203], v4 offset:4480
    s_waitcnt lgkmcnt(0)
    v_mfma_f32_16x16x32_bf16 v[88:91], a[200:203], v[132:135], v[88:91]
    v_mfma_f32_16x16x32_bf16 v[96:99], a[200:203], v[140:143], v[96:99]
    v_mfma_f32_16x16x32_bf16 v[104:107], a[200:203], v[148:151], v[104:107]
    v_mfma_f32_16x16x32_bf16 v[112:115], a[200:203], v[156:159], v[112:115]
    v_mfma_f32_16x16x32_bf16 v[120:123], a[200:203], v[164:167], v[120:123]
    v_mfma_f32_16x16x32_bf16 v[128:131], a[200:203], v[172:175], v[128:131]
    ds_read_b128 a[204:207], v4 offset:4544
    s_waitcnt lgkmcnt(0)
    v_mfma_f32_16x16x32_bf16 v[88:91], a[204:207], v[180:183], v[88:91]
    v_mfma_f32_16x16x32_bf16 v[96:99], a[204:207], v[188:191], v[96:99]
    v_mfma_f32_16x16x32_bf16 v[104:107], a[204:207], v[196:199], v[104:107]
    v_mfma_f32_16x16x32_bf16 v[112:115], a[204:207], v[204:207], v[112:115]
    v_mfma_f32_16x16x32_bf16 v[120:123], a[204:207], v[212:215], v[120:123]
    v_mfma_f32_16x16x32_bf16 v[128:131], a[204:207], v[220:223], v[128:131]
    s_mov_b32 s99, s98
    s_add_u32 s98, s98, 34816
    s_cmp_eq_u32 s98, 139264
    s_cselect_b32 s98, 0, s98
    s_sub_u32 s100, s98, s99
    s_waitcnt vmcnt(0)
    s_barrier
    v_add_u32 v4, s100, v4
    ds_read_b128 a[192:195], v4 offset:0
    ds_read_b128 a[196:199], v4 offset:64
    v_mov_b32 v30, 0
    v_mov_b32 v31, 0
    v_mov_b32 v32, 0
    v_mov_b32 v33, 0
    v_mov_b32 v34, 0
    v_mov_b32 v35, 0
    v_exp_f32 v40, v40
    v_exp_f32 v41, v41
    v_exp_f32 v42, v42
    v_exp_f32 v43, v43
    v_exp_f32 v88, v88
    v_exp_f32 v89, v89
    v_exp_f32 v90, v90
    v_exp_f32 v91, v91
    v_add_f32 v30, v30, v40
    v_add_f32 v30, v30, v41
    v_add_f32 v30, v30, v42
    v_add_f32 v30, v30, v43
    v_add_f32 v30, v30, v88
    v_add_f32 v30, v30, v89
    v_add_f32 v30, v30, v90
    v_add_f32 v30, v30, v91
    v_cvt_pk_bf16_f32 v40, v40, v41
    v_cvt_pk_bf16_f32 v41, v42, v43
    v_cvt_pk_bf16_f32 v42, v88, v89
    v_cvt_pk_bf16_f32 v43, v90, v91
    v_exp_f32 v48, v48
    v_exp_f32 v49, v49
    v_exp_f32 v50, v50
    v_exp_f32 v51, v51
    v_exp_f32 v96, v96
    v_exp_f32 v97, v97
    v_exp_f32 v98, v98
    v_exp_f32 v99, v99
    v_add_f32 v31, v31, v48
    v_add_f32 v31, v31, v49
    v_add_f32 v31, v31, v50
    v_add_f32 v31, v31, v51
    v_add_f32 v31, v31, v96
    v_add_f32 v31, v31, v97
    v_add_f32 v31, v31, v98
    v_add_f32 v31, v31, v99
    v_cvt_pk_bf16_f32 v48, v48, v49
    v_cvt_pk_bf16_f32 v49, v50, v51
    v_cvt_pk_bf16_f32 v50, v96, v97
    v_cvt_pk_bf16_f32 v51, v98, v99
    v_exp_f32 v56, v56
    v_exp_f32 v57, v57
    v_exp_f32 v58, v58
    v_exp_f32 v59, v59
    v_exp_f32 v104, v104
    v_exp_f32 v105, v105
    v_exp_f32 v106, v106
    v_exp_f32 v107, v107
    v_add_f32 v32, v32, v56
    v_add_f32 v32, v32, v57
    v_add_f32 v32, v32, v58
    v_add_f32 v32, v32, v59
    v_add_f32 v32, v32, v104
    v_add_f32 v32, v32, v105
    v_add_f32 v32, v32, v106
    v_add_f32 v32, v32, v107
    v_cvt_pk_bf16_f32 v56, v56, v57
    v_cvt_pk_bf16_f32 v57, v58, v59
    v_cvt_pk_bf16_f32 v58, v104, v105
    v_cvt_pk_bf16_f32 v59, v106, v107
    v_add_u32 v5, s98, v5
    v_add_u32 v6, s98, v6
    v_add_u32 v7, s98, v7
    v_add_u32 v8, s98, v8
    s_waitcnt lgkmcnt(1)
    v_mfma_f32_16x16x32_bf16 v[136:139], a[192:195], v[36:39], v[228:231]
    v_mfma_f32_16x16x32_bf16 v[144:147], a[192:195], v[44:47], v[232:235]
    v_mfma_f32_16x16x32_bf16 v[152:155], a[192:195], v[52:55], v[236:239]
    v_mfma_f32_16x16x32_bf16 v[160:163], a[192:195], v[60:63], v[240:243]
    v_mfma_f32_16x16x32_bf16 v[168:171], a[192:195], v[68:71], v[244:247]
    v_mfma_f32_16x16x32_bf16 v[176:179], a[192:195], v[76:79], v[248:251]
    s_waitcnt lgkmcnt(0)
    v_mfma_f32_16x16x32_bf16 v[136:139], a[196:199], v[84:87], v[136:139]
    v_mfma_f32_16x16x32_bf16 v[144:147], a[196:199], v[92:95], v[144:147]
    v_mfma_f32_16x16x32_bf16 v[152:155], a[196:199], v[100:103], v[152:155]
    v_mfma_f32_16x16x32_bf16 v[160:163], a[196:199], v[108:111], v[160:163]
    v_mfma_f32_16x16x32_bf16 v[168:171], a[196:199], v[116:119], v[168:171]
    v_mfma_f32_16x16x32_bf16 v[176:179], a[196:199], v[124:127], v[176:179]
    ds_read_b128 a[200:203], v4 offset:128
    s_waitcnt lgkmcnt(0)
    v_mfma_f32_16x16x32_bf16 v[136:139], a[200:203], v[132:135], v[136:139]
    v_mfma_f32_16x16x32_bf16 v[144:147], a[200:203], v[140:143], v[144:147]
    v_mfma_f32_16x16x32_bf16 v[152:155], a[200:203], v[148:151], v[152:155]
    v_mfma_f32_16x16x32_bf16 v[160:163], a[200:203], v[156:159], v[160:163]
    v_mfma_f32_16x16x32_bf16 v[168:171], a[200:203], v[164:167], v[168:171]
    v_mfma_f32_16x16x32_bf16 v[176:179], a[200:203], v[172:175], v[176:179]
    ds_read_b128 a[204:207], v4 offset:192
    s_waitcnt lgkmcnt(0)
    v_mfma_f32_16x16x32_bf16 v[136:139], a[204:207], v[180:183], v[136:139]
    v_mfma_f32_16x16x32_bf16 v[144:147], a[204:207], v[188:191], v[144:147]
    v_mfma_f32_16x16x32_bf16 v[152:155], a[204:207], v[196:199], v[152:155]
    v_mfma_f32_16x16x32_bf16 v[160:163], a[204:207], v[204:207], v[160:163]
    v_mfma_f32_16x16x32_bf16 v[168:171], a[204:207], v[212:215], v[168:171]
    v_mfma_f32_16x16x32_bf16 v[176:179], a[204:207], v[220:223], v[176:179]
    ds_read_b128 a[192:195], v4 offset:4352
    s_waitcnt lgkmcnt(0)
    v_mfma_f32_16x16x32_bf16 v[184:187], a[192:195], v[36:39], v[228:231]
    v_mfma_f32_16x16x32_bf16 v[192:195], a[192:195], v[44:47], v[232:235]
    v_mfma_f32_16x16x32_bf16 v[200:203], a[192:195], v[52:55], v[236:239]
    v_mfma_f32_16x16x32_bf16 v[208:211], a[192:195], v[60:63], v[240:243]
    v_mfma_f32_16x16x32_bf16 v[216:219], a[192:195], v[68:71], v[244:247]
    v_mfma_f32_16x16x32_bf16 v[224:227], a[192:195], v[76:79], v[248:251]
    ds_read_b128 a[196:199], v4 offset:4416
    s_waitcnt lgkmcnt(0)
    v_mfma_f32_16x16x32_bf16 v[184:187], a[196:199], v[84:87], v[184:187]
    v_mfma_f32_16x16x32_bf16 v[192:195], a[196:199], v[92:95], v[192:195]
    v_mfma_f32_16x16x32_bf16 v[200:203], a[196:199], v[100:103], v[200:203]
    v_mfma_f32_16x16x32_bf16 v[208:211], a[196:199], v[108:111], v[208:211]
    v_mfma_f32_16x16x32_bf16 v[216:219], a[196:199], v[116:119], v[216:219]
    v_mfma_f32_16x16x32_bf16 v[224:227], a[196:199], v[124:127], v[224:227]
    ds_read_b128 a[200:203], v4 offset:4480
    s_waitcnt lgkmcnt(0)
    v_mfma_f32_16x16x32_bf16 v[184:187], a[200:203], v[132:135], v[184:187]
    v_mfma_f32_16x16x32_bf16 v[192:195], a[200:203], v[140:143], v[192:195]
    v_mfma_f32_16x16x32_bf16 v[200:203], a[200:203], v[148:151], v[200:203]
    v_mfma_f32_16x16x32_bf16 v[208:211], a[200:203], v[156:159], v[208:211]
    v_mfma_f32_16x16x32_bf16 v[216:219], a[200:203], v[164:167], v[216:219]
    v_mfma_f32_16x16x32_bf16 v[224:227], a[200:203], v[172:175], v[224:227]
    ds_read_b128 a[204:207], v4 offset:4544
    s_waitcnt lgkmcnt(0)
    v_mfma_f32_16x16x32_bf16 v[184:187], a[204:207], v[180:183], v[184:187]
    v_mfma_f32_16x16x32_bf16 v[192:195], a[204:207], v[188:191], v[192:195]
    v_mfma_f32_16x16x32_bf16 v[200:203], a[204:207], v[196:199], v[200:203]
    v_mfma_f32_16x16x32_bf16 v[208:211], a[204:207], v[204:207], v[208:211]
    v_mfma_f32_16x16x32_bf16 v[216:219], a[204:207], v[212:215], v[216:219]
    v_mfma_f32_16x16x32_bf16 v[224:227], a[204:207], v[220:223], v[224:227]
    v_exp_f32 v64, v64
    v_exp_f32 v65, v65
    v_exp_f32 v66, v66
    v_exp_f32 v67, v67
    v_exp_f32 v112, v112
    v_exp_f32 v113, v113
    v_exp_f32 v114, v114
    v_exp_f32 v115, v115
    v_add_f32 v33, v33, v64
    v_add_f32 v33, v33, v65
    v_add_f32 v33, v33, v66
    v_add_f32 v33, v33, v67
    v_add_f32 v33, v33, v112
    v_add_f32 v33, v33, v113
    v_add_f32 v33, v33, v114
    v_add_f32 v33, v33, v115
    v_cvt_pk_bf16_f32 v64, v64, v65
    v_cvt_pk_bf16_f32 v65, v66, v67
    v_cvt_pk_bf16_f32 v66, v112, v113
    v_cvt_pk_bf16_f32 v67, v114, v115
    v_exp_f32 v72, v72
    v_exp_f32 v73, v73
    v_exp_f32 v74, v74
    v_exp_f32 v75, v75
    v_exp_f32 v120, v120
    v_exp_f32 v121, v121
    v_exp_f32 v122, v122
    v_exp_f32 v123, v123
    v_add_f32 v34, v34, v72
    v_add_f32 v34, v34, v73
    v_add_f32 v34, v34, v74
    v_add_f32 v34, v34, v75
    v_add_f32 v34, v34, v120
    v_add_f32 v34, v34, v121
    v_add_f32 v34, v34, v122
    v_add_f32 v34, v34, v123
    v_cvt_pk_bf16_f32 v72, v72, v73
    v_cvt_pk_bf16_f32 v73, v74, v75
    v_cvt_pk_bf16_f32 v74, v120, v121
    v_cvt_pk_bf16_f32 v75, v122, v123
    v_exp_f32 v80, v80
    v_exp_f32 v81, v81
    v_exp_f32 v82, v82
    v_exp_f32 v83, v83
    v_exp_f32 v128, v128
    v_exp_f32 v129, v129
    v_exp_f32 v130, v130
    v_exp_f32 v131, v131
    v_add_f32 v35, v35, v80
    v_add_f32 v35, v35, v81
    v_add_f32 v35, v35, v82
    v_add_f32 v35, v35, v83
    v_add_f32 v35, v35, v128
    v_add_f32 v35, v35, v129
    v_add_f32 v35, v35, v130
    v_add_f32 v35, v35, v131
    v_cvt_pk_bf16_f32 v80, v80, v81
    v_cvt_pk_bf16_f32 v81, v82, v83
    v_cvt_pk_bf16_f32 v82, v128, v129
    v_cvt_pk_bf16_f32 v83, v130, v131
    s_add_u32 m0, s43, s99
    s_nop 0
    buffer_load_dwordx4 v9, s[8:11], s48 offen offset:0 nt lds
    buffer_load_dwordx4 v10, s[8:11], s48 offen offset:1088 nt lds
    buffer_load_dwordx4 v11, s[8:11], s48 offen offset:2176 nt lds
    buffer_load_dwordx4 v12, s[8:11], s48 offen offset:3264 nt lds
    s_add_u32 s48, s48, s96
    s_add_u32 m0, s44, s99
    s_nop 0
    buffer_load_dwordx4 v13, s[12:15], s49 offen offset:0 nt lds
    buffer_load_dwordx4 v14, s[12:15], s49 offen offset:1088 nt lds
    buffer_load_dwordx4 v15, s[12:15], s49 offen offset:2176 nt lds
    buffer_load_dwordx4 v16, s[12:15], s49 offen offset:3264 nt lds
    s_add_u32 s49, s49, s96
    ds_read_b64_tr_b16 a[208:209], v5 offset:0
    ds_read_b64_tr_b16 a[210:211], v5 offset:4352
    s_waitcnt lgkmcnt(0)
    v_mfma_f32_16x16x32_bf16 a[0:3], a[208:211], v[40:43], 0
    v_mfma_f32_16x16x32_bf16 a[4:7], a[208:211], v[48:51], 0
    v_mfma_f32_16x16x32_bf16 a[8:11], a[208:211], v[56:59], 0
    v_mfma_f32_16x16x32_bf16 a[12:15], a[208:211], v[64:67], 0
    v_mfma_f32_16x16x32_bf16 a[16:19], a[208:211], v[72:75], 0
    v_mfma_f32_16x16x32_bf16 a[20:23], a[208:211], v[80:83], 0
    ds_read_b64_tr_b16 a[212:213], v6 offset:0
    ds_read_b64_tr_b16 a[214:215], v6 offset:4352
    s_waitcnt lgkmcnt(0)
    v_mfma_f32_16x16x32_bf16 a[24:27], a[212:215], v[40:43], 0
    v_mfma_f32_16x16x32_bf16 a[28:31], a[212:215], v[48:51], 0
    v_mfma_f32_16x16x32_bf16 a[32:35], a[212:215], v[56:59], 0
    v_mfma_f32_16x16x32_bf16 a[36:39], a[212:215], v[64:67], 0
    v_mfma_f32_16x16x32_bf16 a[40:43], a[212:215], v[72:75], 0
    v_mfma_f32_16x16x32_bf16 a[44:47], a[212:215], v[80:83], 0
    ds_read_b64_tr_b16 a[216:217], v7 offset:0
    ds_read_b64_tr_b16 a[218:219], v7 offset:4352
    s_waitcnt lgkmcnt(0)
    v_mfma_f32_16x16x32_bf16 a[48:51], a[216:219], v[40:43], 0
    v_mfma_f32_16x16x32_bf16 a[52:55], a[216:219], v[48:51], 0
    v_mfma_f32_16x16x32_bf16 a[56:59], a[216:219], v[56:59], 0
    v_mfma_f32_16x16x32_bf16 a[60:63], a[216:219], v[64:67], 0
    v_mfma_f32_16x16x32_bf16 a[64:67], a[216:219], v[72:75], 0
    v_mfma_f32_16x16x32_bf16 a[68:71], a[216:219], v[80:83], 0
    ds_read_b64_tr_b16 a[220:221], v8 offset:0
    ds_read_b64_tr_b16 a[222:223], v8 offset:4352
    s_waitcnt lgkmcnt(0)
    v_mfma_f32_16x16x32_bf16 a[72:75], a[220:223], v[40:43], 0
    v_mfma_f32_16x16x32_bf16 a[76:79], a[220:223], v[48:51], 0
    v_mfma_f32_16x16x32_bf16 a[80:83], a[220:223], v[56:59], 0
    v_mfma_f32_16x16x32_bf16 a[84:87], a[220:223], v[64:67], 0
    v_mfma_f32_16x16x32_bf16 a[88:91], a[220:223], v[72:75], 0
    v_mfma_f32_16x16x32_bf16 a[92:95], a[220:223], v[80:83], 0
    ds_read_b64_tr_b16 a[224:225], v5 offset:128
    ds_read_b64_tr_b16 a[226:227], v5 offset:4480
    s_waitcnt lgkmcnt(0)
    v_mfma_f32_16x16x32_bf16 a[96:99], a[224:227], v[40:43], 0
    v_mfma_f32_16x16x32_bf16 a[100:103], a[224:227], v[48:51], 0
    v_mfma_f32_16x16x32_bf16 a[104:107], a[224:227], v[56:59], 0
    v_mfma_f32_16x16x32_bf16 a[108:111], a[224:227], v[64:67], 0
    v_mfma_f32_16x16x32_bf16 a[112:115], a[224:227], v[72:75], 0
    v_mfma_f32_16x16x32_bf16 a[116:119], a[224:227], v[80:83], 0
    ds_read_b64_tr_b16 a[208:209], v6 offset:128
    ds_read_b64_tr_b16 a[210:211], v6 offset:4480
    s_waitcnt lgkmcnt(0)
    v_mfma_f32_16x16x32_bf16 a[120:123], a[208:211], v[40:43], 0
    v_mfma_f32_16x16x32_bf16 a[124:127], a[208:211], v[48:51], 0
    v_mfma_f32_16x16x32_bf16 a[128:131], a[208:211], v[56:59], 0
    v_mfma_f32_16x16x32_bf16 a[132:135], a[208:211], v[64:67], 0
    v_mfma_f32_16x16x32_bf16 a[136:139], a[208:211], v[72:75], 0
    v_mfma_f32_16x16x32_bf16 a[140:143], a[208:211], v[80:83], 0
    ds_read_b64_tr_b16 a[212:213], v7 offset:128
    ds_read_b64_tr_b16 a[214:215], v7 offset:4480
    ds_read_b64_tr_b16 a[216:217], v8 offset:128
    ds_read_b64_tr_b16 a[218:219], v8 offset:4480
    s_mov_b32 s99, s98
    s_add_u32 s98, s98, 34816
    s_cmp_eq_u32 s98, 139264
    s_cselect_b32 s98, 0, s98
    s_sub_u32 s100, s98, s99
    s_waitcnt lgkmcnt(0)
    s_waitcnt vmcnt(0)
    s_barrier
    v_add_u32 v4, s100, v4
    ds_read_b128 a[192:195], v4 offset:0
    ds_read_b128 a[196:199], v4 offset:64
    v_mfma_f32_16x16x32_bf16 a[144:147], a[212:215], v[40:43], 0
    v_mfma_f32_16x16x32_bf16 a[148:151], a[212:215], v[48:51], 0
    v_mfma_f32_16x16x32_bf16 a[152:155], a[212:215], v[56:59], 0
    v_mfma_f32_16x16x32_bf16 a[156:159], a[212:215], v[64:67], 0
    v_mfma_f32_16x16x32_bf16 a[160:163], a[212:215], v[72:75], 0
    v_mfma_f32_16x16x32_bf16 a[164:167], a[212:215], v[80:83], 0
    v_mfma_f32_16x16x32_bf16 a[168:171], a[216:219], v[40:43], 0
    v_mfma_f32_16x16x32_bf16 a[172:175], a[216:219], v[48:51], 0
    v_mfma_f32_16x16x32_bf16 a[176:179], a[216:219], v[56:59], 0
    v_mfma_f32_16x16x32_bf16 a[180:183], a[216:219], v[64:67], 0
    v_mfma_f32_16x16x32_bf16 a[184:187], a[216:219], v[72:75], 0
    v_mfma_f32_16x16x32_bf16 a[188:191], a[216:219], v[80:83], 0
    v_exp_f32 v136, v136
    v_exp_f32 v137, v137
    v_exp_f32 v138, v138
    v_exp_f32 v139, v139
    v_exp_f32 v184, v184
    v_exp_f32 v185, v185
    v_exp_f32 v186, v186
    v_exp_f32 v187, v187
    v_add_f32 v30, v30, v136
    v_add_f32 v30, v30, v137
    v_add_f32 v30, v30, v138
    v_add_f32 v30, v30, v139
    v_add_f32 v30, v30, v184
    v_add_f32 v30, v30, v185
    v_add_f32 v30, v30, v186
    v_add_f32 v30, v30, v187
    v_cvt_pk_bf16_f32 v136, v136, v137
    v_cvt_pk_bf16_f32 v137, v138, v139
    v_cvt_pk_bf16_f32 v138, v184, v185
    v_cvt_pk_bf16_f32 v139, v186, v187
    v_exp_f32 v144, v144
    v_exp_f32 v145, v145
    v_exp_f32 v146, v146
    v_exp_f32 v147, v147
    v_exp_f32 v192, v192
    v_exp_f32 v193, v193
    v_exp_f32 v194, v194
    v_exp_f32 v195, v195
    v_add_f32 v31, v31, v144
    v_add_f32 v31, v31, v145
    v_add_f32 v31, v31, v146
    v_add_f32 v31, v31, v147
    v_add_f32 v31, v31, v192
    v_add_f32 v31, v31, v193
    v_add_f32 v31, v31, v194
    v_add_f32 v31, v31, v195
    v_cvt_pk_bf16_f32 v144, v144, v145
    v_cvt_pk_bf16_f32 v145, v146, v147
    v_cvt_pk_bf16_f32 v146, v192, v193
    v_cvt_pk_bf16_f32 v147, v194, v195
    v_exp_f32 v152, v152
    v_exp_f32 v153, v153
    v_exp_f32 v154, v154
    v_exp_f32 v155, v155
    v_exp_f32 v200, v200
    v_exp_f32 v201, v201
    v_exp_f32 v202, v202
    v_exp_f32 v203, v203
    v_add_f32 v32, v32, v152
    v_add_f32 v32, v32, v153
    v_add_f32 v32, v32, v154
    v_add_f32 v32, v32, v155
    v_add_f32 v32, v32, v200
    v_add_f32 v32, v32, v201
    v_add_f32 v32, v32, v202
    v_add_f32 v32, v32, v203
    v_cvt_pk_bf16_f32 v152, v152, v153
    v_cvt_pk_bf16_f32 v153, v154, v155
    v_cvt_pk_bf16_f32 v154, v200, v201
    v_cvt_pk_bf16_f32 v155, v202, v203
    s_waitcnt vmcnt(0) lgkmcnt(0)
    s_branch L_rejoin
L_end:
    s_endpgm

.section .rodata,"a"
.p2align 6
.amdhsa_kernel concat_heads__gqa_block_cached__gqa_block_cached__near_ridge_kernel
  .amdhsa_next_free_vgpr 512
  .amdhsa_next_free_sgpr 102
  .amdhsa_accum_offset 256
  .amdhsa_group_segment_fixed_size 0
  .amdhsa_kernarg_size 104
  .amdhsa_user_sgpr_count 2
  .amdhsa_user_sgpr_kernarg_segment_ptr 1
  .amdhsa_system_sgpr_workgroup_id_x 1
.end_amdhsa_kernel
```
